```python
import torch

def _softmax(x, axis=-1):
    return torch.softmax(x, dim=axis)
def _gelu(x):
    return torch.nn.functional.gelu(x, approximate="tanh")
def _silu(x):
    return torch.nn.functional.silu(x)
def _sigmoid(x):
    return torch.sigmoid(x)
def _layernorm(x, axis=-1, eps=1e-5):
    m = x.mean(dim=axis, keepdim=True)
    v = x.var(dim=axis, keepdim=True, unbiased=False)
    return (x - m) / torch.sqrt(v + eps)
def _scatter_add(tgt, idx, src, axis=0):
    return tgt.clone().index_add_(axis, idx, src)
def _segment_sum(src, seg, n):
    out = torch.zeros((n,) + src.shape[1:], dtype=src.dtype)
    return out.index_add_(0, seg, src)
def _pad(x, pw):
    flat = tuple(v for pair in reversed(pw) for v in pair)
    return torch.nn.functional.pad(x, flat)

kernel_name = 'interleave_layers__sliding_local_dilated__dense_activation_relu__prompt'

def setup_inputs():

    _w = (lambda a: (lambda t: t.to(torch.bfloat16) if t.is_floating_point() else t)(torch.as_tensor(a)))
    def _A_setup():
        B, S, D = 1, 2048, 512
        return {
            "x": _w((lambda *s: torch.randn(*s, dtype=torch.bfloat16) * 0.05)(B, S, D)),
            "wqkv": _w((lambda *s: torch.randn(*s, dtype=torch.bfloat16) * 0.05)(D, 3 * D)),
            "wo": _w((lambda *s: torch.randn(*s, dtype=torch.bfloat16) * 0.05)(D, D)),
        }
    _A_in = _A_setup()

    def _B_setup():
        B, S, D, Dff = 1, 2048, 512, 1792
        return {
            "x": _w((lambda *s: torch.randn(*s, dtype=torch.bfloat16) * 0.05)(B, S, D)),
            "w1": _w((lambda *s: torch.randn(*s, dtype=torch.bfloat16) * 0.05)(D, Dff)),
            "w2": _w((lambda *s: torch.randn(*s, dtype=torch.bfloat16) * 0.05)(Dff, D)),
        }
    _B_in = _B_setup()

    return {
        "A_x": _A_in["x"],
        "A_wqkv": _A_in["wqkv"],
        "A_wo": _A_in["wo"],
        "B_x": _B_in["x"],
        "B_w1": _B_in["w1"],
        "B_w2": _B_in["w2"],
    }

def reference(A_x, A_wqkv, A_wo, B_x, B_w1, B_w2):
    def _A_ref(x, wqkv, wo):
        B, S, D = x.shape
        H = 32; Dh = D // H
        W, dil = 8, 2
        qkv = (lambda x, *d: x.permute(*d))((x @ wqkv).reshape(B, S, 3, H, Dh), 2, 0, 3, 1, 4)
        q, k, v = qkv[0], qkv[1], qkv[2]
        scale = Dh ** -0.5
        pos = torch.arange(S)
        off = torch.arange(W) * dil
        idx = pos[:, None] - off[None, :]
        mask = idx >= 0
        idx_c = torch.where(mask, idx, 0).reshape(-1)
        kg = k[:, :, idx_c, :].reshape(B, H, S, W, Dh)
        vg = v[:, :, idx_c, :].reshape(B, H, S, W, Dh)
        logits = torch.einsum("bhsd,bhswd->bhsw", q, kg) * scale
        logits = torch.where(mask[None, None, :, :], logits, -1e9)
        attn = _softmax(logits, axis=-1)
        o = torch.einsum("bhsw,bhswd->bhsd", attn, vg)
        return (lambda x, *d: x.permute(*d))(o, 0, 2, 1, 3).reshape(B, S, D) @ wo

    def _B_ref(x, w1, w2):
        h = torch.einsum("bsd,df->bsf", x, w1)
        zero = torch.zeros_like(h)
        h = torch.maximum(h, zero)
        return torch.einsum("bsf,fd->bsd", h, w2)

    x = A_x
    x = x + _A_ref(_layernorm(x, axis=-1), A_wqkv, A_wo)
    x = x + _B_ref(_layernorm(x, axis=-1), B_w1, B_w2)
    x = x + _A_ref(_layernorm(x, axis=-1), A_wqkv, A_wo)
    x = x + _B_ref(_layernorm(x, axis=-1), B_w1, B_w2)
    return x
```

```asm
; @launch grid=(256,1,1) block=(256,1,1) lds=163840
.amdgcn_target "amdgcn-amd-amdhsa--gfx950"
.text
.globl interleave_layers__sliding_local_dilated__dense_activation_relu__prompt_kernel
.p2align 8
.type interleave_layers__sliding_local_dilated__dense_activation_relu__prompt_kernel,@function
interleave_layers__sliding_local_dilated__dense_activation_relu__prompt_kernel:
    s_cmp_ge_u32 s2, 256
    s_cbranch_scc1 L_end
    s_load_dwordx16 s[72:87], s[0:1], 0
    s_load_dwordx2 s[88:89], s[0:1], 64
    s_getpc_b64 s[92:93]
L_pc:
    v_lshrrev_b32 v1, 6, v0
    v_and_b32 v222, 63, v0
    s_lshr_b32 s95, s2, 3
    v_and_b32 v4, 7, v0
    v_lshl_add_u32 v4, v1, 3, v4
    v_lshl_add_u32 v4, s95, 5, v4
    v_lshlrev_b32 v4, 7, v4
    v_min_u32 v4, L_code_end-L_pc-4, v4
    global_load_dword v5, v4, s[92:93]
    v_readfirstlane_b32 s44, v1
    s_and_b32 s94, s2, 7
    s_and_b32 s45, s95, 15
    s_lshr_b32 s95, s95, 4
    s_lshl_b32 s94, s94, 1
    s_add_u32 s3, s94, s95
    s_and_b32 s48, s3, 7
    s_lshr_b32 s49, s3, 3
    s_lshr_b32 s47, s45, 3
    s_and_b32 s46, s45, 7
    v_lshlrev_b32 v223, 4, v222
    v_lshrrev_b32 v1, 3, v222
    v_and_b32 v2, 7, v222
    v_lshrrev_b32 v3, 4, v222
    v_xor_b32 v2, v2, v3
    v_lshlrev_b32 v2, 4, v2
    v_lshl_add_u32 v172, v1, 11, v2
    v_xor_b32 v173, 64, v172
    s_lshl_b32 s94, s48, 8
    s_add_u32 s94, s94, s49
    s_lshl_b32 s94, s94, 10
    s_lshl_b32 s32, s44, 16
    s_add_u32 s32, s32, s94
    s_lshl_b32 s40, s47, 17
    s_add_u32 s40, s40, s94
    s_lshl_b32 s95, s44, 15
    s_add_u32 s40, s40, s95
    s_lshl_b32 s95, s46, 7
    s_add_u32 s40, s40, s95
    s_lshl_b32 s42, s44, 11
    s_sub_u32 s41, s94, 16384
    s_lshl_b32 s95, s44, 8
    s_add_u32 s41, s41, s95
    s_cmp_eq_u32 s48, 0
    s_cselect_b32 s41, 0, s41
    s_cselect_b32 s95, 2130706432, 0
    v_add_u32 v202, s95, v173
    s_lshl_b32 s43, s44, 14
    s_lshl_b32 s33, s44, 8
    s_add_u32 s33, s33, s2
    v_lshlrev_b32 v9, 7, v222
    v_and_b32 v10, 7, v222
    v_lshlrev_b32 v10, 7, v10
    v_lshl_add_u32 v10, v1, 11, v10
    s_lshl_b32 s34, s45, 14
    s_add_u32 s34, s34, s94
    s_cmp_eq_u32 s44, 3
    s_cselect_b32 s34, s34, 2130706432
    v_add_u32 v10, s34, v10
    s_mov_b32 s6, 2097152
    s_mov_b32 s7, 0x20000
    s_waitcnt lgkmcnt(0)
    s_mov_b32 s4, s72
    s_mov_b32 s5, s73
    buffer_load_dword v5, v10, s[4:7], 0 offen
    s_mov_b32 s8, s74
    s_mov_b32 s9, s75
    s_mov_b32 s10, 1572864
    s_mov_b32 s11, 0x20000
    s_sub_u32 s95, s33, 0
    s_min_u32 s95, s95, 0x1000
    s_lshl_b32 s95, s95, 13
    v_add_u32 v11, s95, v9
    buffer_load_dword v5, v11, s[8:11], 0 offen
    s_lshr_b32 s92, s2, 3
    s_mul_i32 s92, s92, 49152
    s_add_u32 s92, s92, 384
    s_cmp_eq_u32 s44, 1
    s_cselect_b32 s92, s92, 2130706432
    v_min_u32 v11, 47, v222
    v_mul_u32_u24 v11, 1024, v11
    v_add_u32 v11, s92, v11
    buffer_load_dword v5, v11, s[8:11], 0 offen
    s_add_u32 m0, s42, 24576
    s_add_u32 s95, s40, 0
    buffer_load_dwordx4 v172, s[4:7], s95 offen lds
    s_add_u32 m0, s42, 25600
    s_add_u32 s95, s40, 16384
    buffer_load_dwordx4 v173, s[4:7], s95 offen lds
    s_add_u32 m0, s42, 57344
    s_add_u32 s95, s41, 0
    buffer_load_dwordx4 v202, s[4:7], s95 offen lds
    s_add_u32 m0, s42, 58368
    s_add_u32 s95, s41, 128
    buffer_load_dwordx4 v202, s[4:7], s95 offen lds
    s_add_u32 m0, s43, 98304
    s_add_u32 s95, s32, 0
    buffer_load_dwordx4 v172, s[4:7], s95 offen lds
    s_add_u32 m0, s43, 99328
    s_add_u32 s95, s32, 16384
    buffer_load_dwordx4 v173, s[4:7], s95 offen lds
    s_add_u32 m0, s43, 100352
    s_add_u32 s95, s32, 32768
    buffer_load_dwordx4 v172, s[4:7], s95 offen lds
    s_add_u32 m0, s43, 101376
    s_add_u32 s95, s32, 49152
    buffer_load_dwordx4 v173, s[4:7], s95 offen lds
    s_mov_b32 s12, s76
    s_mov_b32 s13, s77
    s_mov_b32 s14, 524288
    s_mov_b32 s15, 0x20000
    s_mov_b32 s16, s80
    s_mov_b32 s17, s81
    s_mov_b32 s18, 1835008
    s_mov_b32 s19, 0x20000
    s_mov_b32 s20, s82
    s_mov_b32 s21, s83
    s_mov_b32 s22, 1835008
    s_mov_b32 s23, 0x20000
    s_lshl_b32 s94, s3, 21
    s_add_u32 s28, s88, s94
    s_addc_u32 s29, s89, 0
    s_mov_b32 s30, 2097152
    s_mov_b32 s31, 0x20000
    s_add_u32 s36, s28, 2097152
    s_addc_u32 s37, s29, 0
    s_cmp_lg_u32 s48, 7
    s_cselect_b32 s94, s47, 0
    s_lshl_b32 s38, s94, 21
    s_mov_b32 s39, 0x20000
    v_min_u32 v6, 2, v222
    v_lshlrev_b32 v6, 7, v6
    v_sub_u32 v6, 1769728, v6
    buffer_load_dword v150, v6, s[28:31], 0 offen sc1
    buffer_load_dword v151, v6, s[36:39], 0 offen sc1
    s_mov_b32 s24, s84
    s_mov_b32 s25, s85
    s_mov_b32 s26, 2097152
    s_mov_b32 s27, 0x20000
    s_mov_b32 s78, s32
    s_mov_b32 s82, s43
    s_mov_b32 s32, s28
    s_mov_b32 s33, s29
    s_cmp_eq_u32 s48, 0
    s_cselect_b32 s34, 0, 2097152
    s_mov_b32 s35, 0x20000
    s_cselect_b32 s62, 0, -1
    s_mov_b32 s63, s62
    s_mov_b64 s[60:61], -1
    s_mov_b32 s40, s28
    s_mov_b32 s41, s29
    s_cmp_lt_u32 s45, 14
    s_cselect_b32 s42, 2097152, 0
    s_mov_b32 s43, 0x20000
    s_cmp_lt_u32 s44, 2
    s_cselect_b32 s54, -1, 0
    s_cselect_b32 s55, 0, -1
    s_mov_b32 s64, 0
    s_mov_b32 s65, -1
    s_mov_b32 s53, 0
    s_lshl_b32 s92, s44, 8
    s_add_u32 s90, s92, 161664
    s_lshl_b32 s92, s44, 7
    s_add_u32 s3, s92, 162688
    s_lshl_b32 s92, s44, 4
    s_lshl_b32 s93, s47, 1
    s_add_u32 s92, s92, s93
    s_mov_b64 s[56:57], 0x3333
    s_lshl_b64 s[56:57], s[56:57], s92
    s_mul_i32 s92, s44, 7
    s_lshr_b32 s92, s92, 1
    s_lshl_b32 s92, s92, 2
    s_add_u32 s92, s92, s93
    s_cmp_eq_u32 s44, 3
    s_mov_b32 s58, 0x3333
    s_cselect_b32 s58, 0x333333, s58
    s_mov_b32 s59, 0
    s_lshl_b64 s[58:59], s[58:59], s92
    s_mov_b32 s66, 0
    s_mov_b32 s67, 4096
    s_mov_b32 s68, 8192
    s_mov_b32 s69, 12288
    s_mov_b32 s70, 16384
    s_mov_b32 s71, 20480
    s_mov_b32 s72, 24576
    s_mov_b32 s73, 28672
    v_and_b32 v80, 3, v222
    v_lshlrev_b32 v80, 3, v80
    v_bfe_u32 v86, v222, 2, 2
    v_lshl_add_u32 v80, v86, 6, v80
    v_bfe_u32 v86, v222, 4, 1
    v_lshl_add_u32 v80, v86, 5, v80
    v_lshrrev_b32 v86, 5, v222
    v_lshl_add_u32 v80, v86, 9, v80
    v_add_u32 v81, 0x10000, v80
    s_lshl_b32 s92, s44, 10
    v_add_u32 v83, s92, v80
    v_add_u32 v84, 0x10000, v83
    s_lshl_b32 s92, s45, 2
    s_add_u32 s92, s92, s44
    s_lshl_b32 s92, s92, 2
    s_add_u32 s92, s92, 1769472
    v_mov_b32 v88, 2130706432
    v_writelane_b32 v88, s92, 0
    v_lshlrev_b32 v89, 2, v222
    v_add_u32 v89, 1769472, v89
    v_lshrrev_b32 v86, 4, v222
    v_and_b32 v85, 15, v222
    v_lshlrev_b32 v85, 4, v85
    v_lshl_add_u32 v85, v86, 10, v85
    s_lshl_b32 s92, s44, 8
    s_add_u32 s92, s92, 1572864
    v_add_u32 v85, s92, v85
    v_and_b32 v10, 31, v222
    v_lshrrev_b32 v11, 5, v222
    v_bfe_u32 v12, v222, 1, 3
    v_xor_b32 v11, v11, v12
    v_lshlrev_b32 v11, 4, v11
    v_lshl_add_u32 v174, v10, 7, v11
    v_xor_b32 v175, 32, v174
    v_xor_b32 v176, 64, v174
    v_xor_b32 v177, 0x60, v174
    v_and_b32 v10, 7, v222
    v_lshrrev_b32 v11, 5, v222
    s_lshl_b32 s92, s44, 1
    v_add_u32 v11, s92, v11
    v_bfe_u32 v12, v222, 1, 2
    v_add_u32 v12, 4, v12
    v_xor_b32 v11, v11, v12
    v_lshlrev_b32 v11, 4, v11
    v_lshl_add_u32 v196, v10, 7, v11
    v_add_u32 v196, 57344, v196
    s_lshl_b32 s83, s44, 13
    s_add_u32 s92, s82, 98304
    v_add_u32 v174, s92, v174
    v_add_u32 v175, s92, v175
    v_add_u32 v176, s92, v176
    v_add_u32 v177, s92, v177
    s_lshl_b32 s92, s45, 6
    v_lshrrev_b32 v86, 2, v222
    v_mul_u32_u24 v86, 3072, v86
    v_and_b32 v182, 3, v222
    v_lshlrev_b32 v182, 4, v182
    v_add3_u32 v182, v182, v86, s92
    s_mul_i32 s74, s44, 98304
    s_lshl_b32 s75, s44, 11
    v_and_b32 v10, 31, v222
    v_bfe_u32 v11, v222, 1, 3
    v_xor_b32 v11, s44, v11
    v_lshlrev_b32 v11, 4, v11
    v_lshl_add_u32 v11, v10, 7, v11
    v_lshrrev_b32 v12, 5, v222
    v_lshl_add_u32 v203, v12, 3, v11
    v_xor_b32 v13, 64, v203
    v_add_u32 v203, 24576, v203
    v_add_u32 v13, 24576, v13
    v_add_u32 v14, 57344, v223
    s_lshl_b32 s92, s44, 8
    s_add_u32 s92, s92, 90112
    v_lshlrev_b32 v204, 2, v222
    v_add_u32 v204, s92, v204
    s_or_b32 s88, s44, s48
    s_cmp_eq_u32 s88, 0
    s_cselect_b32 s88, 0xffffff00, -1
    s_cselect_b32 s86, -16, -1
    s_mov_b32 s87, s86
    v_mov_b32 v184, 0xf149f2ca
    v_cndmask_b32_e64 v188, v184, 0, s[86:87]
    v_mov_b32 v192, 0
    s_and_b32 s86, s88, 286331153
    s_mov_b32 s87, s86
    v_cndmask_b32_e64 v185, v184, 0, s[86:87]
    s_mov_b32 s86, 286331153
    s_mov_b32 s87, s86
    v_cndmask_b32_e64 v193, 0, v184, s[86:87]
    v_mov_b32 v189, v188
    s_and_b32 s86, s88, 858993459
    s_mov_b32 s87, s86
    v_cndmask_b32_e64 v186, v184, 0, s[86:87]
    s_mov_b32 s86, 858993459
    s_mov_b32 s87, s86
    v_cndmask_b32_e64 v194, 0, v184, s[86:87]
    v_mov_b32 v190, v188
    s_and_b32 s86, s88, 2004318071
    s_mov_b32 s87, s86
    v_cndmask_b32_e64 v187, v184, 0, s[86:87]
    s_mov_b32 s86, 2004318071
    s_mov_b32 s87, s86
    v_cndmask_b32_e64 v195, 0, v184, s[86:87]
    v_mov_b32 v191, v188
    v_and_b32 v94, 31, v222
    v_lshrrev_b32 v95, 5, v222
    s_lshl_b32 s92, s44, 9
    s_add_u32 s92, s92, 131072
    v_lshlrev_b32 v94, 4, v94
    v_add_u32 v94, s92, v94
    v_mul_u32_u24 v95, 2176, v95
    v_add3_u32 v217, v94, v95, 64
    v_add_u32 v217, 64, v217
    v_lshl_add_u32 v220, v95, 1, v94
    v_and_b32 v94, 3, v222
    v_bfe_u32 v91, v222, 4, 1
    v_lshl_add_u32 v94, v91, 2, v94
    v_bfe_u32 v91, v222, 2, 2
    v_lshl_add_u32 v94, v94, 2, v91
    v_lshlrev_b32 v94, 4, v94
    v_lshl_add_u32 v94, v95, 1, v94
    s_add_u32 s92, s92, 8704
    v_add_u32 v91, s92, v94
    s_lshl_b32 s84, s44, 15
    s_lshl_b32 s92, s45, 11
    s_add_u32 s84, s84, s92
    s_add_u32 s84, s84, 131072
    s_lshl_b32 s93, s46, 7
    v_bfe_u32 v86, v222, 4, 1
    v_lshlrev_b32 v86, 2, v86
    v_and_b32 v216, 7, v222
    v_xor_b32 v216, v216, v86
    v_lshlrev_b32 v216, 4, v216
    v_lshrrev_b32 v86, 3, v222
    v_mul_u32_u24 v86, 1024, v86
    v_add3_u32 v216, v216, v86, s93
    s_min_u32 s92, s45, 13
    s_lshl_b32 s93, s92, 8
    v_bfe_u32 v86, v222, 4, 1
    v_lshlrev_b32 v86, 2, v86
    v_and_b32 v90, 7, v222
    v_xor_b32 v90, v90, v86
    v_lshlrev_b32 v90, 4, v90
    v_lshrrev_b32 v86, 3, v222
    v_mul_u32_u24 v86, 3584, v86
    v_add3_u32 v90, v90, v86, s93
    s_mul_i32 s76, s44, 28672
    s_lshl_b32 s77, s44, 10
    v_and_b32 v87, 15, v222
    v_lshlrev_b32 v87, 7, v87
    v_add_u32 v87, 1771520, v87
    s_add_u32 m0, s75, 32768
    s_add_u32 s95, s74, 1024
    buffer_load_dwordx4 v182, s[8:11], s95 offen lds
    s_add_u32 m0, s75, 33792
    s_add_u32 s95, s74, 50176
    buffer_load_dwordx4 v182, s[8:11], s95 offen lds
    s_add_u32 m0, s75, 65536
    s_add_u32 s95, s74, 2048
    buffer_load_dwordx4 v182, s[8:11], s95 offen lds
    s_add_u32 m0, s75, 66560
    s_add_u32 s95, s74, 51200
    buffer_load_dwordx4 v182, s[8:11], s95 offen lds
    s_add_u32 m0, s75, 0
    s_add_u32 s95, s74, 0
    buffer_load_dwordx4 v182, s[8:11], s95 offen lds
    s_add_u32 m0, s75, 1024
    s_add_u32 s95, s74, 49152
    buffer_load_dwordx4 v182, s[8:11], s95 offen lds
    s_add_u32 m0, s82, 102400
    s_add_u32 s95, s78, 128
    buffer_load_dwordx4 v172, s[4:7], s95 offen lds
    s_add_u32 m0, s82, 103424
    s_add_u32 s95, s78, 16512
    buffer_load_dwordx4 v173, s[4:7], s95 offen lds
    s_add_u32 m0, s82, 104448
    s_add_u32 s95, s78, 32896
    buffer_load_dwordx4 v172, s[4:7], s95 offen lds
    s_add_u32 m0, s82, 105472
    s_add_u32 s95, s78, 49280
    buffer_load_dwordx4 v173, s[4:7], s95 offen lds
    s_waitcnt vmcnt(16)
    s_barrier
    ds_read_b64 v[16:17], v203 offset:0
    ds_read_b64 v[18:19], v13 offset:0
    ds_read_b64 v[20:21], v203 offset:4096
    ds_read_b64 v[22:23], v13 offset:4096
    ds_read_b128 v[48:51], v14 offset:0
    ds_read_b128 v[52:55], v14 offset:1024
    ds_read_b128 v[56:59], v14 offset:2048
    ds_read_b128 v[60:63], v14 offset:3072
    ds_read_b128 v[64:67], v14 offset:4096
    ds_read_b128 v[68:71], v14 offset:5120
    ds_read_b128 v[72:75], v14 offset:6144
    ds_read_b128 v[76:79], v14 offset:7168
    s_waitcnt lgkmcnt(8)
    ds_read_b128 a[128:131], v196 offset:0
    ds_read_b128 a[132:135], v196 offset:1024
    ds_read_b128 a[136:139], v196 offset:2048
    ds_read_b128 a[140:143], v196 offset:3072
    ds_read_b128 a[144:147], v196 offset:4096
    ds_read_b128 a[148:151], v196 offset:5120
    ds_read_b128 a[152:155], v196 offset:6144
    ds_read_b128 a[156:159], v196 offset:7168
    v_lshlrev_b32 v32, 16, v16
    v_and_b32 v33, 0xffff0000, v16
    v_accvgpr_write_b32 a216, v16
    v_lshlrev_b32 v34, 16, v17
    v_and_b32 v35, 0xffff0000, v17
    v_accvgpr_write_b32 a217, v17
    v_lshlrev_b32 v36, 16, v18
    v_and_b32 v37, 0xffff0000, v18
    v_accvgpr_write_b32 a218, v18
    v_lshlrev_b32 v38, 16, v19
    v_and_b32 v39, 0xffff0000, v19
    v_accvgpr_write_b32 a219, v19
    v_pk_add_f32 v[24:25], v[32:33], v[34:35]
    v_pk_mul_f32 v[26:27], v[32:33], v[32:33]
    v_pk_add_f32 v[24:25], v[24:25], v[36:37]
    v_pk_fma_f32 v[26:27], v[34:35], v[34:35], v[26:27]
    v_pk_add_f32 v[24:25], v[24:25], v[38:39]
    v_pk_fma_f32 v[26:27], v[36:37], v[36:37], v[26:27]
    v_add_f32 v24, v24, v25
    v_pk_fma_f32 v[26:27], v[38:39], v[38:39], v[26:27]
    v_add_f32 v26, v26, v27
    s_nop 1
    v_permlane32_swap_b32 v24, v26
    v_add_f32 v24, v24, v26
    ds_write_b32 v204, v24 offset:0
    v_lshlrev_b32 v40, 16, v20
    v_and_b32 v41, 0xffff0000, v20
    v_accvgpr_write_b32 a220, v20
    v_lshlrev_b32 v42, 16, v21
    v_and_b32 v43, 0xffff0000, v21
    v_accvgpr_write_b32 a221, v21
    v_lshlrev_b32 v44, 16, v22
    v_and_b32 v45, 0xffff0000, v22
    v_accvgpr_write_b32 a222, v22
    v_lshlrev_b32 v46, 16, v23
    v_and_b32 v47, 0xffff0000, v23
    v_accvgpr_write_b32 a223, v23
    v_pk_add_f32 v[28:29], v[40:41], v[42:43]
    v_pk_mul_f32 v[30:31], v[40:41], v[40:41]
    v_pk_add_f32 v[28:29], v[28:29], v[44:45]
    v_pk_fma_f32 v[30:31], v[42:43], v[42:43], v[30:31]
    v_pk_add_f32 v[28:29], v[28:29], v[46:47]
    v_pk_fma_f32 v[30:31], v[44:45], v[44:45], v[30:31]
    v_add_f32 v28, v28, v29
    v_pk_fma_f32 v[30:31], v[46:47], v[46:47], v[30:31]
    v_add_f32 v30, v30, v31
    s_nop 1
    v_permlane32_swap_b32 v28, v30
    v_add_f32 v28, v28, v30
    ds_write_b32 v204, v28 offset:1024
    s_add_u32 m0, s75, 40960
    s_add_u32 s95, s74, 394240
    buffer_load_dwordx4 v182, s[8:11], s95 offen lds
    s_add_u32 m0, s75, 41984
    s_add_u32 s95, s74, 443392
    buffer_load_dwordx4 v182, s[8:11], s95 offen lds
    s_add_u32 m0, s75, 73728
    s_add_u32 s95, s74, 395264
    buffer_load_dwordx4 v182, s[8:11], s95 offen lds
    s_add_u32 m0, s75, 74752
    s_add_u32 s95, s74, 444416
    buffer_load_dwordx4 v182, s[8:11], s95 offen lds
    s_add_u32 m0, s75, 8192
    s_add_u32 s95, s74, 393216
    buffer_load_dwordx4 v182, s[8:11], s95 offen lds
    s_add_u32 m0, s75, 9216
    s_add_u32 s95, s74, 442368
    buffer_load_dwordx4 v182, s[8:11], s95 offen lds
    v_mov_b32 v16, 0
    v_mov_b32 v17, 0
    v_mov_b32 v18, 0x3f803f80
    s_waitcnt lgkmcnt(10)
    v_dot2c_f32_bf16 v16, v48, v18
    v_dot2c_f32_bf16 v17, v48, v48
    v_dot2c_f32_bf16 v16, v49, v18
    v_dot2c_f32_bf16 v17, v49, v49
    v_dot2c_f32_bf16 v16, v50, v18
    v_dot2c_f32_bf16 v17, v50, v50
    v_dot2c_f32_bf16 v16, v51, v18
    v_dot2c_f32_bf16 v17, v51, v51
    v_dot2c_f32_bf16 v16, v52, v18
    v_dot2c_f32_bf16 v17, v52, v52
    v_dot2c_f32_bf16 v16, v53, v18
    v_dot2c_f32_bf16 v17, v53, v53
    v_dot2c_f32_bf16 v16, v54, v18
    v_dot2c_f32_bf16 v17, v54, v54
    v_dot2c_f32_bf16 v16, v55, v18
    v_dot2c_f32_bf16 v17, v55, v55
    v_dot2c_f32_bf16 v16, v56, v18
    v_dot2c_f32_bf16 v17, v56, v56
    v_dot2c_f32_bf16 v16, v57, v18
    v_dot2c_f32_bf16 v17, v57, v57
    v_dot2c_f32_bf16 v16, v58, v18
    v_dot2c_f32_bf16 v17, v58, v58
    v_dot2c_f32_bf16 v16, v59, v18
    v_dot2c_f32_bf16 v17, v59, v59
    v_dot2c_f32_bf16 v16, v60, v18
    v_dot2c_f32_bf16 v17, v60, v60
    v_dot2c_f32_bf16 v16, v61, v18
    v_dot2c_f32_bf16 v17, v61, v61
    v_dot2c_f32_bf16 v16, v62, v18
    v_dot2c_f32_bf16 v17, v62, v62
    v_dot2c_f32_bf16 v16, v63, v18
    v_dot2c_f32_bf16 v17, v63, v63
    v_dot2c_f32_bf16 v16, v64, v18
    v_dot2c_f32_bf16 v17, v64, v64
    v_dot2c_f32_bf16 v16, v65, v18
    v_dot2c_f32_bf16 v17, v65, v65
    v_dot2c_f32_bf16 v16, v66, v18
    v_dot2c_f32_bf16 v17, v66, v66
    v_dot2c_f32_bf16 v16, v67, v18
    v_dot2c_f32_bf16 v17, v67, v67
    v_dot2c_f32_bf16 v16, v68, v18
    v_dot2c_f32_bf16 v17, v68, v68
    v_dot2c_f32_bf16 v16, v69, v18
    v_dot2c_f32_bf16 v17, v69, v69
    v_dot2c_f32_bf16 v16, v70, v18
    v_dot2c_f32_bf16 v17, v70, v70
    v_dot2c_f32_bf16 v16, v71, v18
    v_dot2c_f32_bf16 v17, v71, v71
    v_dot2c_f32_bf16 v16, v72, v18
    v_dot2c_f32_bf16 v17, v72, v72
    v_dot2c_f32_bf16 v16, v73, v18
    v_dot2c_f32_bf16 v17, v73, v73
    v_dot2c_f32_bf16 v16, v74, v18
    v_dot2c_f32_bf16 v17, v74, v74
    v_dot2c_f32_bf16 v16, v75, v18
    v_dot2c_f32_bf16 v17, v75, v75
    v_dot2c_f32_bf16 v16, v76, v18
    v_dot2c_f32_bf16 v17, v76, v76
    v_dot2c_f32_bf16 v16, v77, v18
    v_dot2c_f32_bf16 v17, v77, v77
    v_dot2c_f32_bf16 v16, v78, v18
    v_dot2c_f32_bf16 v17, v78, v78
    v_dot2c_f32_bf16 v16, v79, v18
    v_dot2c_f32_bf16 v17, v79, v79
    v_and_b32 v19, 7, v222
    v_lshlrev_b32 v19, 5, v19
    s_nop 1
    v_add_f32_dpp v16, v16, v16 quad_perm:[1,0,3,2] row_mask:0xf bank_mask:0xf
    v_add_f32_dpp v17, v17, v17 quad_perm:[1,0,3,2] row_mask:0xf bank_mask:0xf
    s_nop 0
    v_add_f32_dpp v16, v16, v16 quad_perm:[2,3,0,1] row_mask:0xf bank_mask:0xf
    v_add_f32_dpp v17, v17, v17 quad_perm:[2,3,0,1] row_mask:0xf bank_mask:0xf
    s_nop 0
    v_add_f32_dpp v16, v16, v16 row_half_mirror row_mask:0xf bank_mask:0xf
    v_add_f32_dpp v17, v17, v17 row_half_mirror row_mask:0xf bank_mask:0xf
    ds_bpermute_b32 v16, v19, v16
    ds_bpermute_b32 v17, v19, v17
    s_waitcnt vmcnt(6)
    ds_read_b128 a[0:3], v174 offset:0
    ds_read_b128 a[4:7], v175 offset:0
    ds_read_b128 a[8:11], v176 offset:0
    ds_read_b128 a[12:15], v177 offset:0
    ds_read_b128 a[16:19], v174 offset:4096
    ds_read_b128 a[20:23], v175 offset:4096
    ds_read_b128 a[24:27], v176 offset:4096
    ds_read_b128 a[28:31], v177 offset:4096
    s_waitcnt lgkmcnt(8)
    s_mov_b32 exec_lo, 0x01000000
    s_mov_b32 exec_hi, 0x01000000
    v_accvgpr_write_b32 a128, v18
    v_accvgpr_write_b32 a129, v18
    v_accvgpr_write_b32 a130, v18
    v_accvgpr_write_b32 a131, v18
    v_accvgpr_write_b32 a132, v18
    v_accvgpr_write_b32 a133, v18
    v_accvgpr_write_b32 a134, v18
    v_accvgpr_write_b32 a135, v18
    v_accvgpr_write_b32 a136, v18
    v_accvgpr_write_b32 a137, v18
    v_accvgpr_write_b32 a138, v18
    v_accvgpr_write_b32 a139, v18
    v_accvgpr_write_b32 a140, v18
    v_accvgpr_write_b32 a141, v18
    v_accvgpr_write_b32 a142, v18
    v_accvgpr_write_b32 a143, v18
    v_accvgpr_write_b32 a144, v18
    v_accvgpr_write_b32 a145, v18
    v_accvgpr_write_b32 a146, v18
    v_accvgpr_write_b32 a147, v18
    v_accvgpr_write_b32 a148, v18
    v_accvgpr_write_b32 a149, v18
    v_accvgpr_write_b32 a150, v18
    v_accvgpr_write_b32 a151, v18
    v_accvgpr_write_b32 a152, v18
    v_accvgpr_write_b32 a153, v18
    v_accvgpr_write_b32 a154, v18
    v_accvgpr_write_b32 a155, v18
    v_accvgpr_write_b32 a156, v18
    v_accvgpr_write_b32 a157, v18
    v_accvgpr_write_b32 a158, v18
    v_accvgpr_write_b32 a159, v18
    s_mov_b64 exec, -1
    v_mul_f32 v92, 0x3b000000, v16
    v_mul_f32 v17, 0x3b000000, v17
    v_fma_f32 v17, -v92, v92, v17
    v_max_f32 v17, 0, v17
    v_add_f32 v17, 0x3727c5ac, v17
    v_rsq_f32 v93, v17
    s_waitcnt lgkmcnt(0)
    s_barrier
    ds_read_b64_tr_b16 v[96:97], v80 offset:32768
    ds_read_b64_tr_b16 v[98:99], v80 offset:33024
    ds_read_b64_tr_b16 v[100:101], v81 offset:0
    ds_read_b64_tr_b16 v[102:103], v81 offset:256
    ds_read_b64_tr_b16 v[104:105], v80 offset:0
    ds_read_b64_tr_b16 v[106:107], v80 offset:256
    ds_read_b64_tr_b16 v[108:109], v80 offset:33792
    ds_read_b64_tr_b16 v[110:111], v80 offset:34048
    ds_read_b64_tr_b16 v[112:113], v81 offset:1024
    ds_read_b64_tr_b16 v[114:115], v81 offset:1280
    s_waitcnt lgkmcnt(4)
    v_mfma_f32_32x32x16_bf16 v[16:31], v[96:99], a[0:3], 0
    ds_read_b64_tr_b16 v[116:117], v80 offset:1024
    ds_read_b64_tr_b16 v[118:119], v80 offset:1280
    s_add_u32 m0, s82, 106496
    s_add_u32 s95, s78, 256
    buffer_load_dwordx4 v172, s[4:7], s95 offen lds
    v_mfma_f32_32x32x16_bf16 v[32:47], v[100:103], a[0:3], 0
    ds_read_b64_tr_b16 v[96:97], v80 offset:34816
    ds_read_b64_tr_b16 v[98:99], v80 offset:35072
    s_add_u32 m0, s82, 107520
    s_add_u32 s95, s78, 16640
    buffer_load_dwordx4 v173, s[4:7], s95 offen lds
    v_readfirstlane_b32 s50, v150
    v_mfma_f32_32x32x16_bf16 v[0:15], v[104:107], a[0:3], 0
    ds_read_b64_tr_b16 v[100:101], v81 offset:2048
    ds_read_b64_tr_b16 v[102:103], v81 offset:2304
    s_add_u32 m0, s82, 108544
    s_add_u32 s95, s78, 33024
    buffer_load_dwordx4 v172, s[4:7], s95 offen lds
    v_readfirstlane_b32 s51, v151
    s_waitcnt lgkmcnt(4)
    v_mfma_f32_32x32x16_bf16 v[16:31], v[108:111], a[4:7], v[16:31]
    ds_read_b64_tr_b16 v[104:105], v80 offset:2048
    ds_read_b64_tr_b16 v[106:107], v80 offset:2304
    s_add_u32 m0, s82, 109568
    s_add_u32 s95, s78, 49408
    buffer_load_dwordx4 v173, s[4:7], s95 offen lds
    v_mfma_f32_32x32x16_bf16 v[32:47], v[112:115], a[4:7], v[32:47]
    ds_read_b64_tr_b16 v[108:109], v80 offset:35840
    ds_read_b64_tr_b16 v[110:111], v80 offset:36096
    s_add_u32 m0, s82, 110592
    s_add_u32 s95, s78, 384
    buffer_load_dwordx4 v172, s[4:7], s95 offen lds
    s_getreg_b32 s92, hwreg(HW_REG_XCC_ID, 0, 4)
    v_mfma_f32_32x32x16_bf16 v[0:15], v[116:119], a[4:7], v[0:15]
    ds_read_b64_tr_b16 v[112:113], v81 offset:3072
    ds_read_b64_tr_b16 v[114:115], v81 offset:3328
    s_add_u32 m0, s82, 111616
    s_add_u32 s95, s78, 16768
    buffer_load_dwordx4 v173, s[4:7], s95 offen lds
    s_add_u32 s52, s92, 40
    s_waitcnt lgkmcnt(4)
    v_mfma_f32_32x32x16_bf16 v[16:31], v[96:99], a[8:11], v[16:31]
    ds_read_b64_tr_b16 v[116:117], v80 offset:3072
    ds_read_b64_tr_b16 v[118:119], v80 offset:3328
    s_add_u32 m0, s82, 112640
    s_add_u32 s95, s78, 33152
    buffer_load_dwordx4 v172, s[4:7], s95 offen lds
    v_mfma_f32_32x32x16_bf16 v[32:47], v[100:103], a[8:11], v[32:47]
    ds_read_b64_tr_b16 v[96:97], v83 offset:32768
    ds_read_b64_tr_b16 v[98:99], v83 offset:33024
    s_add_u32 m0, s82, 113664
    s_add_u32 s95, s78, 49536
    buffer_load_dwordx4 v173, s[4:7], s95 offen lds
    s_add_u32 s92, s52, s50
    v_mfma_f32_32x32x16_bf16 v[0:15], v[104:107], a[8:11], v[0:15]
    ds_read_b64_tr_b16 v[100:101], v84 offset:0
    ds_read_b64_tr_b16 v[102:103], v84 offset:256
    s_add_u32 m0, s75, 49152
    s_add_u32 s95, s74, 787456
    buffer_load_dwordx4 v182, s[8:11], s95 offen lds
    v_mov_b32 v148, s92
    s_waitcnt lgkmcnt(4)
    v_mfma_f32_32x32x16_bf16 v[16:31], v[108:111], a[12:15], v[16:31]
    ds_read_b64_tr_b16 v[104:105], v83 offset:0
    ds_read_b64_tr_b16 v[106:107], v83 offset:256
    s_lshl_b32 s93, s45, 7
    s_add_u32 s93, s93, 1771520
    v_and_b32 v149, 31, v222
    v_lshlrev_b32 v149, 2, v149
    s_cmp_eq_u32 s44, 0
    s_cselect_b32 s93, s93, 2130706432
    v_mfma_f32_32x32x16_bf16 v[32:47], v[112:115], a[12:15], v[32:47]
    ds_read_b64_tr_b16 v[108:109], v80 offset:36864
    ds_read_b64_tr_b16 v[110:111], v80 offset:37120
    s_add_u32 m0, s75, 50176
    s_add_u32 s95, s74, 836608
    buffer_load_dwordx4 v182, s[8:11], s95 offen lds
    v_add_u32 v149, s93, v149
    v_mfma_f32_32x32x16_bf16 v[0:15], v[116:119], a[12:15], v[0:15]
    ds_read_b64_tr_b16 v[112:113], v81 offset:4096
    ds_read_b64_tr_b16 v[114:115], v81 offset:4352
    s_and_b32 s92, s44, 1
    s_lshl_b32 s93, s92, 10
    s_add_u32 s93, s93, 90112
    v_lshlrev_b32 v144, 2, v222
    v_add_u32 v144, s93, v144
    ds_read2st64_b32 v[140:141], v144 offset0:0 offset1:1
    ds_read2st64_b32 v[142:143], v144 offset0:2 offset1:3
    s_lshl_b32 s92, s92, 8
    s_lshl_b32 s93, s47, 9
    s_waitcnt lgkmcnt(6)
    v_mfma_f32_32x32x16_bf16 v[48:63], v[96:99], a[128:131], 0
    ds_read_b64_tr_b16 v[116:117], v80 offset:4096
    ds_read_b64_tr_b16 v[118:119], v80 offset:4352
    s_add_u32 m0, s75, 81920
    s_add_u32 s95, s74, 788480
    buffer_load_dwordx4 v182, s[8:11], s95 offen lds
    v_mfma_f32_32x32x16_bf16 v[64:79], v[100:103], a[128:131], 0
    ds_read_b64_tr_b16 v[96:97], v80 offset:37888
    ds_read_b64_tr_b16 v[98:99], v80 offset:38144
    s_add_u32 s92, s92, s93
    s_lshl_b32 s93, s46, 10
    s_add_u32 s92, s92, s93
    s_add_u32 s94, s92, 1572864
    v_and_b32 v144, 31, v222
    v_lshrrev_b32 v145, 5, v222
    v_lshlrev_b32 v144, 3, v144
    v_lshl_add_u32 v144, v145, 2, v144
    v_mfma_f32_32x32x16_bf16 v[124:139], v[104:107], a[128:131], 0
    ds_read_b64_tr_b16 v[100:101], v81 offset:5120
    ds_read_b64_tr_b16 v[102:103], v81 offset:5376
    s_add_u32 m0, s75, 82944
    s_add_u32 s95, s74, 837632
    buffer_load_dwordx4 v182, s[8:11], s95 offen lds
    s_add_u32 s92, s50, 1
    s_waitcnt lgkmcnt(4)
    v_mfma_f32_32x32x16_bf16 v[16:31], v[108:111], a[16:19], v[16:31]
    ds_read_b64_tr_b16 v[104:105], v80 offset:5120
    ds_read_b64_tr_b16 v[106:107], v80 offset:5376
    v_mov_b32 v145, s92
    v_add_f32 v140, v140, v141
    v_add_f32 v142, v142, v143
    v_add_f32 v140, v140, v142
    buffer_store_dword v140, v144, s[28:31], s94 offen sc1
    v_mfma_f32_32x32x16_bf16 v[32:47], v[112:115], a[16:19], v[32:47]
    ds_read_b64_tr_b16 v[108:109], v80 offset:38912
    ds_read_b64_tr_b16 v[110:111], v80 offset:39168
    s_add_u32 m0, s75, 16384
    s_add_u32 s95, s74, 786432
    buffer_load_dwordx4 v182, s[8:11], s95 offen lds
    v_mfma_f32_32x32x16_bf16 v[0:15], v[116:119], a[16:19], v[0:15]
    ds_read_b64_tr_b16 v[112:113], v81 offset:6144
    ds_read_b64_tr_b16 v[114:115], v81 offset:6400
    s_waitcnt lgkmcnt(4)
    v_mfma_f32_32x32x16_bf16 v[16:31], v[96:99], a[20:23], v[16:31]
    ds_read_b64_tr_b16 v[116:117], v80 offset:6144
    ds_read_b64_tr_b16 v[118:119], v80 offset:6400
    s_add_u32 m0, s75, 17408
    s_add_u32 s95, s74, 835584
    buffer_load_dwordx4 v182, s[8:11], s95 offen lds
    v_mfma_f32_32x32x16_bf16 v[32:47], v[100:103], a[20:23], v[32:47]
    ds_read_b64_tr_b16 v[96:97], v80 offset:39936
    ds_read_b64_tr_b16 v[98:99], v80 offset:40192
    s_waitcnt vmcnt(7)
    ds_read_b128 a[32:35], v174 offset:8192
    ds_read_b128 a[36:39], v175 offset:8192
    ds_read_b128 a[40:43], v176 offset:8192
    ds_read_b128 a[44:47], v177 offset:8192
    ds_read_b128 a[48:51], v174 offset:12288
    ds_read_b128 a[52:55], v175 offset:12288
    v_mfma_f32_32x32x16_bf16 v[0:15], v[104:107], a[20:23], v[0:15]
    ds_read_b64_tr_b16 v[100:101], v81 offset:7168
    ds_read_b64_tr_b16 v[102:103], v81 offset:7424
    s_add_u32 m0, s82, 98304
    s_add_u32 s95, s78, 512
    buffer_load_dwordx4 v172, s[4:7], s95 offen lds
    s_waitcnt lgkmcnt(10)
    v_mfma_f32_32x32x16_bf16 v[16:31], v[108:111], a[24:27], v[16:31]
    ds_read_b64_tr_b16 v[104:105], v80 offset:7168
    ds_read_b64_tr_b16 v[106:107], v80 offset:7424
    s_add_u32 m0, s82, 99328
    s_add_u32 s95, s78, 16896
    buffer_load_dwordx4 v173, s[4:7], s95 offen lds
    v_mfma_f32_32x32x16_bf16 v[32:47], v[112:115], a[24:27], v[32:47]
    ds_read_b64_tr_b16 v[108:109], v83 offset:36864
    ds_read_b64_tr_b16 v[110:111], v83 offset:37120
    s_add_u32 m0, s82, 100352
    s_add_u32 s95, s78, 33280
    buffer_load_dwordx4 v172, s[4:7], s95 offen lds
    ds_read_b128 a[56:59], v176 offset:12288
    v_mfma_f32_32x32x16_bf16 v[0:15], v[116:119], a[24:27], v[0:15]
    ds_read_b64_tr_b16 v[112:113], v84 offset:4096
    ds_read_b64_tr_b16 v[114:115], v84 offset:4352
    s_add_u32 m0, s82, 101376
    s_add_u32 s95, s78, 49664
    buffer_load_dwordx4 v173, s[4:7], s95 offen lds
    ds_read_b128 a[60:63], v177 offset:12288
    s_waitcnt lgkmcnt(6)
    v_mfma_f32_32x32x16_bf16 v[16:31], v[96:99], a[28:31], v[16:31]
    ds_read_b64_tr_b16 v[116:117], v83 offset:4096
    ds_read_b64_tr_b16 v[118:119], v83 offset:4352
    s_add_u32 m0, s82, 102400
    s_add_u32 s95, s78, 640
    buffer_load_dwordx4 v172, s[4:7], s95 offen lds
    s_waitcnt lgkmcnt(2)
    s_barrier
    v_mfma_f32_32x32x16_bf16 v[32:47], v[100:103], a[28:31], v[32:47]
    ds_read_b64_tr_b16 v[96:97], v80 offset:40960
    ds_read_b64_tr_b16 v[98:99], v80 offset:41216
    s_add_u32 m0, s82, 103424
    s_add_u32 s95, s78, 17024
    buffer_load_dwordx4 v173, s[4:7], s95 offen lds
    v_mfma_f32_32x32x16_bf16 v[0:15], v[104:107], a[28:31], v[0:15]
    ds_read_b64_tr_b16 v[100:101], v81 offset:8192
    ds_read_b64_tr_b16 v[102:103], v81 offset:8448
    s_waitcnt lgkmcnt(4)
    v_mfma_f32_32x32x16_bf16 v[48:63], v[108:111], a[132:135], v[48:63]
    ds_read_b64_tr_b16 v[104:105], v80 offset:8192
    ds_read_b64_tr_b16 v[106:107], v80 offset:8448
    s_add_u32 m0, s82, 104448
    s_add_u32 s95, s78, 33408
    buffer_load_dwordx4 v172, s[4:7], s95 offen lds
    v_mfma_f32_32x32x16_bf16 v[64:79], v[112:115], a[132:135], v[64:79]
    ds_read_b64_tr_b16 v[108:109], v80 offset:41984
    ds_read_b64_tr_b16 v[110:111], v80 offset:42240
    s_add_u32 m0, s82, 105472
    s_add_u32 s95, s78, 49792
    buffer_load_dwordx4 v173, s[4:7], s95 offen lds
    v_mfma_f32_32x32x16_bf16 v[124:139], v[116:119], a[132:135], v[124:139]
    ds_read_b64_tr_b16 v[112:113], v81 offset:9216
    ds_read_b64_tr_b16 v[114:115], v81 offset:9472
    s_add_u32 m0, s75, 57344
    s_add_u32 s95, s74, 1180672
    buffer_load_dwordx4 v182, s[8:11], s95 offen lds
    s_waitcnt lgkmcnt(4)
    v_mfma_f32_32x32x16_bf16 v[16:31], v[96:99], a[32:35], v[16:31]
    ds_read_b64_tr_b16 v[116:117], v80 offset:9216
    ds_read_b64_tr_b16 v[118:119], v80 offset:9472
    v_mfma_f32_32x32x16_bf16 v[32:47], v[100:103], a[32:35], v[32:47]
    ds_read_b64_tr_b16 v[96:97], v80 offset:43008
    ds_read_b64_tr_b16 v[98:99], v80 offset:43264
    s_add_u32 m0, s75, 58368
    s_add_u32 s95, s74, 1229824
    buffer_load_dwordx4 v182, s[8:11], s95 offen lds
    v_mfma_f32_32x32x16_bf16 v[0:15], v[104:107], a[32:35], v[0:15]
    ds_read_b64_tr_b16 v[100:101], v81 offset:10240
    ds_read_b64_tr_b16 v[102:103], v81 offset:10496
    s_waitcnt lgkmcnt(4)
    v_mfma_f32_32x32x16_bf16 v[16:31], v[108:111], a[36:39], v[16:31]
    ds_read_b64_tr_b16 v[104:105], v80 offset:10240
    ds_read_b64_tr_b16 v[106:107], v80 offset:10496
    s_add_u32 m0, s75, 90112
    s_add_u32 s95, s74, 1181696
    buffer_load_dwordx4 v182, s[8:11], s95 offen lds
    v_mfma_f32_32x32x16_bf16 v[32:47], v[112:115], a[36:39], v[32:47]
    ds_read_b64_tr_b16 v[108:109], v80 offset:44032
    ds_read_b64_tr_b16 v[110:111], v80 offset:44288
    v_mfma_f32_32x32x16_bf16 v[0:15], v[116:119], a[36:39], v[0:15]
    ds_read_b64_tr_b16 v[112:113], v81 offset:11264
    ds_read_b64_tr_b16 v[114:115], v81 offset:11520
    s_add_u32 m0, s75, 91136
    s_add_u32 s95, s74, 1230848
    buffer_load_dwordx4 v182, s[8:11], s95 offen lds
    s_waitcnt lgkmcnt(4)
    v_mfma_f32_32x32x16_bf16 v[16:31], v[96:99], a[40:43], v[16:31]
    ds_read_b64_tr_b16 v[116:117], v80 offset:11264
    ds_read_b64_tr_b16 v[118:119], v80 offset:11520
    s_waitcnt vmcnt(14)
    s_barrier
    buffer_store_dword v148, v149, s[28:31], 0 offen sc1
    v_mfma_f32_32x32x16_bf16 v[32:47], v[100:103], a[40:43], v[32:47]
    ds_read_b64_tr_b16 v[96:97], v83 offset:40960
    ds_read_b64_tr_b16 v[98:99], v83 offset:41216
    s_add_u32 m0, s75, 24576
    s_add_u32 s95, s74, 1179648
    buffer_load_dwordx4 v182, s[8:11], s95 offen lds
    v_mfma_f32_32x32x16_bf16 v[0:15], v[104:107], a[40:43], v[0:15]
    ds_read_b64_tr_b16 v[100:101], v84 offset:8192
    ds_read_b64_tr_b16 v[102:103], v84 offset:8448
    s_waitcnt lgkmcnt(4)
    v_mfma_f32_32x32x16_bf16 v[16:31], v[108:111], a[44:47], v[16:31]
    ds_read_b64_tr_b16 v[104:105], v83 offset:8192
    ds_read_b64_tr_b16 v[106:107], v83 offset:8448
    s_add_u32 m0, s75, 25600
    s_add_u32 s95, s74, 1228800
    buffer_load_dwordx4 v182, s[8:11], s95 offen lds
    v_mfma_f32_32x32x16_bf16 v[32:47], v[112:115], a[44:47], v[32:47]
    ds_read_b64_tr_b16 v[108:109], v80 offset:45056
    ds_read_b64_tr_b16 v[110:111], v80 offset:45312
    v_mfma_f32_32x32x16_bf16 v[0:15], v[116:119], a[44:47], v[0:15]
    ds_read_b64_tr_b16 v[112:113], v81 offset:12288
    ds_read_b64_tr_b16 v[114:115], v81 offset:12544
    s_add_u32 m0, s82, 106496
    s_add_u32 s95, s78, 768
    buffer_load_dwordx4 v172, s[4:7], s95 offen lds
    s_waitcnt lgkmcnt(4)
    v_mfma_f32_32x32x16_bf16 v[48:63], v[96:99], a[136:139], v[48:63]
    ds_read_b64_tr_b16 v[116:117], v80 offset:12288
    ds_read_b64_tr_b16 v[118:119], v80 offset:12544
    s_add_u32 m0, s82, 107520
    s_add_u32 s95, s78, 17152
    buffer_load_dwordx4 v173, s[4:7], s95 offen lds
    v_mfma_f32_32x32x16_bf16 v[64:79], v[100:103], a[136:139], v[64:79]
    ds_read_b64_tr_b16 v[96:97], v80 offset:46080
    ds_read_b64_tr_b16 v[98:99], v80 offset:46336
    s_add_u32 m0, s82, 108544
    s_add_u32 s95, s78, 33536
    buffer_load_dwordx4 v172, s[4:7], s95 offen lds
    v_mfma_f32_32x32x16_bf16 v[124:139], v[104:107], a[136:139], v[124:139]
    ds_read_b64_tr_b16 v[100:101], v81 offset:13312
    ds_read_b64_tr_b16 v[102:103], v81 offset:13568
    s_add_u32 m0, s82, 109568
    s_add_u32 s95, s78, 49920
    buffer_load_dwordx4 v173, s[4:7], s95 offen lds
    s_waitcnt lgkmcnt(4)
    v_mfma_f32_32x32x16_bf16 v[16:31], v[108:111], a[48:51], v[16:31]
    ds_read_b64_tr_b16 v[104:105], v80 offset:13312
    ds_read_b64_tr_b16 v[106:107], v80 offset:13568
    s_add_u32 m0, s82, 110592
    s_add_u32 s95, s78, 896
    buffer_load_dwordx4 v172, s[4:7], s95 offen lds
    v_mfma_f32_32x32x16_bf16 v[32:47], v[112:115], a[48:51], v[32:47]
    ds_read_b64_tr_b16 v[108:109], v80 offset:47104
    ds_read_b64_tr_b16 v[110:111], v80 offset:47360
    v_mfma_f32_32x32x16_bf16 v[0:15], v[116:119], a[48:51], v[0:15]
    ds_read_b64_tr_b16 v[112:113], v81 offset:14336
    ds_read_b64_tr_b16 v[114:115], v81 offset:14592
    s_add_u32 m0, s82, 111616
    s_add_u32 s95, s78, 17280
    buffer_load_dwordx4 v173, s[4:7], s95 offen lds
    s_waitcnt lgkmcnt(4)
    v_mfma_f32_32x32x16_bf16 v[16:31], v[96:99], a[52:55], v[16:31]
    ds_read_b64_tr_b16 v[116:117], v80 offset:14336
    ds_read_b64_tr_b16 v[118:119], v80 offset:14592
    s_add_u32 m0, s82, 112640
    s_add_u32 s95, s78, 33664
    buffer_load_dwordx4 v172, s[4:7], s95 offen lds
    v_mfma_f32_32x32x16_bf16 v[32:47], v[100:103], a[52:55], v[32:47]
    ds_read_b64_tr_b16 v[96:97], v80 offset:48128
    ds_read_b64_tr_b16 v[98:99], v80 offset:48384
    s_add_u32 m0, s82, 113664
    s_add_u32 s95, s78, 50048
    buffer_load_dwordx4 v173, s[4:7], s95 offen lds
    v_mfma_f32_32x32x16_bf16 v[0:15], v[104:107], a[52:55], v[0:15]
    ds_read_b64_tr_b16 v[100:101], v81 offset:15360
    ds_read_b64_tr_b16 v[102:103], v81 offset:15616
    s_waitcnt vmcnt(15)
    ds_read_b128 a[64:67], v174 offset:0
    ds_read_b128 a[68:71], v175 offset:0
    s_waitcnt lgkmcnt(6)
    v_mfma_f32_32x32x16_bf16 v[16:31], v[108:111], a[56:59], v[16:31]
    ds_read_b64_tr_b16 v[104:105], v80 offset:15360
    ds_read_b64_tr_b16 v[106:107], v80 offset:15616
    ds_read_b128 a[72:75], v176 offset:0
    v_mfma_f32_32x32x16_bf16 v[32:47], v[112:115], a[56:59], v[32:47]
    ds_read_b64_tr_b16 v[108:109], v83 offset:45056
    ds_read_b64_tr_b16 v[110:111], v83 offset:45312
    ds_read_b128 a[76:79], v177 offset:0
    ds_read_b128 a[80:83], v174 offset:4096
    ds_read_b128 a[84:87], v175 offset:4096
    v_mfma_f32_32x32x16_bf16 v[0:15], v[116:119], a[56:59], v[0:15]
    ds_read_b64_tr_b16 v[112:113], v84 offset:12288
    ds_read_b64_tr_b16 v[114:115], v84 offset:12544
    ds_read_b128 a[88:91], v176 offset:4096
    ds_read_b128 a[92:95], v177 offset:4096
    s_waitcnt lgkmcnt(10)
    v_mfma_f32_32x32x16_bf16 v[16:31], v[96:99], a[60:63], v[16:31]
    ds_read_b64_tr_b16 v[116:117], v83 offset:12288
    ds_read_b64_tr_b16 v[118:119], v83 offset:12544
    s_barrier
    v_mfma_f32_32x32x16_bf16 v[32:47], v[100:103], a[60:63], v[32:47]
    ds_read_b64_tr_b16 v[96:97], v80 offset:49152
    ds_read_b64_tr_b16 v[98:99], v80 offset:49408
    v_mfma_f32_32x32x16_bf16 v[0:15], v[104:107], a[60:63], v[0:15]
    ds_read_b64_tr_b16 v[100:101], v81 offset:16384
    ds_read_b64_tr_b16 v[102:103], v81 offset:16640
    s_waitcnt lgkmcnt(4)
    v_mfma_f32_32x32x16_bf16 v[48:63], v[108:111], a[140:143], v[48:63]
    ds_read_b64_tr_b16 v[104:105], v80 offset:16384
    ds_read_b64_tr_b16 v[106:107], v80 offset:16640
    v_mfma_f32_32x32x16_bf16 v[64:79], v[112:115], a[140:143], v[64:79]
    ds_read_b64_tr_b16 v[108:109], v80 offset:50176
    ds_read_b64_tr_b16 v[110:111], v80 offset:50432
    v_mfma_f32_32x32x16_bf16 v[124:139], v[116:119], a[140:143], v[124:139]
    ds_read_b64_tr_b16 v[112:113], v81 offset:17408
    ds_read_b64_tr_b16 v[114:115], v81 offset:17664
    s_waitcnt lgkmcnt(4)
    v_mfma_f32_32x32x16_bf16 v[16:31], v[96:99], a[64:67], v[16:31]
    ds_read_b64_tr_b16 v[116:117], v80 offset:17408
    ds_read_b64_tr_b16 v[118:119], v80 offset:17664
    v_mfma_f32_32x32x16_bf16 v[32:47], v[100:103], a[64:67], v[32:47]
    ds_read_b64_tr_b16 v[96:97], v80 offset:51200
    ds_read_b64_tr_b16 v[98:99], v80 offset:51456
    v_mfma_f32_32x32x16_bf16 v[0:15], v[104:107], a[64:67], v[0:15]
    ds_read_b64_tr_b16 v[100:101], v81 offset:18432
    ds_read_b64_tr_b16 v[102:103], v81 offset:18688
    s_waitcnt lgkmcnt(4)
    v_mfma_f32_32x32x16_bf16 v[16:31], v[108:111], a[68:71], v[16:31]
    ds_read_b64_tr_b16 v[104:105], v80 offset:18432
    ds_read_b64_tr_b16 v[106:107], v80 offset:18688
    v_mfma_f32_32x32x16_bf16 v[32:47], v[112:115], a[68:71], v[32:47]
    ds_read_b64_tr_b16 v[108:109], v80 offset:52224
    ds_read_b64_tr_b16 v[110:111], v80 offset:52480
    v_mfma_f32_32x32x16_bf16 v[0:15], v[116:119], a[68:71], v[0:15]
    ds_read_b64_tr_b16 v[112:113], v81 offset:19456
    ds_read_b64_tr_b16 v[114:115], v81 offset:19712
    s_waitcnt lgkmcnt(4)
    v_mfma_f32_32x32x16_bf16 v[16:31], v[96:99], a[72:75], v[16:31]
    ds_read_b64_tr_b16 v[116:117], v80 offset:19456
    ds_read_b64_tr_b16 v[118:119], v80 offset:19712
    s_waitcnt vmcnt(0)
    buffer_load_dword v199, v87, s[28:31], 0 offen sc1
    v_mfma_f32_32x32x16_bf16 v[32:47], v[100:103], a[72:75], v[32:47]
    ds_read_b64_tr_b16 v[96:97], v83 offset:49152
    ds_read_b64_tr_b16 v[98:99], v83 offset:49408
    ds_read_b128 a[96:99], v174 offset:8192
    ds_read_b128 a[100:103], v175 offset:8192
    v_mfma_f32_32x32x16_bf16 v[0:15], v[104:107], a[72:75], v[0:15]
    ds_read_b64_tr_b16 v[100:101], v84 offset:16384
    ds_read_b64_tr_b16 v[102:103], v84 offset:16640
    ds_read_b128 a[104:107], v176 offset:8192
    ds_read_b128 a[108:111], v177 offset:8192
    s_waitcnt lgkmcnt(8)
    v_mfma_f32_32x32x16_bf16 v[16:31], v[108:111], a[76:79], v[16:31]
    ds_read_b64_tr_b16 v[104:105], v83 offset:16384
    ds_read_b64_tr_b16 v[106:107], v83 offset:16640
    ds_read_b128 a[112:115], v174 offset:12288
    v_mfma_f32_32x32x16_bf16 v[32:47], v[112:115], a[76:79], v[32:47]
    ds_read_b64_tr_b16 v[108:109], v83 offset:53248
    ds_read_b64_tr_b16 v[110:111], v83 offset:53504
    ds_read_b128 a[116:119], v175 offset:12288
    v_mfma_f32_32x32x16_bf16 v[0:15], v[116:119], a[76:79], v[0:15]
    ds_read_b64_tr_b16 v[112:113], v84 offset:20480
    ds_read_b64_tr_b16 v[114:115], v84 offset:20736
    ds_read_b128 a[120:123], v176 offset:12288
    ds_read_b128 a[124:127], v177 offset:12288
    s_waitcnt lgkmcnt(8)
    v_mfma_f32_32x32x16_bf16 v[48:63], v[96:99], a[144:147], v[48:63]
    ds_read_b64_tr_b16 v[116:117], v83 offset:20480
    ds_read_b64_tr_b16 v[118:119], v83 offset:20736
    s_waitcnt lgkmcnt(2)
    s_barrier
    v_mfma_f32_32x32x16_bf16 v[64:79], v[100:103], a[144:147], v[64:79]
    ds_read_b64_tr_b16 v[96:97], v83 offset:57344
    ds_read_b64_tr_b16 v[98:99], v83 offset:57600
    v_mfma_f32_32x32x16_bf16 v[124:139], v[104:107], a[144:147], v[124:139]
    ds_read_b64_tr_b16 v[100:101], v84 offset:24576
    ds_read_b64_tr_b16 v[102:103], v84 offset:24832
    s_waitcnt lgkmcnt(4)
    v_mfma_f32_32x32x16_bf16 v[48:63], v[108:111], a[148:151], v[48:63]
    ds_read_b64_tr_b16 v[104:105], v83 offset:24576
    ds_read_b64_tr_b16 v[106:107], v83 offset:24832
    v_mfma_f32_32x32x16_bf16 v[64:79], v[112:115], a[148:151], v[64:79]
    ds_read_b64_tr_b16 v[108:109], v83 offset:61440
    ds_read_b64_tr_b16 v[110:111], v83 offset:61696
    v_mfma_f32_32x32x16_bf16 v[124:139], v[116:119], a[148:151], v[124:139]
    ds_read_b64_tr_b16 v[112:113], v84 offset:28672
    ds_read_b64_tr_b16 v[114:115], v84 offset:28928
    s_waitcnt lgkmcnt(4)
    v_mfma_f32_32x32x16_bf16 v[48:63], v[96:99], a[152:155], v[48:63]
    ds_read_b64_tr_b16 v[116:117], v83 offset:28672
    ds_read_b64_tr_b16 v[118:119], v83 offset:28928
    s_add_u32 s91, s50, 40
    s_waitcnt vmcnt(0)
    v_subrev_u32 v199, s91, v199
    v_cmp_gt_u32 vcc, 8, v199
    s_nop 0
    s_andn2_b64 s[96:97], s[60:61], vcc
    s_cbranch_scc1 L_slow_1
L_pback_2:
    v_mfma_f32_32x32x16_bf16 v[64:79], v[100:103], a[152:155], v[64:79]
    ds_read_b64_tr_b16 v[96:97], v80 offset:53248
    ds_read_b64_tr_b16 v[98:99], v80 offset:53504
    buffer_load_dwordx4 v[140:143], v85, s[28:31], s66 offen sc1
    buffer_load_dwordx4 v[144:147], v85, s[28:31], s67 offen sc1
    s_sub_u32 s52, s52, 40
    v_cmp_ne_u32 vcc, s52, v199
    s_nop 1
    s_cmp_eq_u64 vcc, 0
    s_cselect_b32 s52, 1, 0
    v_mfma_f32_32x32x16_bf16 v[124:139], v[104:107], a[152:155], v[124:139]
    ds_read_b64_tr_b16 v[100:101], v81 offset:20480
    ds_read_b64_tr_b16 v[102:103], v81 offset:20736
    s_lshl_b32 s78, s44, 17
    s_lshl_b32 s92, s44, 8
    s_add_u32 s92, s92, s2
    s_sub_u32 s93, s92, 256
    s_min_u32 s93, s93, 0x1000
    s_lshl_b32 s93, s93, 13
    v_lshlrev_b32 v197, 7, v222
    s_waitcnt lgkmcnt(4)
    v_mfma_f32_32x32x16_bf16 v[48:63], v[108:111], a[156:159], v[48:63]
    ds_read_b64_tr_b16 v[104:105], v80 offset:20480
    ds_read_b64_tr_b16 v[106:107], v80 offset:20736
    v_add_u32 v197, s93, v197
    buffer_load_dword v198, v197, s[12:15], 0 offen
    s_sub_u32 s93, s92, 320
    s_min_u32 s93, s93, 0x1000
    s_lshl_b32 s93, s93, 13
    v_mfma_f32_32x32x16_bf16 v[64:79], v[112:115], a[156:159], v[64:79]
    ds_read_b64_tr_b16 v[108:109], v80 offset:54272
    ds_read_b64_tr_b16 v[110:111], v80 offset:54528
    v_lshlrev_b32 v197, 7, v222
    v_add_u32 v197, s93, v197
    buffer_load_dword v198, v197, s[16:19], 0 offen
    s_sub_u32 s93, s92, 544
    s_min_u32 s93, s93, 0x1000
    s_lshl_b32 s93, s93, 13
    v_lshlrev_b32 v197, 7, v222
    v_mfma_f32_32x32x16_bf16 v[124:139], v[116:119], a[156:159], v[124:139]
    ds_read_b64_tr_b16 v[112:113], v81 offset:21504
    ds_read_b64_tr_b16 v[114:115], v81 offset:21760
    v_add_u32 v197, s93, v197
    buffer_load_dword v198, v197, s[20:23], 0 offen
    s_lshr_b32 s92, s2, 3
    s_mul_i32 s92, s92, 16384
    s_add_u32 s92, s92, 384
    s_cmp_eq_u32 s44, 0
    s_cselect_b32 s92, s92, 2130706432
    v_min_u32 v197, 15, v222
    s_waitcnt lgkmcnt(4)
    v_mfma_f32_32x32x16_bf16 v[16:31], v[96:99], a[80:83], v[16:31]
    ds_read_b64_tr_b16 v[116:117], v80 offset:21504
    ds_read_b64_tr_b16 v[118:119], v80 offset:21760
    v_mul_u32_u24 v197, 1024, v197
    v_add_u32 v197, s92, v197
    buffer_load_dword v198, v197, s[12:15], 0 offen
    s_lshr_b32 s92, s2, 3
    s_mul_i32 s92, s92, 57344
    v_mfma_f32_32x32x16_bf16 v[32:47], v[100:103], a[80:83], v[32:47]
    ds_read_b64_tr_b16 v[96:97], v80 offset:55296
    ds_read_b64_tr_b16 v[98:99], v80 offset:55552
    s_add_u32 s92, s92, 384
    s_cmp_eq_u32 s44, 3
    s_cselect_b32 s92, s92, 2130706432
    v_min_u32 v197, 55, v222
    v_mul_u32_u24 v197, 1024, v197
    v_add_u32 v197, s92, v197
    buffer_load_dword v198, v197, s[16:19], 0 offen
    v_mfma_f32_32x32x16_bf16 v[0:15], v[104:107], a[80:83], v[0:15]
    ds_read_b64_tr_b16 v[100:101], v81 offset:22528
    ds_read_b64_tr_b16 v[102:103], v81 offset:22784
    s_mul_i32 s92, s44, 3072
    s_add_u32 s92, s92, 148480
    v_add_u32 v94, s92, v223
    s_waitcnt lgkmcnt(4)
    v_mfma_f32_32x32x16_bf16 v[16:31], v[108:111], a[84:87], v[16:31]
    ds_read_b64_tr_b16 v[104:105], v80 offset:22528
    ds_read_b64_tr_b16 v[106:107], v80 offset:22784
    v_mov_b32_dpp v60, v56 row_shl:8 row_mask:0xa bank_mask:0x3
    v_mov_b32_dpp v52, v48 row_shl:8 row_mask:0xa bank_mask:0x3
    v_mfma_f32_32x32x16_bf16 v[32:47], v[112:115], a[84:87], v[32:47]
    ds_read_b64_tr_b16 v[108:109], v80 offset:56320
    ds_read_b64_tr_b16 v[110:111], v80 offset:56576
    v_mov_b32_dpp v61, v57 row_shl:8 row_mask:0xa bank_mask:0x3
    v_mov_b32_dpp v53, v49 row_shl:8 row_mask:0xa bank_mask:0x3
    v_mov_b32_dpp v62, v58 row_shl:8 row_mask:0xa bank_mask:0x3
    v_mfma_f32_32x32x16_bf16 v[0:15], v[116:119], a[84:87], v[0:15]
    ds_read_b64_tr_b16 v[112:113], v81 offset:23552
    ds_read_b64_tr_b16 v[114:115], v81 offset:23808
    v_mov_b32_dpp v54, v50 row_shl:8 row_mask:0xa bank_mask:0x3
    v_mov_b32_dpp v63, v59 row_shl:8 row_mask:0xa bank_mask:0x3
    v_mov_b32_dpp v55, v51 row_shl:8 row_mask:0xa bank_mask:0x3
    s_waitcnt lgkmcnt(4)
    v_mfma_f32_32x32x16_bf16 v[16:31], v[96:99], a[88:91], v[16:31]
    ds_read_b64_tr_b16 v[116:117], v80 offset:23552
    ds_read_b64_tr_b16 v[118:119], v80 offset:23808
    s_add_u32 m0, s83, 98304
    s_add_u32 s95, s78, 0
    buffer_load_dwordx4 v216, s[12:15], s95 offen lds
    v_mfma_f32_32x32x16_bf16 v[32:47], v[100:103], a[88:91], v[32:47]
    ds_read_b64_tr_b16 v[96:97], v80 offset:57344
    ds_read_b64_tr_b16 v[98:99], v80 offset:57600
    v_permlane16_swap_b32 v52, v60
    v_permlane16_swap_b32 v53, v61
    v_permlane16_swap_b32 v54, v62
    v_mfma_f32_32x32x16_bf16 v[0:15], v[104:107], a[88:91], v[0:15]
    ds_read_b64_tr_b16 v[100:101], v81 offset:24576
    ds_read_b64_tr_b16 v[102:103], v81 offset:24832
    v_permlane16_swap_b32 v55, v63
    ds_write_b128 v94, v[60:63] offset:0
    v_mov_b32_dpp v76, v72 row_shl:8 row_mask:0xa bank_mask:0x3
    s_waitcnt lgkmcnt(5)
    v_mfma_f32_32x32x16_bf16 v[16:31], v[108:111], a[92:95], v[16:31]
    ds_read_b64_tr_b16 v[104:105], v80 offset:24576
    ds_read_b64_tr_b16 v[106:107], v80 offset:24832
    s_add_u32 m0, s83, 99328
    s_add_u32 s95, s78, 8192
    buffer_load_dwordx4 v216, s[12:15], s95 offen lds
    v_mfma_f32_32x32x16_bf16 v[32:47], v[112:115], a[92:95], v[32:47]
    ds_read_b64_tr_b16 v[108:109], v80 offset:58368
    ds_read_b64_tr_b16 v[110:111], v80 offset:58624
    v_mov_b32_dpp v68, v64 row_shl:8 row_mask:0xa bank_mask:0x3
    v_mov_b32_dpp v77, v73 row_shl:8 row_mask:0xa bank_mask:0x3
    v_mov_b32_dpp v69, v65 row_shl:8 row_mask:0xa bank_mask:0x3
    v_mfma_f32_32x32x16_bf16 v[0:15], v[116:119], a[92:95], v[0:15]
    ds_read_b64_tr_b16 v[112:113], v81 offset:25600
    ds_read_b64_tr_b16 v[114:115], v81 offset:25856
    v_mov_b32_dpp v78, v74 row_shl:8 row_mask:0xa bank_mask:0x3
    v_mov_b32_dpp v70, v66 row_shl:8 row_mask:0xa bank_mask:0x3
    v_mov_b32_dpp v79, v75 row_shl:8 row_mask:0xa bank_mask:0x3
    s_waitcnt lgkmcnt(4)
    v_mfma_f32_32x32x16_bf16 v[16:31], v[96:99], a[96:99], v[16:31]
    ds_read_b64_tr_b16 v[116:117], v80 offset:25600
    ds_read_b64_tr_b16 v[118:119], v80 offset:25856
    v_mov_b32_dpp v71, v67 row_shl:8 row_mask:0xa bank_mask:0x3
    v_permlane16_swap_b32 v68, v76
    v_mfma_f32_32x32x16_bf16 v[32:47], v[100:103], a[96:99], v[32:47]
    ds_read_b64_tr_b16 v[96:97], v80 offset:59392
    ds_read_b64_tr_b16 v[98:99], v80 offset:59648
    s_add_u32 m0, s83, 100352
    s_add_u32 s95, s78, 16384
    buffer_load_dwordx4 v216, s[12:15], s95 offen lds
    v_mfma_f32_32x32x16_bf16 v[0:15], v[104:107], a[96:99], v[0:15]
    ds_read_b64_tr_b16 v[100:101], v81 offset:26624
    ds_read_b64_tr_b16 v[102:103], v81 offset:26880
    v_permlane16_swap_b32 v69, v77
    v_permlane16_swap_b32 v70, v78
    v_permlane16_swap_b32 v71, v79
    s_waitcnt lgkmcnt(4)
    v_mfma_f32_32x32x16_bf16 v[16:31], v[108:111], a[100:103], v[16:31]
    ds_read_b64_tr_b16 v[104:105], v80 offset:26624
    ds_read_b64_tr_b16 v[106:107], v80 offset:26880
    ds_write_b128 v94, v[76:79] offset:1024
    v_mov_b32_dpp v136, v132 row_shl:8 row_mask:0xa bank_mask:0x3
    v_mfma_f32_32x32x16_bf16 v[32:47], v[112:115], a[100:103], v[32:47]
    ds_read_b64_tr_b16 v[108:109], v80 offset:60416
    ds_read_b64_tr_b16 v[110:111], v80 offset:60672
    s_add_u32 m0, s83, 101376
    s_add_u32 s95, s78, 24576
    buffer_load_dwordx4 v216, s[12:15], s95 offen lds
    v_mfma_f32_32x32x16_bf16 v[0:15], v[116:119], a[100:103], v[0:15]
    ds_read_b64_tr_b16 v[112:113], v81 offset:27648
    ds_read_b64_tr_b16 v[114:115], v81 offset:27904
    v_mov_b32_dpp v128, v124 row_shl:8 row_mask:0xa bank_mask:0x3
    v_mov_b32_dpp v137, v133 row_shl:8 row_mask:0xa bank_mask:0x3
    v_mov_b32_dpp v129, v125 row_shl:8 row_mask:0xa bank_mask:0x3
    s_waitcnt lgkmcnt(5)
    v_mfma_f32_32x32x16_bf16 v[16:31], v[96:99], a[104:107], v[16:31]
    ds_read_b64_tr_b16 v[116:117], v80 offset:27648
    ds_read_b64_tr_b16 v[118:119], v80 offset:27904
    v_mov_b32_dpp v138, v134 row_shl:8 row_mask:0xa bank_mask:0x3
    v_mov_b32_dpp v130, v126 row_shl:8 row_mask:0xa bank_mask:0x3
    v_mfma_f32_32x32x16_bf16 v[32:47], v[100:103], a[104:107], v[32:47]
    ds_read_b64_tr_b16 v[96:97], v80 offset:61440
    ds_read_b64_tr_b16 v[98:99], v80 offset:61696
    v_mov_b32_dpp v139, v135 row_shl:8 row_mask:0xa bank_mask:0x3
    v_mov_b32_dpp v131, v127 row_shl:8 row_mask:0xa bank_mask:0x3
    v_permlane16_swap_b32 v128, v136
    v_mfma_f32_32x32x16_bf16 v[0:15], v[104:107], a[104:107], v[0:15]
    ds_read_b64_tr_b16 v[100:101], v81 offset:28672
    ds_read_b64_tr_b16 v[102:103], v81 offset:28928
    s_add_u32 m0, s83, 102400
    s_add_u32 s95, s78, 32768
    buffer_load_dwordx4 v216, s[12:15], s95 offen lds
    s_waitcnt lgkmcnt(4)
    v_mfma_f32_32x32x16_bf16 v[16:31], v[108:111], a[108:111], v[16:31]
    ds_read_b64_tr_b16 v[104:105], v80 offset:28672
    ds_read_b64_tr_b16 v[106:107], v80 offset:28928
    v_permlane16_swap_b32 v129, v137
    v_permlane16_swap_b32 v130, v138
    v_mfma_f32_32x32x16_bf16 v[32:47], v[112:115], a[108:111], v[32:47]
    ds_read_b64_tr_b16 v[108:109], v80 offset:62464
    ds_read_b64_tr_b16 v[110:111], v80 offset:62720
    v_permlane16_swap_b32 v131, v139
    ds_write_b128 v94, v[136:139] offset:2048
    s_waitcnt vmcnt(10)
    v_mfma_f32_32x32x16_bf16 v[0:15], v[116:119], a[108:111], v[0:15]
    ds_read_b64_tr_b16 v[112:113], v81 offset:29696
    ds_read_b64_tr_b16 v[114:115], v81 offset:29952
    s_add_u32 m0, s83, 103424
    s_add_u32 s95, s78, 40960
    buffer_load_dwordx4 v216, s[12:15], s95 offen lds
    s_waitcnt lgkmcnt(5)
    v_mfma_f32_32x32x16_bf16 v[16:31], v[96:99], a[112:115], v[16:31]
    ds_read_b64_tr_b16 v[116:117], v80 offset:29696
    ds_read_b64_tr_b16 v[118:119], v80 offset:29952
    v_add_f32 v140, v140, v144
    v_add_f32 v141, v141, v145
    v_mfma_f32_32x32x16_bf16 v[32:47], v[100:103], a[112:115], v[32:47]
    ds_read_b64_tr_b16 v[96:97], v80 offset:63488
    ds_read_b64_tr_b16 v[98:99], v80 offset:63744
    s_waitcnt lgkmcnt(6)
    s_barrier
    v_and_b32 v94, 7, v222
    v_mfma_f32_32x32x16_bf16 v[0:15], v[104:107], a[112:115], v[0:15]
    ds_read_b64_tr_b16 v[100:101], v81 offset:30720
    ds_read_b64_tr_b16 v[102:103], v81 offset:30976
    v_bfe_u32 v86, v222, 3, 1
    v_bfe_u32 v95, v222, 4, 2
    v_lshlrev_b32 v94, 4, v94
    s_waitcnt lgkmcnt(4)
    v_mfma_f32_32x32x16_bf16 v[16:31], v[108:111], a[116:119], v[16:31]
    ds_read_b64_tr_b16 v[104:105], v80 offset:30720
    ds_read_b64_tr_b16 v[106:107], v80 offset:30976
    s_add_u32 m0, s83, 104448
    s_add_u32 s95, s78, 49152
    buffer_load_dwordx4 v216, s[12:15], s95 offen lds
    v_mfma_f32_32x32x16_bf16 v[32:47], v[112:115], a[116:119], v[32:47]
    ds_read_b64_tr_b16 v[108:109], v80 offset:64512
    ds_read_b64_tr_b16 v[110:111], v80 offset:64768
    v_lshl_add_u32 v68, v86, 9, v94
    v_lshl_add_u32 v68, v95, 10, v68
    s_lshl_b32 s92, s44, 7
    v_mfma_f32_32x32x16_bf16 v[0:15], v[116:119], a[116:119], v[0:15]
    ds_read_b64_tr_b16 v[112:113], v81 offset:31744
    ds_read_b64_tr_b16 v[114:115], v81 offset:32000
    s_add_u32 s92, s92, 148480
    v_add_u32 v68, s92, v68
    ds_read_b128 v[48:51], v68 offset:0
    s_waitcnt lgkmcnt(5)
    v_mfma_f32_32x32x16_bf16 v[16:31], v[96:99], a[120:123], v[16:31]
    ds_read_b64_tr_b16 v[116:117], v80 offset:31744
    ds_read_b64_tr_b16 v[118:119], v80 offset:32000
    s_add_u32 m0, s83, 105472
    s_add_u32 s95, s78, 57344
    buffer_load_dwordx4 v216, s[12:15], s95 offen lds
    v_mfma_f32_32x32x16_bf16 v[32:47], v[100:103], a[120:123], v[32:47]
    ds_read_b128 v[52:55], v68 offset:3072
    ds_read_b128 v[56:59], v68 offset:6144
    ds_read_b128 v[60:63], v68 offset:9216
    v_lshlrev_b32 v69, 4, v86
    v_lshl_add_u32 v69, v95, 7, v69
    v_mfma_f32_32x32x16_bf16 v[0:15], v[104:107], a[120:123], v[0:15]
    s_lshl_b32 s92, s44, 5
    s_add_u32 s92, s92, 160768
    v_add_u32 v69, s92, v69
    v_mul_u32_u24 v95, 8704, v95
    v_mul_u32_u24 v86, 2176, v86
    s_waitcnt lgkmcnt(3)
    v_mfma_f32_32x32x16_bf16 v[16:31], v[108:111], a[124:127], v[16:31]
    v_add3_u32 v94, v94, v95, v86
    s_lshr_b32 s92, s44, 1
    s_mul_i32 s92, s92, 4352
    s_and_b32 s93, s44, 1
    v_mfma_f32_32x32x16_bf16 v[32:47], v[112:115], a[124:127], v[32:47]
    s_lshl_b32 s93, s93, 3
    s_add_u32 s92, s92, s93
    s_add_u32 s92, s92, 131072
    v_add_u32 v94, s92, v94
    s_waitcnt lgkmcnt(0)
    v_mfma_f32_32x32x16_bf16 v[0:15], v[116:119], a[124:127], v[0:15]
    v_add_f32 v48, v48, v52
    v_add_f32 v49, v49, v53
    v_add_f32 v50, v50, v54
    v_add_f32 v51, v51, v55
    v_add_f32 v48, v48, v56
    v_add_f32 v49, v49, v57
    v_add_f32 v50, v50, v58
    v_add_f32 v51, v51, v59
    v_add_f32 v48, v48, v60
    v_add_f32 v49, v49, v61
    v_add_f32 v50, v50, v62
    v_add_f32 v51, v51, v63
    s_mov_b32 exec_lo, 0x01010101
    s_mov_b32 exec_hi, 0x0101
    ds_write_b128 v69, v[48:51]
    s_mov_b64 exec, -1
    s_waitcnt lgkmcnt(0)
    s_barrier
    ds_read_b128 v[64:67], v69
    v_lshrrev_b32 v86, 5, v222
    v_lshlrev_b32 v86, 4, v86
    v_add_u32 v86, 160768, v86
    s_waitcnt lgkmcnt(0)
    v_fma_f32 v48, -v92, v64, v48
    v_fma_f32 v49, -v92, v65, v49
    v_fma_f32 v50, -v92, v66, v50
    v_fma_f32 v51, -v92, v67, v51
    v_mul_f32 v48, v48, v93
    v_mul_f32 v49, v49, v93
    v_mul_f32 v50, v50, v93
    v_mul_f32 v51, v51, v93
    v_cvt_pk_bf16_f32 v52, v48, v49
    v_cvt_pk_bf16_f32 v53, v50, v51
    s_mov_b32 exec_hi, 0
    ds_write_b64 v94, v[52:53]
    s_mov_b32 exec_hi, -1
    s_waitcnt lgkmcnt(0)
    ds_read_b128 v[48:51], v86 offset:0
    ds_read_b128 v[52:55], v86 offset:32
    ds_read_b128 v[56:59], v86 offset:64
    ds_read_b128 v[60:63], v86 offset:96
    ds_read_b128 v[64:67], v86 offset:128
    ds_read_b128 v[68:71], v86 offset:160
    ds_read_b128 v[72:75], v86 offset:192
    ds_read_b128 v[76:79], v86 offset:224
    ds_read_b128 v[200:203], v86 offset:256
    ds_read_b128 v[204:207], v86 offset:288
    ds_read_b128 v[208:211], v86 offset:320
    ds_read_b128 v[212:215], v86 offset:352
    v_add_f32 v142, v142, v146
    v_add_f32 v143, v143, v147
    v_lshrrev_b32 v85, 4, v222
    v_and_b32 v87, 1, v85
    v_permlane32_swap_b32 v140, v142
    v_permlane32_swap_b32 v141, v143
    v_lshlrev_b32 v87, 7, v87
    v_lshrrev_b32 v85, 1, v85
    v_add_f32 v140, v140, v142
    v_add_f32 v141, v141, v143
    v_lshl_add_u32 v87, v85, 2, v87
    v_and_b32 v85, 15, v222
    v_permlane16_swap_b32 v140, v141
    v_lshl_add_u32 v87, v85, 3, v87
    v_add_f32 v140, v140, v141
    v_add_u32 v87, s90, v87
    ds_write_b32 v87, v140
    v_and_b32 v85, 31, v222
    v_lshlrev_b32 v85, 2, v85
    v_add_u32 v87, s90, v85
    s_waitcnt lgkmcnt(0)
    ds_read2_b32 v[142:143], v87 offset0:0 offset1:32
    s_waitcnt lgkmcnt(0)
    v_mul_f32 v218, 0x3b000000, v142
    v_mul_f32 v143, 0x3b000000, v143
    v_fma_f32 v143, -v218, v218, v143
    v_max_f32 v143, 0, v143
    v_add_f32 v143, 0x3727c5ac, v143
    v_rsq_f32 v219, v143
    s_nop 0
    v_pk_fma_f32 v[16:17], v[48:49], v[218:219], v[16:17] op_sel_hi:[1,0,1] neg_lo:[0,1,0] neg_hi:[0,1,0]
    v_pk_fma_f32 v[18:19], v[50:51], v[218:219], v[18:19] op_sel_hi:[1,0,1] neg_lo:[0,1,0] neg_hi:[0,1,0]
    v_pk_fma_f32 v[20:21], v[52:53], v[218:219], v[20:21] op_sel_hi:[1,0,1] neg_lo:[0,1,0] neg_hi:[0,1,0]
    v_pk_fma_f32 v[22:23], v[54:55], v[218:219], v[22:23] op_sel_hi:[1,0,1] neg_lo:[0,1,0] neg_hi:[0,1,0]
    v_pk_fma_f32 v[24:25], v[56:57], v[218:219], v[24:25] op_sel_hi:[1,0,1] neg_lo:[0,1,0] neg_hi:[0,1,0]
    v_pk_fma_f32 v[26:27], v[58:59], v[218:219], v[26:27] op_sel_hi:[1,0,1] neg_lo:[0,1,0] neg_hi:[0,1,0]
    v_pk_fma_f32 v[28:29], v[60:61], v[218:219], v[28:29] op_sel_hi:[1,0,1] neg_lo:[0,1,0] neg_hi:[0,1,0]
    v_pk_fma_f32 v[30:31], v[62:63], v[218:219], v[30:31] op_sel_hi:[1,0,1] neg_lo:[0,1,0] neg_hi:[0,1,0]
    v_pk_mul_f32 v[16:17], v[16:17], v[218:219] op_sel:[0,1] op_sel_hi:[1,1]
    v_pk_mul_f32 v[18:19], v[18:19], v[218:219] op_sel:[0,1] op_sel_hi:[1,1]
    v_pk_mul_f32 v[20:21], v[20:21], v[218:219] op_sel:[0,1] op_sel_hi:[1,1]
    v_pk_mul_f32 v[22:23], v[22:23], v[218:219] op_sel:[0,1] op_sel_hi:[1,1]
    v_pk_mul_f32 v[24:25], v[24:25], v[218:219] op_sel:[0,1] op_sel_hi:[1,1]
    v_pk_mul_f32 v[26:27], v[26:27], v[218:219] op_sel:[0,1] op_sel_hi:[1,1]
    v_pk_mul_f32 v[28:29], v[28:29], v[218:219] op_sel:[0,1] op_sel_hi:[1,1]
    v_pk_mul_f32 v[30:31], v[30:31], v[218:219] op_sel:[0,1] op_sel_hi:[1,1]
    v_cvt_pk_bf16_f32 v96, v16, v17
    v_cvt_pk_bf16_f32 v97, v18, v19
    v_cvt_pk_bf16_f32 v98, v20, v21
    v_cvt_pk_bf16_f32 v99, v22, v23
    v_cvt_pk_bf16_f32 v100, v24, v25
    v_cvt_pk_bf16_f32 v101, v26, v27
    v_cvt_pk_bf16_f32 v102, v28, v29
    v_cvt_pk_bf16_f32 v103, v30, v31
    ds_write_b128 v217, v[96:99] offset:0
    ds_write_b128 v217, v[100:103] offset:4352
    v_pk_fma_f32 v[32:33], v[64:65], v[218:219], v[32:33] op_sel_hi:[1,0,1] neg_lo:[0,1,0] neg_hi:[0,1,0]
    v_pk_fma_f32 v[34:35], v[66:67], v[218:219], v[34:35] op_sel_hi:[1,0,1] neg_lo:[0,1,0] neg_hi:[0,1,0]
    v_pk_fma_f32 v[36:37], v[68:69], v[218:219], v[36:37] op_sel_hi:[1,0,1] neg_lo:[0,1,0] neg_hi:[0,1,0]
    v_pk_fma_f32 v[38:39], v[70:71], v[218:219], v[38:39] op_sel_hi:[1,0,1] neg_lo:[0,1,0] neg_hi:[0,1,0]
    v_pk_fma_f32 v[40:41], v[72:73], v[218:219], v[40:41] op_sel_hi:[1,0,1] neg_lo:[0,1,0] neg_hi:[0,1,0]
    v_pk_fma_f32 v[42:43], v[74:75], v[218:219], v[42:43] op_sel_hi:[1,0,1] neg_lo:[0,1,0] neg_hi:[0,1,0]
    v_pk_fma_f32 v[44:45], v[76:77], v[218:219], v[44:45] op_sel_hi:[1,0,1] neg_lo:[0,1,0] neg_hi:[0,1,0]
    v_pk_fma_f32 v[46:47], v[78:79], v[218:219], v[46:47] op_sel_hi:[1,0,1] neg_lo:[0,1,0] neg_hi:[0,1,0]
    v_pk_mul_f32 v[32:33], v[32:33], v[218:219] op_sel:[0,1] op_sel_hi:[1,1]
    v_pk_mul_f32 v[34:35], v[34:35], v[218:219] op_sel:[0,1] op_sel_hi:[1,1]
    v_pk_mul_f32 v[36:37], v[36:37], v[218:219] op_sel:[0,1] op_sel_hi:[1,1]
    v_pk_mul_f32 v[38:39], v[38:39], v[218:219] op_sel:[0,1] op_sel_hi:[1,1]
    v_pk_mul_f32 v[40:41], v[40:41], v[218:219] op_sel:[0,1] op_sel_hi:[1,1]
    v_pk_mul_f32 v[42:43], v[42:43], v[218:219] op_sel:[0,1] op_sel_hi:[1,1]
    v_pk_mul_f32 v[44:45], v[44:45], v[218:219] op_sel:[0,1] op_sel_hi:[1,1]
    v_pk_mul_f32 v[46:47], v[46:47], v[218:219] op_sel:[0,1] op_sel_hi:[1,1]
    v_cvt_pk_bf16_f32 v104, v32, v33
    v_cvt_pk_bf16_f32 v105, v34, v35
    v_cvt_pk_bf16_f32 v106, v36, v37
    v_cvt_pk_bf16_f32 v107, v38, v39
    v_cvt_pk_bf16_f32 v108, v40, v41
    v_cvt_pk_bf16_f32 v109, v42, v43
    v_cvt_pk_bf16_f32 v110, v44, v45
    v_cvt_pk_bf16_f32 v111, v46, v47
    ds_write_b128 v217, v[104:107] offset:8704
    ds_write_b128 v217, v[108:111] offset:13056
    v_pk_fma_f32 v[0:1], v[200:201], v[218:219], v[0:1] op_sel_hi:[1,0,1] neg_lo:[0,1,0] neg_hi:[0,1,0]
    v_pk_fma_f32 v[2:3], v[202:203], v[218:219], v[2:3] op_sel_hi:[1,0,1] neg_lo:[0,1,0] neg_hi:[0,1,0]
    v_pk_fma_f32 v[4:5], v[204:205], v[218:219], v[4:5] op_sel_hi:[1,0,1] neg_lo:[0,1,0] neg_hi:[0,1,0]
    v_pk_fma_f32 v[6:7], v[206:207], v[218:219], v[6:7] op_sel_hi:[1,0,1] neg_lo:[0,1,0] neg_hi:[0,1,0]
    v_pk_fma_f32 v[8:9], v[208:209], v[218:219], v[8:9] op_sel_hi:[1,0,1] neg_lo:[0,1,0] neg_hi:[0,1,0]
    v_pk_fma_f32 v[10:11], v[210:211], v[218:219], v[10:11] op_sel_hi:[1,0,1] neg_lo:[0,1,0] neg_hi:[0,1,0]
    v_pk_fma_f32 v[12:13], v[212:213], v[218:219], v[12:13] op_sel_hi:[1,0,1] neg_lo:[0,1,0] neg_hi:[0,1,0]
    v_pk_fma_f32 v[14:15], v[214:215], v[218:219], v[14:15] op_sel_hi:[1,0,1] neg_lo:[0,1,0] neg_hi:[0,1,0]
    v_cvt_pk_bf16_f32 v112, v0, v1
    v_cvt_pk_bf16_f32 v113, v2, v3
    v_cvt_pk_bf16_f32 v114, v4, v5
    v_cvt_pk_bf16_f32 v115, v6, v7
    v_cvt_pk_bf16_f32 v116, v8, v9
    v_cvt_pk_bf16_f32 v117, v10, v11
    v_cvt_pk_bf16_f32 v118, v12, v13
    v_cvt_pk_bf16_f32 v119, v14, v15
    v_mul_f32 v144, 0x3eb8aa3b, v219
    v_permlane32_swap_b32 v112, v116
    v_permlane32_swap_b32 v113, v117
    v_permlane32_swap_b32 v114, v118
    v_permlane32_swap_b32 v115, v119
    s_waitcnt lgkmcnt(0)
    s_barrier
    ds_read_b128 v[16:19], v220 offset:0
    ds_read_b128 v[20:23], v220 offset:2176
    ds_read_b128 v[24:27], v220 offset:64
    ds_read_b128 v[28:31], v220 offset:2240
    ds_read_b128 v[32:35], v220 offset:128
    ds_read_b128 v[36:39], v220 offset:2304
    ds_read_b64_tr_b16 v[40:41], v91 offset:0
    ds_read_b64_tr_b16 v[42:43], v91 offset:2176
    ds_read_b64_tr_b16 v[44:45], v91 offset:8
    ds_read_b64_tr_b16 v[46:47], v91 offset:2184
    ds_read_b64_tr_b16 v[48:49], v91 offset:64
    ds_read_b64_tr_b16 v[50:51], v91 offset:2240
    ds_read_b64_tr_b16 v[52:53], v91 offset:72
    ds_read_b64_tr_b16 v[54:55], v91 offset:2248
    ds_read_b64_tr_b16 v[56:57], v91 offset:128
    ds_read_b64_tr_b16 v[58:59], v91 offset:2304
    ds_read_b64_tr_b16 v[60:61], v91 offset:136
    ds_read_b64_tr_b16 v[62:63], v91 offset:2312
    s_add_u32 m0, s83, 65536
    s_add_u32 s95, s78, 65536
    buffer_load_dwordx4 v216, s[12:15], s95 offen lds
    s_add_u32 m0, s83, 66560
    s_add_u32 s95, s78, 73728
    buffer_load_dwordx4 v216, s[12:15], s95 offen lds
    s_add_u32 m0, s83, 67584
    s_add_u32 s95, s78, 81920
    buffer_load_dwordx4 v216, s[12:15], s95 offen lds
    s_add_u32 m0, s83, 68608
    s_add_u32 s95, s78, 90112
    buffer_load_dwordx4 v216, s[12:15], s95 offen lds
    s_add_u32 m0, s83, 69632
    s_add_u32 s95, s78, 98304
    buffer_load_dwordx4 v216, s[12:15], s95 offen lds
    s_add_u32 m0, s83, 70656
    s_add_u32 s95, s78, 106496
    buffer_load_dwordx4 v216, s[12:15], s95 offen lds
    s_add_u32 m0, s83, 71680
    s_add_u32 s95, s78, 114688
    buffer_load_dwordx4 v216, s[12:15], s95 offen lds
    s_add_u32 m0, s83, 72704
    s_add_u32 s95, s78, 122880
    buffer_load_dwordx4 v216, s[12:15], s95 offen lds
    s_waitcnt lgkmcnt(12)
    v_mfma_f32_4x4x4_16b_bf16 v[64:67], v[16:17], v[112:113], v[184:187]
    v_mfma_f32_4x4x4_16b_bf16 v[68:71], v[24:25], v[112:113], v[188:191]
    v_mfma_f32_4x4x4_16b_bf16 v[72:75], v[32:33], v[112:113], v[192:195]
    v_mfma_f32_4x4x4_16b_bf16 v[64:67], v[18:19], v[114:115], v[64:67]
    v_mfma_f32_4x4x4_16b_bf16 v[68:71], v[26:27], v[114:115], v[68:71]
    v_mfma_f32_4x4x4_16b_bf16 v[72:75], v[34:35], v[114:115], v[72:75]
    v_mfma_f32_4x4x4_16b_bf16 v[64:67], v[20:21], v[116:117], v[64:67]
    v_mfma_f32_4x4x4_16b_bf16 v[68:71], v[28:29], v[116:117], v[68:71]
    v_mfma_f32_4x4x4_16b_bf16 v[72:75], v[36:37], v[116:117], v[72:75]
    v_mfma_f32_4x4x4_16b_bf16 v[64:67], v[22:23], v[118:119], v[64:67]
    v_mfma_f32_4x4x4_16b_bf16 v[68:71], v[30:31], v[118:119], v[68:71]
    v_mfma_f32_4x4x4_16b_bf16 v[72:75], v[38:39], v[118:119], v[72:75]
    s_nop 2
    v_max3_f32 v145, v64, v65, v66
    v_max3_f32 v145, v145, v67, v68
    v_max3_f32 v145, v145, v69, v70
    v_max3_f32 v145, v145, v71, v72
    v_max3_f32 v145, v145, v73, v74
    v_max_f32 v145, v145, v75
    v_mul_f32 v145, v145, v144
    v_pk_fma_f32 v[64:65], v[64:65], v[144:145], v[144:145] op_sel:[0,0,1] op_sel_hi:[1,0,1] neg_lo:[0,0,1] neg_hi:[0,0,1]
    v_pk_fma_f32 v[66:67], v[66:67], v[144:145], v[144:145] op_sel:[0,0,1] op_sel_hi:[1,0,1] neg_lo:[0,0,1] neg_hi:[0,0,1]
    v_pk_fma_f32 v[68:69], v[68:69], v[144:145], v[144:145] op_sel:[0,0,1] op_sel_hi:[1,0,1] neg_lo:[0,0,1] neg_hi:[0,0,1]
    v_pk_fma_f32 v[70:71], v[70:71], v[144:145], v[144:145] op_sel:[0,0,1] op_sel_hi:[1,0,1] neg_lo:[0,0,1] neg_hi:[0,0,1]
    v_pk_fma_f32 v[72:73], v[72:73], v[144:145], v[144:145] op_sel:[0,0,1] op_sel_hi:[1,0,1] neg_lo:[0,0,1] neg_hi:[0,0,1]
    v_pk_fma_f32 v[74:75], v[74:75], v[144:145], v[144:145] op_sel:[0,0,1] op_sel_hi:[1,0,1] neg_lo:[0,0,1] neg_hi:[0,0,1]
    v_exp_f32 v64, v64
    v_exp_f32 v65, v65
    v_exp_f32 v66, v66
    v_exp_f32 v67, v67
    v_exp_f32 v68, v68
    v_exp_f32 v69, v69
    v_exp_f32 v70, v70
    v_exp_f32 v71, v71
    v_exp_f32 v72, v72
    v_exp_f32 v73, v73
    v_exp_f32 v74, v74
    v_exp_f32 v75, v75
    v_pk_add_f32 v[144:145], v[64:65], v[66:67]
    v_pk_add_f32 v[144:145], v[144:145], v[68:69]
    v_pk_add_f32 v[144:145], v[144:145], v[70:71]
    v_pk_add_f32 v[144:145], v[144:145], v[72:73]
    v_pk_add_f32 v[144:145], v[144:145], v[74:75]
    v_add_f32 v144, v144, v145
    v_rcp_f32 v144, v144
    v_mov_b32 v210, v90
    v_pk_mul_f32 v[64:65], v[64:65], v[144:145] op_sel_hi:[1,0]
    v_pk_mul_f32 v[66:67], v[66:67], v[144:145] op_sel_hi:[1,0]
    v_pk_mul_f32 v[68:69], v[68:69], v[144:145] op_sel_hi:[1,0]
    v_pk_mul_f32 v[70:71], v[70:71], v[144:145] op_sel_hi:[1,0]
    v_pk_mul_f32 v[72:73], v[72:73], v[144:145] op_sel_hi:[1,0]
    v_pk_mul_f32 v[74:75], v[74:75], v[144:145] op_sel_hi:[1,0]
    v_cvt_pk_bf16_f32 v120, v64, v65
    v_cvt_pk_bf16_f32 v121, v66, v67
    v_cvt_pk_bf16_f32 v122, v68, v69
    v_cvt_pk_bf16_f32 v123, v70, v71
    v_cvt_pk_bf16_f32 v124, v72, v73
    v_cvt_pk_bf16_f32 v125, v74, v75
    s_lshl_b32 s92, s45, 2
    s_add_u32 s92, s92, s44
    s_lshl_b32 s92, s92, 2
    s_add_u32 s92, s92, 1769472
    v_mov_b32 v208, 2130706432
    v_writelane_b32 v208, s92, 0
    v_lshlrev_b32 v209, 2, v222
    v_add_u32 v209, 1769472, v209
    s_waitcnt lgkmcnt(8)
    v_mfma_f32_4x4x4_16b_bf16 v[128:131], v[40:41], v[120:121], 0
    v_mfma_f32_4x4x4_16b_bf16 v[132:135], v[42:43], v[120:121], 0
    v_mfma_f32_4x4x4_16b_bf16 v[136:139], v[44:45], v[120:121], 0
    v_mfma_f32_4x4x4_16b_bf16 v[140:143], v[46:47], v[120:121], 0
    s_waitcnt lgkmcnt(4)
    v_mfma_f32_4x4x4_16b_bf16 v[128:131], v[48:49], v[122:123], v[128:131]
    v_mfma_f32_4x4x4_16b_bf16 v[132:135], v[50:51], v[122:123], v[132:135]
    v_mfma_f32_4x4x4_16b_bf16 v[136:139], v[52:53], v[122:123], v[136:139]
    v_mfma_f32_4x4x4_16b_bf16 v[140:143], v[54:55], v[122:123], v[140:143]
    s_waitcnt lgkmcnt(0)
    v_mfma_f32_4x4x4_16b_bf16 v[128:131], v[56:57], v[124:125], v[128:131]
    v_mfma_f32_4x4x4_16b_bf16 v[132:135], v[58:59], v[124:125], v[132:135]
    v_mfma_f32_4x4x4_16b_bf16 v[136:139], v[60:61], v[124:125], v[136:139]
    v_mfma_f32_4x4x4_16b_bf16 v[140:143], v[62:63], v[124:125], v[140:143]
    s_add_u32 s92, s50, 2
    v_mov_b32 v10, s92
    v_cvt_pk_bf16_f32 v0, v128, v129
    v_cvt_pk_bf16_f32 v1, v130, v131
    v_cvt_pk_bf16_f32 v2, v132, v133
    v_cvt_pk_bf16_f32 v3, v134, v135
    v_cvt_pk_bf16_f32 v4, v136, v137
    v_cvt_pk_bf16_f32 v5, v138, v139
    v_cvt_pk_bf16_f32 v6, v140, v141
    v_cvt_pk_bf16_f32 v7, v142, v143
    buffer_store_dwordx4 v[0:3], v223, s[28:31], s84 offen offset:0 sc1
    buffer_store_dwordx4 v[4:7], v223, s[28:31], s84 offen offset:1024 sc1
    v_and_b32 v184, 3, v222
    v_bfe_u32 v186, v222, 4, 1
    v_lshl_add_u32 v184, v186, 2, v184
    s_lshl_b32 s92, s44, 1
    v_add_u32 v184, s92, v184
    v_and_b32 v184, 7, v184
    v_lshlrev_b32 v184, 3, v184
    v_bfe_u32 v186, v222, 2, 2
    v_lshl_add_u32 v184, v186, 7, v184
    v_bfe_u32 v186, v222, 3, 1
    v_lshl_add_u32 v184, v186, 6, v184
    v_lshrrev_b32 v186, 5, v222
    v_lshl_add_u32 v184, v186, 11, v184
    v_xor_b32 v185, 64, v184
    s_lshl_b32 s92, s44, 13
    s_add_u32 s93, s92, 98304
    v_add_u32 v186, s93, v184
    v_add_u32 v187, s93, v185
    s_add_u32 s93, s92, 65536
    v_add_u32 v184, s93, v184
    v_add_u32 v185, s93, v185
    s_waitcnt vmcnt(2)
    ds_read_b64_tr_b16 a[224:225], v186 offset:0
    ds_read_b64_tr_b16 a[226:227], v186 offset:512
    ds_read_b64_tr_b16 a[228:229], v187 offset:0
    ds_read_b64_tr_b16 a[230:231], v187 offset:512
    ds_read_b64_tr_b16 a[232:233], v186 offset:1024
    ds_read_b64_tr_b16 a[234:235], v186 offset:1536
    ds_read_b64_tr_b16 a[236:237], v187 offset:1024
    ds_read_b64_tr_b16 a[238:239], v187 offset:1536
    ds_read_b64_tr_b16 a[240:241], v186 offset:4096
    ds_read_b64_tr_b16 a[242:243], v186 offset:4608
    ds_read_b64_tr_b16 a[244:245], v187 offset:4096
    ds_read_b64_tr_b16 a[246:247], v187 offset:4608
    ds_read_b64_tr_b16 a[248:249], v186 offset:5120
    ds_read_b64_tr_b16 a[250:251], v186 offset:5632
    ds_read_b64_tr_b16 a[252:253], v187 offset:5120
    ds_read_b64_tr_b16 a[254:255], v187 offset:5632
    ds_read_b64_tr_b16 v[224:225], v184 offset:0
    ds_read_b64_tr_b16 v[226:227], v184 offset:512
    ds_read_b64_tr_b16 v[228:229], v185 offset:0
    ds_read_b64_tr_b16 v[230:231], v185 offset:512
    ds_read_b64_tr_b16 v[232:233], v184 offset:1024
    ds_read_b64_tr_b16 v[234:235], v184 offset:1536
    ds_read_b64_tr_b16 v[236:237], v185 offset:1024
    ds_read_b64_tr_b16 v[238:239], v185 offset:1536
    ds_read_b64_tr_b16 v[240:241], v184 offset:4096
    ds_read_b64_tr_b16 v[242:243], v184 offset:4608
    ds_read_b64_tr_b16 v[244:245], v185 offset:4096
    ds_read_b64_tr_b16 v[246:247], v185 offset:4608
    ds_read_b64_tr_b16 v[248:249], v184 offset:5120
    ds_read_b64_tr_b16 v[250:251], v184 offset:5632
    ds_read_b64_tr_b16 v[252:253], v185 offset:5120
    ds_read_b64_tr_b16 v[254:255], v185 offset:5632
    v_accvgpr_read_b32 v176, a216
    v_accvgpr_read_b32 v177, a217
    v_accvgpr_read_b32 v178, a218
    v_accvgpr_read_b32 v179, a219
    v_accvgpr_read_b32 v180, a220
    v_accvgpr_read_b32 v181, a221
    v_accvgpr_read_b32 v182, a222
    v_accvgpr_read_b32 v183, a223
    s_lshl_b32 s92, s46, 2
    s_add_u32 s92, s92, s44
    s_lshl_b32 s93, s47, 6
    s_add_u32 s93, s93, s92
    s_lshl_b32 s84, s93, 10
    s_lshl_b32 s93, s92, 10
    s_lshl_b32 s94, s47, 9
    s_add_u32 s85, s93, s94
    s_lshl_b32 s86, s92, 6
    s_mov_b32 s87, s93
    v_and_b32 v184, 31, v222
    v_lshrrev_b32 v185, 5, v222
    v_lshlrev_b32 v215, 3, v184
    v_lshl_add_u32 v215, v185, 2, v215
    s_lshl_b32 s92, s44, 3
    s_lshl_b32 s93, s47, 6
    s_add_u32 s92, s92, s93
    s_lshl_b32 s92, s92, 10
    s_add_u32 s92, s92, 131072
    v_add_u32 v217, s92, v223
    v_add_u32 v220, 32768, v217
    s_waitcnt vmcnt(0)
    s_cmp_eq_u32 s52, 1
    s_cbranch_scc0 L_safe_6
    buffer_store_dword v10, v208, s[28:31], 0 offen
L_back_7:
    s_waitcnt lgkmcnt(0)
    s_barrier
    s_add_u32 m0, s77, 98304
    s_add_u32 s95, s76, 0
    buffer_load_dwordx4 v210, s[16:19], s95 offen lds
    s_add_u32 m0, s77, 102400
    s_add_u32 s95, s76, 114688
    buffer_load_dwordx4 v210, s[16:19], s95 offen lds
    s_add_u32 m0, s77, 106496
    s_add_u32 s95, s76, 229376
    buffer_load_dwordx4 v210, s[16:19], s95 offen lds
    s_add_u32 m0, s77, 110592
    s_add_u32 s95, s76, 344064
    buffer_load_dwordx4 v210, s[16:19], s95 offen lds
    s_lshl_b32 s92, s44, 8
    s_add_u32 s92, s92, 157696
    v_lshlrev_b32 v156, 2, v222
    v_add_u32 v156, s92, v156
    s_add_u32 s92, s44, 0
    s_and_b32 s92, s92, 3
    s_mul_i32 s93, s92, 6144
    s_add_u32 s93, s93, 131072
    v_add_u32 v214, s93, v223
    s_lshr_b32 s93, s92, 1
    s_mul_i32 s93, s93, 0
    s_add_u32 s93, s93, 0
    v_add_u32 v155, s93, v214
    s_add_u32 s92, s44, 1
    s_and_b32 s92, s92, 3
    s_mul_i32 s93, s92, 6144
    s_add_u32 s93, s93, 131072
    v_add_u32 v211, s93, v223
    s_lshr_b32 s93, s92, 1
    s_mul_i32 s93, s93, 0
    s_add_u32 s93, s93, 0
    v_add_u32 v152, s93, v211
    s_add_u32 s92, s44, 2
    s_and_b32 s92, s92, 3
    s_mul_i32 s93, s92, 6144
    s_add_u32 s93, s93, 133120
    v_add_u32 v212, s93, v223
    s_lshr_b32 s93, s92, 1
    s_mul_i32 s93, s93, 0
    s_add_u32 s93, s93, 0
    v_add_u32 v153, s93, v212
    s_add_u32 s92, s44, 3
    s_and_b32 s92, s92, 3
    s_mul_i32 s93, s92, 6144
    s_add_u32 s93, s93, 135168
    v_add_u32 v213, s93, v223
    s_lshr_b32 s93, s92, 1
    s_mul_i32 s93, s93, 0
    s_add_u32 s93, s93, 0
    v_add_u32 v154, s93, v213
    s_add_u32 s91, s50, 2
L_poll_8:
    buffer_load_dword v184, v209, s[28:31], 0 offen sc1
    s_waitcnt vmcnt(0)
    v_subrev_u32 v184, s91, v184
    v_cmp_gt_u32 vcc, 32, v184
    s_nop 0
    s_andn2_b64 s[96:97], s[56:57], vcc
    s_cbranch_scc1 L_chk_9
L_done_10:
    buffer_load_dwordx4 v[64:67], v217, s[28:31], s66 offen offset:0 sc1
    buffer_load_dwordx4 v[68:71], v217, s[28:31], s66 offen offset:1024 sc1
    buffer_load_dwordx4 v[72:75], v217, s[28:31], s66 offen offset:2048 sc1
    buffer_load_dwordx4 v[76:79], v217, s[28:31], s66 offen offset:3072 sc1
    buffer_load_dwordx4 v[80:83], v217, s[28:31], s67 offen offset:0 sc1
    buffer_load_dwordx4 v[84:87], v217, s[28:31], s67 offen offset:1024 sc1
    buffer_load_dwordx4 v[88:91], v217, s[28:31], s67 offen offset:2048 sc1
    buffer_load_dwordx4 v[92:95], v217, s[28:31], s67 offen offset:3072 sc1
    buffer_load_dwordx4 v[96:99], v220, s[28:31], s66 offen offset:0 sc1
    buffer_load_dwordx4 v[100:103], v220, s[28:31], s66 offen offset:1024 sc1
    buffer_load_dwordx4 v[104:107], v220, s[28:31], s66 offen offset:2048 sc1
    v_lshlrev_b32 v160, 16, v176
    v_and_b32 v161, 0xffff0000, v176
    v_lshlrev_b32 v162, 16, v177
    v_and_b32 v163, 0xffff0000, v177
    v_lshlrev_b32 v164, 16, v178
    v_and_b32 v165, 0xffff0000, v178
    v_lshlrev_b32 v166, 16, v179
    v_and_b32 v167, 0xffff0000, v179
    v_lshlrev_b32 v168, 16, v180
    v_and_b32 v169, 0xffff0000, v180
    v_lshlrev_b32 v170, 16, v181
    v_and_b32 v171, 0xffff0000, v181
    v_lshlrev_b32 v172, 16, v182
    v_and_b32 v173, 0xffff0000, v182
    v_lshlrev_b32 v174, 16, v183
    v_and_b32 v175, 0xffff0000, v183
    s_waitcnt vmcnt(10)
    v_mfma_f32_32x32x16_bf16 v[0:15], a[224:227], v[64:67], 0
    v_mfma_f32_32x32x16_bf16 v[16:31], a[228:231], v[64:67], 0
    buffer_load_dwordx4 v[108:111], v220, s[28:31], s66 offen offset:3072 sc1
    s_waitcnt vmcnt(10)
    v_mfma_f32_32x32x16_bf16 v[0:15], a[232:235], v[68:71], v[0:15]
    v_mfma_f32_32x32x16_bf16 v[16:31], a[236:239], v[68:71], v[16:31]
    buffer_load_dwordx4 v[112:115], v220, s[28:31], s67 offen offset:0 sc1
    s_waitcnt vmcnt(10)
    v_mfma_f32_32x32x16_bf16 v[0:15], a[240:243], v[72:75], v[0:15]
    v_mfma_f32_32x32x16_bf16 v[16:31], a[244:247], v[72:75], v[16:31]
    buffer_load_dwordx4 v[116:119], v220, s[28:31], s67 offen offset:1024 sc1
    s_waitcnt vmcnt(10)
    v_mfma_f32_32x32x16_bf16 v[0:15], a[248:251], v[76:79], v[0:15]
    v_mfma_f32_32x32x16_bf16 v[16:31], a[252:255], v[76:79], v[16:31]
    buffer_load_dwordx4 v[120:123], v220, s[28:31], s67 offen offset:2048 sc1
    s_waitcnt vmcnt(10)
    v_mfma_f32_32x32x16_bf16 v[0:15], v[224:227], v[80:83], v[0:15]
    v_mfma_f32_32x32x16_bf16 v[16:31], v[228:231], v[80:83], v[16:31]
    buffer_load_dwordx4 v[124:127], v220, s[28:31], s67 offen offset:3072 sc1
    s_waitcnt vmcnt(10)
    v_mfma_f32_32x32x16_bf16 v[0:15], v[232:235], v[84:87], v[0:15]
    v_mfma_f32_32x32x16_bf16 v[16:31], v[236:239], v[84:87], v[16:31]
    s_add_u32 m0, s77, 114688
    s_add_u32 s95, s76, 458752
    buffer_load_dwordx4 v210, s[16:19], s95 offen lds
    s_waitcnt vmcnt(10)
    v_mfma_f32_32x32x16_bf16 v[0:15], v[240:243], v[88:91], v[0:15]
    v_mfma_f32_32x32x16_bf16 v[16:31], v[244:247], v[88:91], v[16:31]
    s_add_u32 m0, s77, 118784
    s_add_u32 s95, s76, 573440
    buffer_load_dwordx4 v210, s[16:19], s95 offen lds
    s_waitcnt vmcnt(10)
    v_mfma_f32_32x32x16_bf16 v[0:15], v[248:251], v[92:95], v[0:15]
    v_mfma_f32_32x32x16_bf16 v[16:31], v[252:255], v[92:95], v[16:31]
    s_add_u32 m0, s77, 122880
    s_add_u32 s95, s76, 688128
    buffer_load_dwordx4 v210, s[16:19], s95 offen lds
    s_waitcnt vmcnt(10)
    v_mfma_f32_32x32x16_bf16 v[32:47], a[224:227], v[96:99], 0
    v_mfma_f32_32x32x16_bf16 v[48:63], a[228:231], v[96:99], 0
    s_add_u32 m0, s77, 126976
    s_add_u32 s95, s76, 802816
    buffer_load_dwordx4 v210, s[16:19], s95 offen lds
    s_waitcnt vmcnt(10)
    v_mfma_f32_32x32x16_bf16 v[32:47], a[232:235], v[100:103], v[32:47]
    ds_write_b128 v211, v[4:7] offset:0
    ds_write_b128 v211, v[20:23] offset:1024
    v_mfma_f32_32x32x16_bf16 v[48:63], a[236:239], v[100:103], v[48:63]
    s_add_u32 m0, s77, 65536
    s_add_u32 s95, s76, 917504
    buffer_load_dwordx4 v210, s[16:19], s95 offen lds
    ds_write_b128 v212, v[8:11] offset:0
    ds_write_b128 v212, v[24:27] offset:1024
    s_waitcnt vmcnt(10)
    v_mfma_f32_32x32x16_bf16 v[32:47], a[240:243], v[104:107], v[32:47]
    ds_write_b128 v213, v[12:15] offset:0
    ds_write_b128 v213, v[28:31] offset:1024
    v_mfma_f32_32x32x16_bf16 v[48:63], a[244:247], v[104:107], v[48:63]
    s_add_u32 m0, s77, 69632
    s_add_u32 s95, s76, 1032192
    buffer_load_dwordx4 v210, s[16:19], s95 offen lds
    s_waitcnt vmcnt(10)
    v_mfma_f32_32x32x16_bf16 v[32:47], a[248:251], v[108:111], v[32:47]
    v_mfma_f32_32x32x16_bf16 v[48:63], a[252:255], v[108:111], v[48:63]
    s_add_u32 m0, s77, 73728
    s_add_u32 s95, s76, 1146880
    buffer_load_dwordx4 v210, s[16:19], s95 offen lds
    s_waitcnt vmcnt(10)
    v_mfma_f32_32x32x16_bf16 v[32:47], v[224:227], v[112:115], v[32:47]
    s_waitcnt lgkmcnt(0)
    s_barrier
    ds_read_b128 v[184:187], v214 offset:0
    ds_read_b128 v[188:191], v214 offset:1024
    ds_read_b128 v[192:195], v214 offset:2048
    v_mfma_f32_32x32x16_bf16 v[48:63], v[228:231], v[112:115], v[48:63]
    s_add_u32 m0, s77, 77824
    s_add_u32 s95, s76, 1261568
    buffer_load_dwordx4 v210, s[16:19], s95 offen lds
    ds_read_b128 v[196:199], v214 offset:3072
    ds_read_b128 v[200:203], v214 offset:4096
    ds_read_b128 v[204:207], v214 offset:5120
    s_waitcnt vmcnt(10)
    v_mfma_f32_32x32x16_bf16 v[32:47], v[232:235], v[116:119], v[32:47]
    v_mfma_f32_32x32x16_bf16 v[48:63], v[236:239], v[116:119], v[48:63]
    s_waitcnt vmcnt(9)
    v_mfma_f32_32x32x16_bf16 v[32:47], v[240:243], v[120:123], v[32:47]
    v_mfma_f32_32x32x16_bf16 v[48:63], v[244:247], v[120:123], v[48:63]
    s_waitcnt vmcnt(8)
    v_mfma_f32_32x32x16_bf16 v[32:47], v[248:251], v[124:127], v[32:47]
    v_mfma_f32_32x32x16_bf16 v[48:63], v[252:255], v[124:127], v[48:63]
    s_waitcnt lgkmcnt(0)
    s_barrier
    s_nop 8
    ds_write_b128 v152, v[36:39] offset:0
    s_add_u32 s94, s84, 0
    v_pk_add_f32 v[0:1], v[0:1], v[184:185]
    v_pk_add_f32 v[2:3], v[2:3], v[186:187]
    v_pk_add_f32 v[16:17], v[16:17], v[188:189]
    v_pk_add_f32 v[18:19], v[18:19], v[190:191]
    ds_write_b128 v152, v[52:55] offset:1024
    v_pk_add_f32 v[0:1], v[0:1], v[192:193]
    v_pk_add_f32 v[2:3], v[2:3], v[194:195]
    v_pk_add_f32 v[16:17], v[16:17], v[196:197]
    v_pk_add_f32 v[18:19], v[18:19], v[198:199]
    ds_write_b128 v153, v[40:43] offset:0
    v_pk_add_f32 v[0:1], v[0:1], v[200:201]
    v_pk_add_f32 v[2:3], v[2:3], v[202:203]
    v_pk_add_f32 v[16:17], v[16:17], v[204:205]
    v_pk_add_f32 v[18:19], v[18:19], v[206:207]
    v_pk_add_f32 v[160:161], v[0:1], v[160:161]
    v_pk_add_f32 v[162:163], v[2:3], v[162:163]
    v_pk_add_f32 v[164:165], v[16:17], v[164:165]
    ds_write_b128 v153, v[56:59] offset:1024
    v_pk_add_f32 v[166:167], v[18:19], v[166:167]
    v_cvt_pk_bf16_f32 v176, v160, v161
    v_cvt_pk_bf16_f32 v177, v162, v163
    v_cvt_pk_bf16_f32 v178, v164, v165
    v_cvt_pk_bf16_f32 v179, v166, v167
    buffer_store_dwordx4 v[176:179], v223, s[28:31], s94 offen sc1
    ds_write_b128 v154, v[44:47] offset:0
    v_pk_add_f32 v[4:5], v[160:161], v[162:163]
    v_pk_mul_f32 v[6:7], v[160:161], v[160:161]
    v_pk_add_f32 v[4:5], v[4:5], v[164:165]
    v_pk_fma_f32 v[6:7], v[162:163], v[162:163], v[6:7]
    v_pk_add_f32 v[4:5], v[4:5], v[166:167]
    v_pk_fma_f32 v[6:7], v[164:165], v[164:165], v[6:7]
    ds_write_b128 v154, v[60:63] offset:1024
    v_add_f32 v4, v4, v5
    v_pk_fma_f32 v[6:7], v[166:167], v[166:167], v[6:7]
    v_add_f32 v6, v6, v7
    s_nop 1
    v_permlane32_swap_b32 v4, v6
    v_add_f32 v4, v4, v6
    ds_write_b32 v156, v4 offset:0
    s_waitcnt lgkmcnt(1)
    s_barrier
    ds_read_b128 v[128:131], v155 offset:0
    ds_read_b128 v[132:135], v155 offset:1024
    ds_read_b128 v[136:139], v155 offset:2048
    ds_read_b128 v[140:143], v155 offset:3072
    ds_read_b128 v[144:147], v155 offset:4096
    ds_read_b128 v[148:151], v155 offset:5120
    s_add_u32 s92, s84, 32768
    s_waitcnt lgkmcnt(4)
    v_pk_add_f32 v[32:33], v[32:33], v[128:129]
    v_pk_add_f32 v[34:35], v[34:35], v[130:131]
    v_pk_add_f32 v[48:49], v[48:49], v[132:133]
    v_pk_add_f32 v[50:51], v[50:51], v[134:135]
    s_waitcnt lgkmcnt(2)
    v_pk_add_f32 v[32:33], v[32:33], v[136:137]
    v_pk_add_f32 v[34:35], v[34:35], v[138:139]
    v_pk_add_f32 v[48:49], v[48:49], v[140:141]
    v_pk_add_f32 v[50:51], v[50:51], v[142:143]
    s_waitcnt lgkmcnt(0)
    v_pk_add_f32 v[32:33], v[32:33], v[144:145]
    v_pk_add_f32 v[34:35], v[34:35], v[146:147]
    v_pk_add_f32 v[48:49], v[48:49], v[148:149]
    v_pk_add_f32 v[50:51], v[50:51], v[150:151]
    v_pk_add_f32 v[168:169], v[32:33], v[168:169]
    v_pk_add_f32 v[170:171], v[34:35], v[170:171]
    v_pk_add_f32 v[172:173], v[48:49], v[172:173]
    v_pk_add_f32 v[174:175], v[50:51], v[174:175]
    v_cvt_pk_bf16_f32 v180, v168, v169
    v_cvt_pk_bf16_f32 v181, v170, v171
    v_cvt_pk_bf16_f32 v182, v172, v173
    v_cvt_pk_bf16_f32 v183, v174, v175
    buffer_store_dwordx4 v[180:183], v223, s[28:31], s92 offen sc1
    v_pk_add_f32 v[36:37], v[168:169], v[170:171]
    v_pk_mul_f32 v[38:39], v[168:169], v[168:169]
    v_pk_add_f32 v[36:37], v[36:37], v[172:173]
    v_pk_fma_f32 v[38:39], v[170:171], v[170:171], v[38:39]
    v_pk_add_f32 v[36:37], v[36:37], v[174:175]
    v_pk_fma_f32 v[38:39], v[172:173], v[172:173], v[38:39]
    v_add_f32 v36, v36, v37
    v_pk_fma_f32 v[38:39], v[174:175], v[174:175], v[38:39]
    v_add_f32 v38, v38, v39
    s_nop 1
    v_permlane32_swap_b32 v36, v38
    v_add_f32 v36, v36, v38
    ds_write_b32 v156, v36 offset:1024
    s_add_u32 s92, s50, 3
    v_mov_b32 v220, s92
    v_and_b32 v211, 3, v222
    v_bfe_u32 v215, v222, 4, 1
    v_lshl_add_u32 v211, v215, 2, v211
    v_lshlrev_b32 v211, 3, v211
    v_bfe_u32 v215, v222, 2, 2
    v_lshl_add_u32 v211, v215, 7, v211
    v_bfe_u32 v215, v222, 3, 1
    v_lshl_add_u32 v211, v215, 6, v211
    v_lshrrev_b32 v215, 5, v222
    v_lshl_add_u32 v211, v215, 9, v211
    v_xor_b32 v212, 64, v211
    s_lshl_b32 s92, s44, 15
    s_add_u32 s92, s92, 0
    v_add_u32 v213, s92, v223
    v_add_u32 v211, 98304, v211
    v_add_u32 v212, 98304, v212
    s_waitcnt vmcnt(0)
    s_cmp_eq_u32 s52, 1
    s_cbranch_scc0 L_safe_11
    buffer_store_dword v220, v208, s[28:31], 0 offen
L_back_12:
    s_add_u32 m0, s77, 81920
    s_add_u32 s95, s76, 1376256
    buffer_load_dwordx4 v210, s[16:19], s95 offen lds
    s_add_u32 m0, s77, 86016
    s_add_u32 s95, s76, 1490944
    buffer_load_dwordx4 v210, s[16:19], s95 offen lds
    s_add_u32 m0, s77, 90112
    s_add_u32 s95, s76, 1605632
    buffer_load_dwordx4 v210, s[16:19], s95 offen lds
    s_add_u32 m0, s77, 94208
    s_add_u32 s95, s76, 1720320
    buffer_load_dwordx4 v210, s[16:19], s95 offen lds
    s_min_u32 s92, s45, 13
    s_lshl_b32 s92, s92, 3
    s_mul_i32 s93, s44, 112
    s_add_u32 s92, s92, s93
    s_lshl_b32 s92, s92, 10
    s_add_u32 s84, s92, 262144
    s_add_u32 s85, s84, 4096
    v_lshrrev_b32 v217, 5, v222
    v_lshlrev_b32 v217, 4, v217
    v_add_u32 v217, 159744, v217
    s_lshl_b32 s93, s46, 7
    v_bfe_u32 v215, v222, 4, 1
    v_lshlrev_b32 v215, 2, v215
    v_and_b32 v216, 7, v222
    v_xor_b32 v216, v216, v215
    v_lshlrev_b32 v216, 4, v216
    v_lshrrev_b32 v215, 3, v222
    v_mul_u32_u24 v215, 1024, v215
    v_add3_u32 v216, v216, v215, s93
    s_mul_i32 s92, s44, 28
    s_and_b32 s93, s44, 1
    s_lshl_b32 s94, s93, 2
    s_add_u32 s94, s94, s92
    s_lshl_b32 s88, s94, 14
    s_xor_b32 s93, s93, 1
    s_mul_i32 s93, s93, 24
    s_add_u32 s93, s93, s92
    s_lshl_b32 s89, s93, 14
    s_mul_i32 s78, s44, 6144
    s_lshl_b32 s79, s44, 12
    v_mov_b32 v215, 0x3f803f80
    v_accvgpr_write_b32 a204, v215
    v_accvgpr_write_b32 a205, v215
    v_accvgpr_write_b32 a206, v215
    v_accvgpr_write_b32 a207, v215
    s_and_b32 s92, s44, 1
    s_lshl_b32 s92, s92, 6
    s_lshr_b32 s93, s44, 1
    s_lshl_b32 s93, s93, 10
    v_xor_b32 v214, s92, v211
    v_add_u32 v214, s93, v214
    s_waitcnt vmcnt(0) lgkmcnt(0)
    s_barrier
    ds_read_b64_tr_b16 v[192:193], v211 offset:0
    ds_read_b64_tr_b16 v[194:195], v211 offset:4096
    ds_read_b64_tr_b16 v[196:197], v212 offset:0
    ds_read_b64_tr_b16 v[198:199], v212 offset:4096
    ds_read_b64_tr_b16 v[200:201], v214 offset:0
    ds_read_b64_tr_b16 v[202:203], v214 offset:4096
    s_add_u32 s91, s50, 3
L_poll_13:
    buffer_load_dword v215, v209, s[28:31], 0 offen sc1
    s_waitcnt vmcnt(0)
    v_subrev_u32 v215, s91, v215
    v_cmp_gt_u32 vcc, 32, v215
    s_nop 0
    s_andn2_b64 s[96:97], s[54:55], vcc
    s_cbranch_scc1 L_chk_14
L_done_15:
    buffer_load_dwordx4 v[0:3], v213, s[28:31], s66 offen offset:0 sc1
    buffer_load_dwordx4 v[4:7], v213, s[28:31], s66 offen offset:1024 sc1
    buffer_load_dwordx4 v[8:11], v213, s[28:31], s66 offen offset:2048 sc1
    buffer_load_dwordx4 v[12:15], v213, s[28:31], s66 offen offset:3072 sc1
    buffer_load_dwordx4 v[16:19], v213, s[28:31], s67 offen offset:0 sc1
    buffer_load_dwordx4 v[20:23], v213, s[28:31], s67 offen offset:1024 sc1
    buffer_load_dwordx4 v[24:27], v213, s[28:31], s67 offen offset:2048 sc1
    buffer_load_dwordx4 v[28:31], v213, s[28:31], s67 offen offset:3072 sc1
    buffer_load_dwordx4 v[32:35], v213, s[28:31], s68 offen offset:0 sc1
    buffer_load_dwordx4 v[36:39], v213, s[28:31], s68 offen offset:1024 sc1
    s_waitcnt vmcnt(9) lgkmcnt(2)
    v_mfma_f32_32x32x16_bf16 v[128:143], v[192:195], v[0:3], 0
    ds_read_b64_tr_b16 v[204:205], v211 offset:1024
    ds_read_b64_tr_b16 v[206:207], v211 offset:5120
    s_and_b32 s92, s44, 1
    s_lshl_b32 s93, s92, 10
    v_mfma_f32_32x32x16_bf16 v[144:159], v[196:199], v[0:3], 0
    ds_read_b64_tr_b16 v[192:193], v212 offset:1024
    ds_read_b64_tr_b16 v[194:195], v212 offset:5120
    buffer_load_dwordx4 v[40:43], v213, s[28:31], s68 offen offset:2048 sc1
    s_add_u32 s93, s93, 157696
    v_lshlrev_b32 v164, 2, v222
    s_waitcnt lgkmcnt(2)
    v_mfma_f32_32x32x16_bf16 a[208:223], v[200:203], a[204:207], 0
    ds_read_b64_tr_b16 v[196:197], v211 offset:2048
    ds_read_b64_tr_b16 v[198:199], v211 offset:6144
    v_add_u32 v164, s93, v164
    ds_read2st64_b32 v[160:161], v164 offset0:0 offset1:1
    s_waitcnt vmcnt(9)
    v_mfma_f32_32x32x16_bf16 v[128:143], v[204:207], v[4:7], v[128:143]
    ds_read_b64_tr_b16 v[200:201], v212 offset:2048
    ds_read_b64_tr_b16 v[202:203], v212 offset:6144
    ds_read2st64_b32 v[162:163], v164 offset0:2 offset1:3
    s_waitcnt lgkmcnt(4)
    v_mfma_f32_32x32x16_bf16 v[144:159], v[192:195], v[4:7], v[144:159]
    ds_read_b64_tr_b16 v[204:205], v214 offset:2048
    ds_read_b64_tr_b16 v[206:207], v214 offset:6144
    buffer_load_dwordx4 v[44:47], v213, s[28:31], s68 offen offset:3072 sc1
    s_lshl_b32 s92, s92, 8
    s_waitcnt vmcnt(9)
    v_mfma_f32_32x32x16_bf16 v[128:143], v[196:199], v[8:11], v[128:143]
    ds_read_b64_tr_b16 v[192:193], v211 offset:3072
    ds_read_b64_tr_b16 v[194:195], v211 offset:7168
    s_lshl_b32 s93, s47, 9
    s_add_u32 s92, s92, s93
    s_waitcnt lgkmcnt(2)
    v_mfma_f32_32x32x16_bf16 v[144:159], v[200:203], v[8:11], v[144:159]
    ds_read_b64_tr_b16 v[196:197], v212 offset:3072
    ds_read_b64_tr_b16 v[198:199], v212 offset:7168
    buffer_load_dwordx4 v[48:51], v213, s[28:31], s69 offen offset:0 sc1
    s_lshl_b32 s93, s46, 10
    v_mfma_f32_32x32x16_bf16 a[208:223], v[204:207], a[204:207], a[208:223]
    ds_read_b64_tr_b16 v[200:201], v211 offset:8192
    ds_read_b64_tr_b16 v[202:203], v211 offset:12288
    s_add_u32 s92, s92, s93
    s_add_u32 s94, s92, 1572864
    v_and_b32 v164, 31, v222
    s_waitcnt vmcnt(9) lgkmcnt(2)
    v_mfma_f32_32x32x16_bf16 v[128:143], v[192:195], v[12:15], v[128:143]
    ds_read_b64_tr_b16 v[204:205], v212 offset:8192
    ds_read_b64_tr_b16 v[206:207], v212 offset:12288
    v_lshrrev_b32 v165, 5, v222
    v_lshlrev_b32 v164, 3, v164
    v_mfma_f32_32x32x16_bf16 v[144:159], v[196:199], v[12:15], v[144:159]
    ds_read_b64_tr_b16 v[192:193], v214 offset:8192
    ds_read_b64_tr_b16 v[194:195], v214 offset:12288
    buffer_load_dwordx4 v[52:55], v213, s[28:31], s69 offen offset:1024 sc1
    v_lshl_add_u32 v164, v165, 2, v164
    s_add_u32 s92, s50, 4
    s_waitcnt vmcnt(9) lgkmcnt(2)
    v_mfma_f32_32x32x16_bf16 v[128:143], v[200:203], v[16:19], v[128:143]
    ds_read_b64_tr_b16 v[196:197], v211 offset:9216
    ds_read_b64_tr_b16 v[198:199], v211 offset:13312
    v_mov_b32 v165, s92
    v_mfma_f32_32x32x16_bf16 v[144:159], v[204:207], v[16:19], v[144:159]
    ds_read_b64_tr_b16 v[200:201], v212 offset:9216
    ds_read_b64_tr_b16 v[202:203], v212 offset:13312
    buffer_load_dwordx4 v[56:59], v213, s[28:31], s69 offen offset:2048 sc1
    v_add_f32 v160, v160, v161
    s_waitcnt lgkmcnt(2)
    v_mfma_f32_32x32x16_bf16 a[208:223], v[192:195], a[204:207], a[208:223]
    ds_read_b64_tr_b16 v[204:205], v211 offset:10240
    ds_read_b64_tr_b16 v[206:207], v211 offset:14336
    v_add_f32 v162, v162, v163
    v_add_f32 v160, v160, v162
    s_waitcnt vmcnt(9)
    v_mfma_f32_32x32x16_bf16 v[128:143], v[196:199], v[20:23], v[128:143]
    ds_read_b64_tr_b16 v[192:193], v212 offset:10240
    ds_read_b64_tr_b16 v[194:195], v212 offset:14336
    s_cmp_eq_u32 s52, 1
    s_cbranch_scc0 L_safe_16
    buffer_store_dword v160, v164, s[28:31], s94 offen
L_back_17:
    s_waitcnt lgkmcnt(2)
    v_mfma_f32_32x32x16_bf16 v[144:159], v[200:203], v[20:23], v[144:159]
    ds_read_b64_tr_b16 v[196:197], v214 offset:10240
    ds_read_b64_tr_b16 v[198:199], v214 offset:14336
    buffer_load_dwordx4 v[60:63], v213, s[28:31], s69 offen offset:3072 sc1
    s_waitcnt vmcnt(10)
    v_mfma_f32_32x32x16_bf16 v[128:143], v[204:207], v[24:27], v[128:143]
    ds_read_b64_tr_b16 v[200:201], v211 offset:11264
    ds_read_b64_tr_b16 v[202:203], v211 offset:15360
    s_waitcnt lgkmcnt(2)
    v_mfma_f32_32x32x16_bf16 v[144:159], v[192:195], v[24:27], v[144:159]
    ds_read_b64_tr_b16 v[204:205], v212 offset:11264
    ds_read_b64_tr_b16 v[206:207], v212 offset:15360
    buffer_load_dwordx4 v[64:67], v213, s[28:31], s70 offen offset:0 sc1
    v_mfma_f32_32x32x16_bf16 a[208:223], v[196:199], a[204:207], a[208:223]
    v_add_u32 v211, 16384, v211
    ds_read_b64_tr_b16 v[192:193], v211 offset:0
    ds_read_b64_tr_b16 v[194:195], v211 offset:4096
    s_waitcnt vmcnt(10) lgkmcnt(2)
    v_mfma_f32_32x32x16_bf16 v[128:143], v[200:203], v[28:31], v[128:143]
    v_add_u32 v212, 16384, v212
    ds_read_b64_tr_b16 v[196:197], v212 offset:0
    ds_read_b64_tr_b16 v[198:199], v212 offset:4096
    v_mfma_f32_32x32x16_bf16 v[144:159], v[204:207], v[28:31], v[144:159]
    v_add_u32 v214, 16384, v214
    ds_read_b64_tr_b16 v[200:201], v214 offset:0
    ds_read_b64_tr_b16 v[202:203], v214 offset:4096
    buffer_load_dwordx4 v[68:71], v213, s[28:31], s70 offen offset:1024 sc1
    s_waitcnt vmcnt(10) lgkmcnt(2)
    v_mfma_f32_32x32x16_bf16 v[128:143], v[192:195], v[32:35], v[128:143]
    ds_read_b64_tr_b16 v[204:205], v211 offset:1024
    ds_read_b64_tr_b16 v[206:207], v211 offset:5120
    s_lshr_b32 s92, s2, 3
    s_mul_i32 s92, s92, 57344
    v_mfma_f32_32x32x16_bf16 v[144:159], v[196:199], v[32:35], v[144:159]
    s_barrier
    ds_read_b64_tr_b16 v[192:193], v212 offset:1024
    ds_read_b64_tr_b16 v[194:195], v212 offset:5120
    buffer_load_dwordx4 v[72:75], v213, s[28:31], s70 offen offset:2048 sc1
    s_add_u32 s92, s92, 384
    s_cmp_eq_u32 s44, 0
    s_cselect_b32 s92, s92, 2130706432
    s_waitcnt lgkmcnt(2)
    v_mfma_f32_32x32x16_bf16 a[208:223], v[200:203], a[204:207], a[208:223]
    ds_read_b64_tr_b16 v[196:197], v211 offset:2048
    ds_read_b64_tr_b16 v[198:199], v211 offset:6144
    s_add_u32 m0, s77, 98304
    s_add_u32 s95, s76, 128
    buffer_load_dwordx4 v210, s[16:19], s95 offen lds
    v_min_u32 v215, 55, v222
    s_waitcnt vmcnt(11)
    v_mfma_f32_32x32x16_bf16 v[128:143], v[204:207], v[36:39], v[128:143]
    ds_read_b64_tr_b16 v[200:201], v212 offset:2048
    ds_read_b64_tr_b16 v[202:203], v212 offset:6144
    v_mul_u32_u24 v215, 1024, v215
    v_add_u32 v215, s92, v215
    s_waitcnt lgkmcnt(2)
    v_mfma_f32_32x32x16_bf16 v[144:159], v[192:195], v[36:39], v[144:159]
    ds_read_b64_tr_b16 v[204:205], v214 offset:2048
    ds_read_b64_tr_b16 v[206:207], v214 offset:6144
    buffer_load_dwordx4 v[76:79], v213, s[28:31], s70 offen offset:3072 sc1
    s_mov_b32 m0, 162688
    s_nop 0
    buffer_load_dword v215, s[20:23], 0 offen lds
    s_waitcnt vmcnt(12)
    v_mfma_f32_32x32x16_bf16 v[128:143], v[196:199], v[40:43], v[128:143]
    ds_read_b64_tr_b16 v[192:193], v211 offset:3072
    ds_read_b64_tr_b16 v[194:195], v211 offset:7168
    s_add_u32 m0, s77, 102400
    s_add_u32 s95, s76, 114816
    buffer_load_dwordx4 v210, s[16:19], s95 offen lds
    s_waitcnt lgkmcnt(2)
    v_mfma_f32_32x32x16_bf16 v[144:159], v[200:203], v[40:43], v[144:159]
    ds_read_b64_tr_b16 v[196:197], v212 offset:3072
    ds_read_b64_tr_b16 v[198:199], v212 offset:7168
    buffer_load_dwordx4 v[80:83], v213, s[28:31], s71 offen offset:0 sc1
    v_mfma_f32_32x32x16_bf16 a[208:223], v[204:207], a[204:207], a[208:223]
    ds_read_b64_tr_b16 v[200:201], v211 offset:8192
    ds_read_b64_tr_b16 v[202:203], v211 offset:12288
    s_waitcnt vmcnt(13) lgkmcnt(2)
    v_mfma_f32_32x32x16_bf16 v[128:143], v[192:195], v[44:47], v[128:143]
    ds_read_b64_tr_b16 v[204:205], v212 offset:8192
    ds_read_b64_tr_b16 v[206:207], v212 offset:12288
    v_mfma_f32_32x32x16_bf16 v[144:159], v[196:199], v[44:47], v[144:159]
    ds_read_b64_tr_b16 v[192:193], v214 offset:8192
    ds_read_b64_tr_b16 v[194:195], v214 offset:12288
    buffer_load_dwordx4 v[84:87], v213, s[28:31], s71 offen offset:1024 sc1
    s_add_u32 m0, s77, 106496
    s_add_u32 s95, s76, 229504
    buffer_load_dwordx4 v210, s[16:19], s95 offen lds
    s_waitcnt vmcnt(14) lgkmcnt(2)
    v_mfma_f32_32x32x16_bf16 v[128:143], v[200:203], v[48:51], v[128:143]
    ds_read_b64_tr_b16 v[196:197], v211 offset:9216
    ds_read_b64_tr_b16 v[198:199], v211 offset:13312
    s_waitcnt vmcnt(11)
    v_mfma_f32_32x32x16_bf16 v[144:159], v[204:207], v[48:51], v[144:159]
    ds_read_b64_tr_b16 v[200:201], v212 offset:9216
    ds_read_b64_tr_b16 v[202:203], v212 offset:13312
    buffer_load_dwordx4 v[88:91], v213, s[28:31], s71 offen offset:2048 sc1
    s_cmp_eq_u32 s52, 1
    s_cbranch_scc0 L_safe_18
    buffer_store_dword v165, v208, s[28:31], 0 offen
L_back_19:
    s_waitcnt lgkmcnt(2)
    v_mfma_f32_32x32x16_bf16 a[208:223], v[192:195], a[204:207], a[208:223]
    ds_read_b64_tr_b16 v[204:205], v211 offset:10240
    ds_read_b64_tr_b16 v[206:207], v211 offset:14336
    s_add_u32 m0, s77, 110592
    s_add_u32 s95, s76, 344192
    buffer_load_dwordx4 v210, s[16:19], s95 offen lds
    v_mfma_f32_32x32x16_bf16 v[128:143], v[196:199], v[52:55], v[128:143]
    ds_read_b64_tr_b16 v[192:193], v212 offset:10240
    ds_read_b64_tr_b16 v[194:195], v212 offset:14336
    s_waitcnt lgkmcnt(2)
    v_mfma_f32_32x32x16_bf16 v[144:159], v[200:203], v[52:55], v[144:159]
    ds_read_b64_tr_b16 v[196:197], v214 offset:10240
    ds_read_b64_tr_b16 v[198:199], v214 offset:14336
    buffer_load_dwordx4 v[92:95], v213, s[28:31], s71 offen offset:3072 sc1
    v_mfma_f32_32x32x16_bf16 v[128:143], v[204:207], v[56:59], v[128:143]
    ds_read_b64_tr_b16 v[200:201], v211 offset:11264
    ds_read_b64_tr_b16 v[202:203], v211 offset:15360
    s_waitcnt lgkmcnt(2)
    v_mfma_f32_32x32x16_bf16 v[144:159], v[192:195], v[56:59], v[144:159]
    ds_read_b64_tr_b16 v[204:205], v212 offset:11264
    ds_read_b64_tr_b16 v[206:207], v212 offset:15360
    buffer_load_dwordx4 v[96:99], v213, s[28:31], s72 offen offset:0 sc1
    v_mfma_f32_32x32x16_bf16 a[208:223], v[196:199], a[204:207], a[208:223]
    v_subrev_u32 v211, 49152, v211
    ds_read_b64_tr_b16 v[192:193], v211 offset:0
    ds_read_b64_tr_b16 v[194:195], v211 offset:4096
    s_waitcnt vmcnt(15) lgkmcnt(2)
    v_mfma_f32_32x32x16_bf16 v[128:143], v[200:203], v[60:63], v[128:143]
    v_subrev_u32 v212, 49152, v212
    ds_read_b64_tr_b16 v[196:197], v212 offset:0
    ds_read_b64_tr_b16 v[198:199], v212 offset:4096
    v_mfma_f32_32x32x16_bf16 v[144:159], v[204:207], v[60:63], v[144:159]
    v_subrev_u32 v214, 49152, v214
    ds_read_b64_tr_b16 v[200:201], v214 offset:0
    ds_read_b64_tr_b16 v[202:203], v214 offset:4096
    buffer_load_dwordx4 v[100:103], v213, s[28:31], s72 offen offset:1024 sc1
    s_waitcnt vmcnt(15) lgkmcnt(2)
    v_mfma_f32_32x32x16_bf16 v[128:143], v[192:195], v[64:67], v[128:143]
    ds_read_b64_tr_b16 v[204:205], v211 offset:1024
    ds_read_b64_tr_b16 v[206:207], v211 offset:5120
    v_mfma_f32_32x32x16_bf16 v[144:159], v[196:199], v[64:67], v[144:159]
    s_barrier
    ds_read_b64_tr_b16 v[192:193], v212 offset:1024
    ds_read_b64_tr_b16 v[194:195], v212 offset:5120
    buffer_load_dwordx4 v[104:107], v213, s[28:31], s72 offen offset:2048 sc1
    s_waitcnt lgkmcnt(2)
    v_mfma_f32_32x32x16_bf16 a[208:223], v[200:203], a[204:207], a[208:223]
    ds_read_b64_tr_b16 v[196:197], v211 offset:2048
    ds_read_b64_tr_b16 v[198:199], v211 offset:6144
    s_waitcnt vmcnt(15)
    v_mfma_f32_32x32x16_bf16 v[128:143], v[204:207], v[68:71], v[128:143]
    ds_read_b64_tr_b16 v[200:201], v212 offset:2048
    ds_read_b64_tr_b16 v[202:203], v212 offset:6144
    s_waitcnt lgkmcnt(2)
    v_mfma_f32_32x32x16_bf16 v[144:159], v[192:195], v[68:71], v[144:159]
    ds_read_b64_tr_b16 v[204:205], v214 offset:2048
    ds_read_b64_tr_b16 v[206:207], v214 offset:6144
    buffer_load_dwordx4 v[108:111], v213, s[28:31], s72 offen offset:3072 sc1
    s_waitcnt vmcnt(15)
    v_mfma_f32_32x32x16_bf16 v[128:143], v[196:199], v[72:75], v[128:143]
    ds_read_b64_tr_b16 v[192:193], v211 offset:3072
    ds_read_b64_tr_b16 v[194:195], v211 offset:7168
    s_waitcnt lgkmcnt(2)
    v_mfma_f32_32x32x16_bf16 v[144:159], v[200:203], v[72:75], v[144:159]
    ds_read_b64_tr_b16 v[196:197], v212 offset:3072
    ds_read_b64_tr_b16 v[198:199], v212 offset:7168
    buffer_load_dwordx4 v[112:115], v213, s[28:31], s73 offen offset:0 sc1
    v_mfma_f32_32x32x16_bf16 a[208:223], v[204:207], a[204:207], a[208:223]
    ds_read_b64_tr_b16 v[200:201], v211 offset:8192
    ds_read_b64_tr_b16 v[202:203], v211 offset:12288
    s_waitcnt vmcnt(14) lgkmcnt(2)
    v_mfma_f32_32x32x16_bf16 v[128:143], v[192:195], v[76:79], v[128:143]
    ds_read_b64_tr_b16 v[204:205], v212 offset:8192
    ds_read_b64_tr_b16 v[206:207], v212 offset:12288
    buffer_load_dword v168, v209, s[28:31], 0 offen sc1
    v_mfma_f32_32x32x16_bf16 v[144:159], v[196:199], v[76:79], v[144:159]
    ds_read_b64_tr_b16 v[192:193], v214 offset:8192
    ds_read_b64_tr_b16 v[194:195], v214 offset:12288
    buffer_load_dwordx4 v[116:119], v213, s[28:31], s73 offen offset:1024 sc1
    s_waitcnt vmcnt(13) lgkmcnt(2)
    v_mfma_f32_32x32x16_bf16 v[128:143], v[200:203], v[80:83], v[128:143]
    ds_read_b64_tr_b16 v[196:197], v211 offset:9216
    ds_read_b64_tr_b16 v[198:199], v211 offset:13312
    s_add_u32 m0, s78, 131072
    s_add_u32 s95, s88, 0
    buffer_load_dwordx4 v216, s[20:23], s95 offen lds
    v_mfma_f32_32x32x16_bf16 v[144:159], v[204:207], v[80:83], v[144:159]
    ds_read_b64_tr_b16 v[200:201], v212 offset:9216
    ds_read_b64_tr_b16 v[202:203], v212 offset:13312
    buffer_load_dwordx4 v[120:123], v213, s[28:31], s73 offen offset:2048 sc1
    s_waitcnt lgkmcnt(2)
    v_mfma_f32_32x32x16_bf16 a[208:223], v[192:195], a[204:207], a[208:223]
    ds_read_b64_tr_b16 v[204:205], v211 offset:10240
    ds_read_b64_tr_b16 v[206:207], v211 offset:14336
    s_add_u32 m0, s78, 132096
    s_add_u32 s95, s88, 8192
    buffer_load_dwordx4 v216, s[20:23], s95 offen lds
    s_waitcnt vmcnt(15)
    v_mfma_f32_32x32x16_bf16 v[128:143], v[196:199], v[84:87], v[128:143]
    ds_read_b64_tr_b16 v[192:193], v212 offset:10240
    ds_read_b64_tr_b16 v[194:195], v212 offset:14336
    s_add_u32 m0, s78, 133120
    s_add_u32 s95, s88, 16384
    buffer_load_dwordx4 v216, s[20:23], s95 offen lds
    s_waitcnt lgkmcnt(2)
    v_mfma_f32_32x32x16_bf16 v[144:159], v[200:203], v[84:87], v[144:159]
    ds_read_b64_tr_b16 v[196:197], v214 offset:10240
    ds_read_b64_tr_b16 v[198:199], v214 offset:14336
    buffer_load_dwordx4 v[124:127], v213, s[28:31], s73 offen offset:3072 sc1
    s_waitcnt vmcnt(15)
    v_mfma_f32_32x32x16_bf16 v[128:143], v[204:207], v[88:91], v[128:143]
    ds_read_b64_tr_b16 v[200:201], v211 offset:11264
    ds_read_b64_tr_b16 v[202:203], v211 offset:15360
    s_add_u32 m0, s77, 114688
    s_add_u32 s95, s76, 458880
    buffer_load_dwordx4 v210, s[16:19], s95 offen lds
    s_waitcnt lgkmcnt(2)
    v_mfma_f32_32x32x16_bf16 v[144:159], v[192:195], v[88:91], v[144:159]
    ds_read_b64_tr_b16 v[204:205], v212 offset:11264
    ds_read_b64_tr_b16 v[206:207], v212 offset:15360
    s_add_u32 m0, s78, 134144
    s_add_u32 s95, s88, 24576
    buffer_load_dwordx4 v216, s[20:23], s95 offen lds
    v_mfma_f32_32x32x16_bf16 a[208:223], v[196:199], a[204:207], a[208:223]
    v_add_u32 v211, 16384, v211
    ds_read_b64_tr_b16 v[192:193], v211 offset:0
    ds_read_b64_tr_b16 v[194:195], v211 offset:4096
    s_add_u32 m0, s77, 118784
    s_add_u32 s95, s76, 573568
    buffer_load_dwordx4 v210, s[16:19], s95 offen lds
    s_waitcnt vmcnt(15) lgkmcnt(2)
    v_mfma_f32_32x32x16_bf16 v[128:143], v[200:203], v[92:95], v[128:143]
    v_add_u32 v212, 16384, v212
    ds_read_b64_tr_b16 v[196:197], v212 offset:0
    ds_read_b64_tr_b16 v[198:199], v212 offset:4096
    v_mfma_f32_32x32x16_bf16 v[144:159], v[204:207], v[92:95], v[144:159]
    v_add_u32 v214, 16384, v214
    ds_read_b64_tr_b16 v[200:201], v214 offset:0
    ds_read_b64_tr_b16 v[202:203], v214 offset:4096
    s_add_u32 m0, s77, 122880
    s_add_u32 s95, s76, 688256
    buffer_load_dwordx4 v210, s[16:19], s95 offen lds
    s_waitcnt vmcnt(15) lgkmcnt(2)
    v_mfma_f32_32x32x16_bf16 v[128:143], v[192:195], v[96:99], v[128:143]
    ds_read_b64_tr_b16 v[204:205], v211 offset:1024
    ds_read_b64_tr_b16 v[206:207], v211 offset:5120
    s_add_u32 m0, s78, 135168
    s_add_u32 s95, s88, 32768
    buffer_load_dwordx4 v216, s[20:23], s95 offen lds
    v_mfma_f32_32x32x16_bf16 v[144:159], v[196:199], v[96:99], v[144:159]
    s_barrier
    ds_read_b64_tr_b16 v[192:193], v212 offset:1024
    ds_read_b64_tr_b16 v[194:195], v212 offset:5120
    s_add_u32 m0, s77, 126976
    s_add_u32 s95, s76, 802944
    buffer_load_dwordx4 v210, s[16:19], s95 offen lds
    s_waitcnt lgkmcnt(2)
    v_mfma_f32_32x32x16_bf16 a[208:223], v[200:203], a[204:207], a[208:223]
    ds_read_b64_tr_b16 v[196:197], v211 offset:2048
    ds_read_b64_tr_b16 v[198:199], v211 offset:6144
    s_waitcnt vmcnt(16)
    v_mfma_f32_32x32x16_bf16 v[128:143], v[204:207], v[100:103], v[128:143]
    ds_read_b64_tr_b16 v[200:201], v212 offset:2048
    ds_read_b64_tr_b16 v[202:203], v212 offset:6144
    s_add_u32 m0, s77, 65536
    s_add_u32 s95, s76, 917632
    buffer_load_dwordx4 v210, s[16:19], s95 offen lds
    s_waitcnt lgkmcnt(2)
    v_mfma_f32_32x32x16_bf16 v[144:159], v[192:195], v[100:103], v[144:159]
    ds_read_b64_tr_b16 v[204:205], v214 offset:2048
    ds_read_b64_tr_b16 v[206:207], v214 offset:6144
    s_add_u32 m0, s78, 136192
    s_add_u32 s95, s88, 40960
    buffer_load_dwordx4 v216, s[20:23], s95 offen lds
    s_waitcnt vmcnt(17)
    v_mfma_f32_32x32x16_bf16 v[128:143], v[196:199], v[104:107], v[128:143]
    ds_read_b64_tr_b16 v[192:193], v211 offset:3072
    ds_read_b64_tr_b16 v[194:195], v211 offset:7168
    s_add_u32 m0, s77, 69632
    s_add_u32 s95, s76, 1032320
    buffer_load_dwordx4 v210, s[16:19], s95 offen lds
    s_waitcnt lgkmcnt(2)
    v_mfma_f32_32x32x16_bf16 v[144:159], v[200:203], v[104:107], v[144:159]
    ds_read_b64_tr_b16 v[196:197], v212 offset:3072
    ds_read_b64_tr_b16 v[198:199], v212 offset:7168
    v_mfma_f32_32x32x16_bf16 a[208:223], v[204:207], a[204:207], a[208:223]
    ds_read_b64_tr_b16 v[200:201], v211 offset:8192
    ds_read_b64_tr_b16 v[202:203], v211 offset:12288
    s_add_u32 m0, s77, 73728
    s_add_u32 s95, s76, 1147008
    buffer_load_dwordx4 v210, s[16:19], s95 offen lds
    s_waitcnt vmcnt(18) lgkmcnt(2)
    v_mfma_f32_32x32x16_bf16 v[128:143], v[192:195], v[108:111], v[128:143]
    ds_read_b64_tr_b16 v[204:205], v212 offset:8192
    ds_read_b64_tr_b16 v[206:207], v212 offset:12288
    v_lshrrev_b32 v215, 4, v222
    v_and_b32 v213, 15, v222
    v_lshlrev_b32 v213, 4, v213
    v_mfma_f32_32x32x16_bf16 v[144:159], v[196:199], v[108:111], v[144:159]
    ds_read_b64_tr_b16 v[192:193], v214 offset:8192
    ds_read_b64_tr_b16 v[194:195], v214 offset:12288
    s_add_u32 m0, s77, 77824
    s_add_u32 s95, s76, 1261696
    buffer_load_dwordx4 v210, s[16:19], s95 offen lds
    v_lshl_add_u32 v213, v215, 10, v213
    s_waitcnt vmcnt(18) lgkmcnt(2)
    v_mfma_f32_32x32x16_bf16 v[128:143], v[200:203], v[112:115], v[128:143]
    ds_read_b64_tr_b16 v[196:197], v211 offset:9216
    ds_read_b64_tr_b16 v[198:199], v211 offset:13312
    s_lshl_b32 s92, s44, 8
    s_add_u32 s92, s92, 1572864
    v_add_u32 v213, s92, v213
    v_mfma_f32_32x32x16_bf16 v[144:159], v[204:207], v[112:115], v[144:159]
    ds_read_b64_tr_b16 v[200:201], v212 offset:9216
    ds_read_b64_tr_b16 v[202:203], v212 offset:13312
    s_add_u32 s91, s50, 4
    s_waitcnt vmcnt(17)
    v_subrev_u32 v168, s91, v168
    v_cmp_gt_u32 vcc, 32, v168
    s_nop 0
    s_andn2_b64 s[96:97], s[54:55], vcc
    s_cbranch_scc1 L_slow_20
L_pback_21:
    s_waitcnt lgkmcnt(2)
    v_mfma_f32_32x32x16_bf16 a[208:223], v[192:195], a[204:207], a[208:223]
    ds_read_b64_tr_b16 v[204:205], v211 offset:10240
    ds_read_b64_tr_b16 v[206:207], v211 offset:14336
    v_and_b32 v220, 3, v222
    v_bfe_u32 v215, v222, 4, 1
    s_waitcnt vmcnt(16)
    v_mfma_f32_32x32x16_bf16 v[128:143], v[196:199], v[116:119], v[128:143]
    ds_read_b64_tr_b16 v[192:193], v212 offset:10240
    ds_read_b64_tr_b16 v[194:195], v212 offset:14336
    v_lshl_add_u32 v220, v215, 2, v220
    s_lshl_b32 s92, s44, 1
    v_add_u32 v220, s92, v220
    s_waitcnt lgkmcnt(2)
    v_mfma_f32_32x32x16_bf16 v[144:159], v[200:203], v[116:119], v[144:159]
    ds_read_b64_tr_b16 v[196:197], v214 offset:10240
    ds_read_b64_tr_b16 v[198:199], v214 offset:14336
    v_and_b32 v220, 7, v220
    v_lshlrev_b32 v220, 3, v220
    v_bfe_u32 v215, v222, 2, 2
    s_waitcnt vmcnt(14)
    v_mfma_f32_32x32x16_bf16 v[128:143], v[204:207], v[120:123], v[128:143]
    ds_read_b64_tr_b16 v[200:201], v211 offset:11264
    ds_read_b64_tr_b16 v[202:203], v211 offset:15360
    v_lshl_add_u32 v220, v215, 7, v220
    v_bfe_u32 v215, v222, 3, 1
    v_lshl_add_u32 v220, v215, 6, v220
    s_waitcnt lgkmcnt(2)
    v_mfma_f32_32x32x16_bf16 v[144:159], v[192:195], v[120:123], v[144:159]
    ds_read_b64_tr_b16 v[204:205], v212 offset:11264
    ds_read_b64_tr_b16 v[206:207], v212 offset:15360
    v_lshrrev_b32 v215, 5, v222
    v_lshl_add_u32 v220, v215, 9, v220
    v_xor_b32 v209, 64, v220
    s_add_u32 s92, s78, 131072
    v_mfma_f32_32x32x16_bf16 a[208:223], v[196:199], a[204:207], a[208:223]
    s_barrier
    v_add_u32 v211, 16384, v211
    ds_read_b64_tr_b16 v[192:193], v211 offset:0
    ds_read_b64_tr_b16 v[194:195], v211 offset:4096
    s_waitcnt vmcnt(11) lgkmcnt(2)
    v_mfma_f32_32x32x16_bf16 v[128:143], v[200:203], v[124:127], v[128:143]
    v_add_u32 v212, 16384, v212
    ds_read_b64_tr_b16 v[196:197], v212 offset:0
    ds_read_b64_tr_b16 v[198:199], v212 offset:4096
    v_add_u32 v220, s92, v220
    v_add_u32 v209, s92, v209
    v_mfma_f32_32x32x16_bf16 v[144:159], v[204:207], v[124:127], v[144:159]
    v_add_u32 v214, 16384, v214
    ds_read_b64_tr_b16 v[200:201], v214 offset:0
    ds_read_b64_tr_b16 v[202:203], v214 offset:4096
    s_waitcnt lgkmcnt(2)
    v_mfma_f32_32x32x16_bf16 v[160:175], v[192:195], v[0:3], 0
    ds_read_b64_tr_b16 v[204:205], v211 offset:1024
    ds_read_b64_tr_b16 v[206:207], v211 offset:5120
    v_mfma_f32_32x32x16_bf16 v[176:191], v[196:199], v[0:3], 0
    s_barrier
    ds_read_b64_tr_b16 v[192:193], v212 offset:1024
    ds_read_b64_tr_b16 v[194:195], v212 offset:5120
    s_waitcnt lgkmcnt(2)
    v_mfma_f32_32x32x16_bf16 a[184:199], v[200:203], a[204:207], 0
    ds_read_b64_tr_b16 v[196:197], v211 offset:2048
    ds_read_b64_tr_b16 v[198:199], v211 offset:6144
    s_add_u32 m0, s77, 81920
    s_add_u32 s95, s76, 1376384
    buffer_load_dwordx4 v210, s[16:19], s95 offen lds
    v_mfma_f32_32x32x16_bf16 v[160:175], v[204:207], v[4:7], v[160:175]
    ds_read_b64_tr_b16 v[200:201], v212 offset:2048
    ds_read_b64_tr_b16 v[202:203], v212 offset:6144
    s_and_b32 s92, s44, 1
    s_lshl_b32 s92, s92, 7
    s_lshr_b32 s93, s44, 1
    s_mul_i32 s93, s93, 1408
    s_waitcnt lgkmcnt(2)
    v_mfma_f32_32x32x16_bf16 v[176:191], v[192:195], v[4:7], v[176:191]
    ds_read_b64_tr_b16 v[204:205], v214 offset:2048
    ds_read_b64_tr_b16 v[206:207], v214 offset:6144
    s_add_u32 s92, s92, s93
    v_add_u32 v215, s92, v217
    v_mfma_f32_32x32x16_bf16 v[160:175], v[196:199], v[8:11], v[160:175]
    ds_read_b64_tr_b16 v[192:193], v211 offset:3072
    ds_read_b64_tr_b16 v[194:195], v211 offset:7168
    s_add_u32 m0, s77, 86016
    s_add_u32 s95, s76, 1491072
    buffer_load_dwordx4 v210, s[16:19], s95 offen lds
    s_waitcnt lgkmcnt(2)
    v_mfma_f32_32x32x16_bf16 v[176:191], v[200:203], v[8:11], v[176:191]
    ds_read_b64_tr_b16 v[196:197], v212 offset:3072
    ds_read_b64_tr_b16 v[198:199], v212 offset:7168
    buffer_load_dwordx4 v[0:3], v213, s[28:31], s66 offen sc1
    v_mfma_f32_32x32x16_bf16 a[184:199], v[204:207], a[204:207], a[184:199]
    ds_read_b64_tr_b16 v[200:201], v211 offset:8192
    ds_read_b64_tr_b16 v[202:203], v211 offset:12288
    buffer_load_dwordx4 v[4:7], v213, s[28:31], s67 offen sc1
    s_mov_b32 exec_lo, 1
    s_mov_b32 exec_hi, 1
    ds_write_b128 v215, a[208:211] offset:0
    ds_write_b128 v215, a[212:215] offset:32
    ds_write_b128 v215, a[216:219] offset:64
    ds_write_b128 v215, a[220:223] offset:96
    s_mov_b64 exec, -1
    s_waitcnt lgkmcnt(6)
    v_mfma_f32_32x32x16_bf16 v[160:175], v[192:195], v[12:15], v[160:175]
    ds_read_b64_tr_b16 v[204:205], v212 offset:8192
    ds_read_b64_tr_b16 v[206:207], v212 offset:12288
    s_waitcnt lgkmcnt(2)
    s_barrier
    v_mfma_f32_32x32x16_bf16 v[176:191], v[196:199], v[12:15], v[176:191]
    ds_read_b64_tr_b16 v[192:193], v214 offset:8192
    ds_read_b64_tr_b16 v[194:195], v214 offset:12288
    s_add_u32 m0, s77, 90112
    s_add_u32 s95, s76, 1605760
    buffer_load_dwordx4 v210, s[16:19], s95 offen lds
    s_waitcnt lgkmcnt(2)
    v_mfma_f32_32x32x16_bf16 v[160:175], v[200:203], v[16:19], v[160:175]
    ds_read_b64_tr_b16 v[196:197], v211 offset:9216
    ds_read_b64_tr_b16 v[198:199], v211 offset:13312
    s_waitcnt vmcnt(8)
    ds_read_b64_tr_b16 a[0:1], v220 offset:0
    ds_read_b64_tr_b16 a[2:3], v220 offset:1024
    ds_read_b64_tr_b16 a[4:5], v209 offset:0
    v_mfma_f32_32x32x16_bf16 v[176:191], v[204:207], v[16:19], v[176:191]
    ds_read_b64_tr_b16 v[200:201], v212 offset:9216
    ds_read_b64_tr_b16 v[202:203], v212 offset:13312
    ds_read_b64_tr_b16 a[6:7], v209 offset:1024
    ds_read_b64_tr_b16 a[8:9], v220 offset:2048
    ds_read_b64_tr_b16 a[10:11], v220 offset:3072
    ds_read_b64_tr_b16 a[12:13], v209 offset:2048
    ds_read_b64_tr_b16 a[14:15], v209 offset:3072
    s_waitcnt lgkmcnt(10)
    v_mfma_f32_32x32x16_bf16 a[184:199], v[192:195], a[204:207], a[184:199]
    ds_read_b64_tr_b16 v[204:205], v211 offset:10240
    ds_read_b64_tr_b16 v[206:207], v211 offset:14336
    s_add_u32 m0, s77, 94208
    s_add_u32 s95, s76, 1720448
    buffer_load_dwordx4 v210, s[16:19], s95 offen lds
    v_mfma_f32_32x32x16_bf16 v[160:175], v[196:199], v[20:23], v[160:175]
    ds_read_b64_tr_b16 v[192:193], v212 offset:10240
    ds_read_b64_tr_b16 v[194:195], v212 offset:14336
    ds_read_b64_tr_b16 a[16:17], v220 offset:4096
    ds_read_b64_tr_b16 a[18:19], v220 offset:5120
    ds_read_b64_tr_b16 a[20:21], v209 offset:4096
    ds_read_b64_tr_b16 a[22:23], v209 offset:5120
    s_waitcnt lgkmcnt(0)
    v_mfma_f32_32x32x16_bf16 v[176:191], v[200:203], v[20:23], v[176:191]
    ds_read_b64_tr_b16 v[196:197], v214 offset:10240
    ds_read_b64_tr_b16 v[198:199], v214 offset:14336
    s_add_u32 m0, s78, 131072
    s_add_u32 s95, s88, 49152
    buffer_load_dwordx4 v216, s[20:23], s95 offen lds
    v_mfma_f32_32x32x16_bf16 v[160:175], v[204:207], v[24:27], v[160:175]
    ds_read_b64_tr_b16 v[200:201], v211 offset:11264
    ds_read_b64_tr_b16 v[202:203], v211 offset:15360
    s_add_u32 m0, s78, 132096
    s_add_u32 s95, s88, 57344
    buffer_load_dwordx4 v216, s[20:23], s95 offen lds
    s_add_u32 m0, s78, 133120
    s_add_u32 s95, s88, 131072
    buffer_load_dwordx4 v216, s[20:23], s95 offen lds
    s_waitcnt lgkmcnt(2)
    v_mfma_f32_32x32x16_bf16 v[176:191], v[192:195], v[24:27], v[176:191]
    ds_read_b64_tr_b16 v[204:205], v212 offset:11264
    ds_read_b64_tr_b16 v[206:207], v212 offset:15360
    s_add_u32 m0, s78, 134144
    s_add_u32 s95, s88, 139264
    buffer_load_dwordx4 v216, s[20:23], s95 offen lds
    v_mfma_f32_32x32x16_bf16 a[184:199], v[196:199], a[204:207], a[184:199]
    s_barrier
    v_add_u32 v211, 16384, v211
    ds_read_b64_tr_b16 v[192:193], v211 offset:0
    ds_read_b64_tr_b16 v[194:195], v211 offset:4096
    s_waitcnt lgkmcnt(2)
    v_mfma_f32_32x32x16_bf16 v[160:175], v[200:203], v[28:31], v[160:175]
    v_add_u32 v212, 16384, v212
    ds_read_b64_tr_b16 v[196:197], v212 offset:0
    ds_read_b64_tr_b16 v[198:199], v212 offset:4096
    s_add_u32 m0, s78, 135168
    s_add_u32 s95, s88, 147456
    buffer_load_dwordx4 v216, s[20:23], s95 offen lds
    v_mfma_f32_32x32x16_bf16 v[176:191], v[204:207], v[28:31], v[176:191]
    v_add_u32 v214, 16384, v214
    ds_read_b64_tr_b16 v[200:201], v214 offset:0
    ds_read_b64_tr_b16 v[202:203], v214 offset:4096
    s_add_u32 m0, s78, 136192
    s_add_u32 s95, s88, 155648
    buffer_load_dwordx4 v216, s[20:23], s95 offen lds
    s_waitcnt lgkmcnt(2)
    v_mfma_f32_32x32x16_bf16 v[160:175], v[192:195], v[32:35], v[160:175]
    ds_read_b64_tr_b16 v[204:205], v211 offset:1024
    ds_read_b64_tr_b16 v[206:207], v211 offset:5120
    v_mfma_f32_32x32x16_bf16 v[176:191], v[196:199], v[32:35], v[176:191]
    s_barrier
    ds_read_b64_tr_b16 v[192:193], v212 offset:1024
    ds_read_b64_tr_b16 v[194:195], v212 offset:5120
    s_waitcnt lgkmcnt(2)
    v_mfma_f32_32x32x16_bf16 a[184:199], v[200:203], a[204:207], a[184:199]
    ds_read_b64_tr_b16 v[196:197], v211 offset:2048
    ds_read_b64_tr_b16 v[198:199], v211 offset:6144
    s_add_u32 m0, s79, 98304
    s_add_u32 s95, s89, 0
    buffer_load_dwordx4 v216, s[20:23], s95 offen lds
    v_mfma_f32_32x32x16_bf16 v[160:175], v[204:207], v[36:39], v[160:175]
    ds_read_b64_tr_b16 v[200:201], v212 offset:2048
    ds_read_b64_tr_b16 v[202:203], v212 offset:6144
    s_waitcnt lgkmcnt(2)
    v_mfma_f32_32x32x16_bf16 v[176:191], v[192:195], v[36:39], v[176:191]
    ds_read_b64_tr_b16 v[204:205], v214 offset:2048
    ds_read_b64_tr_b16 v[206:207], v214 offset:6144
    v_mfma_f32_32x32x16_bf16 v[160:175], v[196:199], v[40:43], v[160:175]
    ds_read_b64_tr_b16 v[192:193], v211 offset:3072
    ds_read_b64_tr_b16 v[194:195], v211 offset:7168
    s_add_u32 m0, s79, 99328
    s_add_u32 s95, s89, 8192
    buffer_load_dwordx4 v216, s[20:23], s95 offen lds
    s_waitcnt lgkmcnt(2)
    v_mfma_f32_32x32x16_bf16 v[176:191], v[200:203], v[40:43], v[176:191]
    ds_read_b64_tr_b16 v[196:197], v212 offset:3072
    ds_read_b64_tr_b16 v[198:199], v212 offset:7168
    v_mfma_f32_32x32x16_bf16 a[184:199], v[204:207], a[204:207], a[184:199]
    ds_read_b64_tr_b16 v[200:201], v211 offset:8192
    ds_read_b64_tr_b16 v[202:203], v211 offset:12288
    s_waitcnt lgkmcnt(2)
    v_mfma_f32_32x32x16_bf16 v[160:175], v[192:195], v[44:47], v[160:175]
    ds_read_b64_tr_b16 v[204:205], v212 offset:8192
    ds_read_b64_tr_b16 v[206:207], v212 offset:12288
    v_mfma_f32_32x32x16_bf16 v[176:191], v[196:199], v[44:47], v[176:191]
    ds_read_b64_tr_b16 v[192:193], v214 offset:8192
    ds_read_b64_tr_b16 v[194:195], v214 offset:12288
    s_add_u32 m0, s79, 100352
    s_add_u32 s95, s89, 16384
    buffer_load_dwordx4 v216, s[20:23], s95 offen lds
    s_waitcnt lgkmcnt(2)
    v_mfma_f32_32x32x16_bf16 v[160:175], v[200:203], v[48:51], v[160:175]
    ds_read_b64_tr_b16 v[196:197], v211 offset:9216
    ds_read_b64_tr_b16 v[198:199], v211 offset:13312
    v_mfma_f32_32x32x16_bf16 v[176:191], v[204:207], v[48:51], v[176:191]
    ds_read_b64_tr_b16 v[200:201], v212 offset:9216
    ds_read_b64_tr_b16 v[202:203], v212 offset:13312
    s_waitcnt lgkmcnt(2)
    v_mfma_f32_32x32x16_bf16 a[184:199], v[192:195], a[204:207], a[184:199]
    ds_read_b64_tr_b16 v[204:205], v211 offset:10240
    ds_read_b64_tr_b16 v[206:207], v211 offset:14336
    s_add_u32 m0, s79, 101376
    s_add_u32 s95, s89, 24576
    buffer_load_dwordx4 v216, s[20:23], s95 offen lds
    v_mfma_f32_32x32x16_bf16 v[160:175], v[196:199], v[52:55], v[160:175]
    ds_read_b64_tr_b16 v[192:193], v212 offset:10240
    ds_read_b64_tr_b16 v[194:195], v212 offset:14336
    s_waitcnt vmcnt(12)
    v_add_f32 v0, v0, v4
    v_add_f32 v1, v1, v5
    s_waitcnt lgkmcnt(2)
    v_mfma_f32_32x32x16_bf16 v[176:191], v[200:203], v[52:55], v[176:191]
    ds_read_b64_tr_b16 v[196:197], v214 offset:10240
    ds_read_b64_tr_b16 v[198:199], v214 offset:14336
    v_add_f32 v2, v2, v6
    v_add_f32 v3, v3, v7
    v_mfma_f32_32x32x16_bf16 v[160:175], v[204:207], v[56:59], v[160:175]
    ds_read_b64_tr_b16 v[200:201], v211 offset:11264
    ds_read_b64_tr_b16 v[202:203], v211 offset:15360
    v_lshrrev_b32 v215, 4, v222
    v_and_b32 v213, 1, v215
    v_permlane32_swap_b32 v0, v2
    s_waitcnt lgkmcnt(2)
    v_mfma_f32_32x32x16_bf16 v[176:191], v[192:195], v[56:59], v[176:191]
    ds_read_b64_tr_b16 v[204:205], v212 offset:11264
    ds_read_b64_tr_b16 v[206:207], v212 offset:15360
    v_permlane32_swap_b32 v1, v3
    v_lshlrev_b32 v213, 7, v213
    v_mfma_f32_32x32x16_bf16 a[184:199], v[196:199], a[204:207], a[184:199]
    s_barrier
    v_subrev_u32 v211, 49152, v211
    ds_read_b64_tr_b16 v[192:193], v211 offset:0
    ds_read_b64_tr_b16 v[194:195], v211 offset:4096
    s_waitcnt lgkmcnt(2)
    v_mfma_f32_32x32x16_bf16 v[160:175], v[200:203], v[60:63], v[160:175]
    v_subrev_u32 v212, 49152, v212
    ds_read_b64_tr_b16 v[196:197], v212 offset:0
    ds_read_b64_tr_b16 v[198:199], v212 offset:4096
    v_lshrrev_b32 v215, 1, v215
    v_mfma_f32_32x32x16_bf16 v[176:191], v[204:207], v[60:63], v[176:191]
    v_subrev_u32 v214, 49152, v214
    ds_read_b64_tr_b16 v[200:201], v214 offset:0
    ds_read_b64_tr_b16 v[202:203], v214 offset:4096
    v_add_f32 v0, v0, v2
    v_add_f32 v1, v1, v3
    s_waitcnt lgkmcnt(2)
    v_mfma_f32_32x32x16_bf16 v[160:175], v[192:195], v[64:67], v[160:175]
    ds_read_b64_tr_b16 v[204:205], v211 offset:1024
    ds_read_b64_tr_b16 v[206:207], v211 offset:5120
    s_waitcnt vmcnt(4)
    ds_read_b64_tr_b16 a[24:25], v220 offset:0
    ds_read_b64_tr_b16 a[26:27], v220 offset:1024
    ds_read_b64_tr_b16 a[28:29], v209 offset:0
    v_mfma_f32_32x32x16_bf16 v[176:191], v[196:199], v[64:67], v[176:191]
    s_barrier
    ds_read_b64_tr_b16 v[192:193], v212 offset:1024
    ds_read_b64_tr_b16 v[194:195], v212 offset:5120
    ds_read_b64_tr_b16 a[30:31], v209 offset:1024
    ds_read_b64_tr_b16 a[32:33], v220 offset:2048
    ds_read_b64_tr_b16 a[34:35], v220 offset:3072
    ds_read_b64_tr_b16 a[36:37], v209 offset:2048
    s_waitcnt lgkmcnt(9)
    v_mfma_f32_32x32x16_bf16 a[184:199], v[200:203], a[204:207], a[184:199]
    ds_read_b64_tr_b16 v[196:197], v211 offset:2048
    ds_read_b64_tr_b16 v[198:199], v211 offset:6144
    s_add_u32 m0, s79, 114688
    s_add_u32 s95, s89, 32768
    buffer_load_dwordx4 v216, s[20:23], s95 offen lds
    v_mfma_f32_32x32x16_bf16 v[160:175], v[204:207], v[68:71], v[160:175]
    ds_read_b64_tr_b16 v[200:201], v212 offset:2048
    ds_read_b64_tr_b16 v[202:203], v212 offset:6144
    ds_read_b64_tr_b16 a[38:39], v209 offset:3072
    ds_read_b64_tr_b16 a[40:41], v220 offset:4096
    ds_read_b64_tr_b16 a[42:43], v220 offset:5120
    ds_read_b64_tr_b16 a[44:45], v209 offset:4096
    ds_read_b64_tr_b16 a[46:47], v209 offset:5120
    s_waitcnt lgkmcnt(7)
    v_mfma_f32_32x32x16_bf16 v[176:191], v[192:195], v[68:71], v[176:191]
    ds_read_b64_tr_b16 v[204:205], v214 offset:2048
    ds_read_b64_tr_b16 v[206:207], v214 offset:6144
    s_waitcnt lgkmcnt(2)
    s_add_u32 m0, s78, 131072
    s_add_u32 s95, s88, 163840
    buffer_load_dwordx4 v216, s[20:23], s95 offen lds
    v_mfma_f32_32x32x16_bf16 v[160:175], v[196:199], v[72:75], v[160:175]
    ds_read_b64_tr_b16 v[192:193], v211 offset:3072
    ds_read_b64_tr_b16 v[194:195], v211 offset:7168
    s_add_u32 m0, s79, 115712
    s_add_u32 s95, s89, 40960
    buffer_load_dwordx4 v216, s[20:23], s95 offen lds
    s_waitcnt lgkmcnt(2)
    v_mfma_f32_32x32x16_bf16 v[176:191], v[200:203], v[72:75], v[176:191]
    ds_read_b64_tr_b16 v[196:197], v212 offset:3072
    ds_read_b64_tr_b16 v[198:199], v212 offset:7168
    s_add_u32 m0, s78, 132096
    s_add_u32 s95, s88, 172032
    buffer_load_dwordx4 v216, s[20:23], s95 offen lds
    s_add_u32 m0, s78, 133120
    s_add_u32 s95, s88, 180224
    buffer_load_dwordx4 v216, s[20:23], s95 offen lds
    v_mfma_f32_32x32x16_bf16 a[184:199], v[204:207], a[204:207], a[184:199]
    ds_read_b64_tr_b16 v[200:201], v211 offset:8192
    ds_read_b64_tr_b16 v[202:203], v211 offset:12288
    s_add_u32 m0, s78, 134144
    s_add_u32 s95, s88, 188416
    buffer_load_dwordx4 v216, s[20:23], s95 offen lds
    s_waitcnt lgkmcnt(2)
    v_mfma_f32_32x32x16_bf16 v[160:175], v[192:195], v[76:79], v[160:175]
    ds_read_b64_tr_b16 v[204:205], v212 offset:8192
    ds_read_b64_tr_b16 v[206:207], v212 offset:12288
    s_add_u32 m0, s78, 135168
    s_add_u32 s95, s88, 262144
    buffer_load_dwordx4 v216, s[20:23], s95 offen lds
    s_add_u32 m0, s78, 136192
    s_add_u32 s95, s88, 270336
    buffer_load_dwordx4 v216, s[20:23], s95 offen lds
    v_mfma_f32_32x32x16_bf16 v[176:191], v[196:199], v[76:79], v[176:191]
    ds_read_b64_tr_b16 v[192:193], v214 offset:8192
    ds_read_b64_tr_b16 v[194:195], v214 offset:12288
    s_add_u32 m0, s79, 116736
    s_add_u32 s95, s89, 49152
    buffer_load_dwordx4 v216, s[20:23], s95 offen lds
    s_waitcnt lgkmcnt(2)
    v_mfma_f32_32x32x16_bf16 v[160:175], v[200:203], v[80:83], v[160:175]
    ds_read_b64_tr_b16 v[196:197], v211 offset:9216
    ds_read_b64_tr_b16 v[198:199], v211 offset:13312
    v_lshl_add_u32 v213, v215, 2, v213
    v_and_b32 v215, 15, v222
    v_mfma_f32_32x32x16_bf16 v[176:191], v[204:207], v[80:83], v[176:191]
    ds_read_b64_tr_b16 v[200:201], v212 offset:9216
    ds_read_b64_tr_b16 v[202:203], v212 offset:13312
    v_permlane16_swap_b32 v0, v1
    v_lshl_add_u32 v213, v215, 3, v213
    v_add_f32 v0, v0, v1
    s_waitcnt lgkmcnt(2)
    v_mfma_f32_32x32x16_bf16 a[184:199], v[192:195], a[204:207], a[184:199]
    ds_read_b64_tr_b16 v[204:205], v211 offset:10240
    ds_read_b64_tr_b16 v[206:207], v211 offset:14336
    s_add_u32 m0, s79, 117760
    s_add_u32 s95, s89, 57344
    buffer_load_dwordx4 v216, s[20:23], s95 offen lds
    v_mfma_f32_32x32x16_bf16 v[160:175], v[196:199], v[84:87], v[160:175]
    ds_read_b64_tr_b16 v[192:193], v212 offset:10240
    ds_read_b64_tr_b16 v[194:195], v212 offset:14336
    v_add_u32 v213, s90, v213
    ds_write_b32 v213, v0
    v_and_b32 v215, 31, v222
    s_waitcnt lgkmcnt(3)
    v_mfma_f32_32x32x16_bf16 v[176:191], v[200:203], v[84:87], v[176:191]
    ds_read_b64_tr_b16 v[196:197], v214 offset:10240
    ds_read_b64_tr_b16 v[198:199], v214 offset:14336
    v_lshlrev_b32 v215, 2, v215
    v_add_u32 v213, s90, v215
    v_mfma_f32_32x32x16_bf16 v[160:175], v[204:207], v[88:91], v[160:175]
    ds_read_b64_tr_b16 v[200:201], v211 offset:11264
    ds_read_b64_tr_b16 v[202:203], v211 offset:15360
    s_waitcnt lgkmcnt(2)
    v_mfma_f32_32x32x16_bf16 v[176:191], v[192:195], v[88:91], v[176:191]
    ds_read_b64_tr_b16 v[204:205], v212 offset:11264
    ds_read_b64_tr_b16 v[206:207], v212 offset:15360
    ds_read2_b32 v[2:3], v213 offset0:0 offset1:32
    v_mfma_f32_32x32x16_bf16 a[184:199], v[196:199], a[204:207], a[184:199]
    s_barrier
    v_add_u32 v211, 16384, v211
    ds_read_b64_tr_b16 v[192:193], v211 offset:0
    ds_read_b64_tr_b16 v[194:195], v211 offset:4096
    s_waitcnt lgkmcnt(3)
    v_mfma_f32_32x32x16_bf16 v[160:175], v[200:203], v[92:95], v[160:175]
    v_add_u32 v212, 16384, v212
    ds_read_b64_tr_b16 v[196:197], v212 offset:0
    ds_read_b64_tr_b16 v[198:199], v212 offset:4096
    v_lshrrev_b32 v213, 5, v222
    v_mfma_f32_32x32x16_bf16 v[176:191], v[204:207], v[92:95], v[176:191]
    v_add_u32 v214, 16384, v214
    ds_read_b64_tr_b16 v[200:201], v214 offset:0
    ds_read_b64_tr_b16 v[202:203], v214 offset:4096
    v_lshl_add_u32 v215, v213, 9, v215
    v_add_u32 v215, s3, v215
    s_waitcnt lgkmcnt(2)
    v_mfma_f32_32x32x16_bf16 v[160:175], v[192:195], v[96:99], v[160:175]
    ds_read_b64_tr_b16 v[204:205], v211 offset:1024
    ds_read_b64_tr_b16 v[206:207], v211 offset:5120
    v_mul_f32 v218, 0x3b000000, v2
    v_mfma_f32_32x32x16_bf16 v[176:191], v[196:199], v[96:99], v[176:191]
    s_barrier
    ds_read_b64_tr_b16 v[192:193], v212 offset:1024
    ds_read_b64_tr_b16 v[194:195], v212 offset:5120
    v_mul_f32 v3, 0x3b000000, v3
    v_fma_f32 v3, -v218, v218, v3
    s_waitcnt lgkmcnt(2)
    v_mfma_f32_32x32x16_bf16 a[184:199], v[200:203], a[204:207], a[184:199]
    ds_read_b64_tr_b16 v[196:197], v211 offset:2048
    ds_read_b64_tr_b16 v[198:199], v211 offset:6144
    s_add_u32 m0, s79, 65536
    s_add_u32 s95, s88, 65536
    buffer_load_dwordx4 v216, s[20:23], s95 offen lds
    v_mfma_f32_32x32x16_bf16 v[160:175], v[204:207], v[100:103], v[160:175]
    ds_read_b64_tr_b16 v[200:201], v212 offset:2048
    ds_read_b64_tr_b16 v[202:203], v212 offset:6144
    v_max_f32 v3, 0, v3
    v_add_f32 v3, 0x3727c5ac, v3
    v_rsq_f32 v219, v3
    s_waitcnt lgkmcnt(2)
    v_mfma_f32_32x32x16_bf16 v[176:191], v[192:195], v[100:103], v[176:191]
    ds_read_b64_tr_b16 v[204:205], v214 offset:2048
    ds_read_b64_tr_b16 v[206:207], v214 offset:6144
    v_cndmask_b32 v2, v218, v219, s[64:65]
    ds_write_b32 v215, v2
    v_mfma_f32_32x32x16_bf16 v[160:175], v[196:199], v[104:107], v[160:175]
    ds_read_b64_tr_b16 v[192:193], v211 offset:3072
    ds_read_b64_tr_b16 v[194:195], v211 offset:7168
    s_add_u32 m0, s79, 66560
    s_add_u32 s95, s88, 73728
    buffer_load_dwordx4 v216, s[20:23], s95 offen lds
    s_waitcnt lgkmcnt(3)
    v_mfma_f32_32x32x16_bf16 v[176:191], v[200:203], v[104:107], v[176:191]
    ds_read_b64_tr_b16 v[196:197], v212 offset:3072
    ds_read_b64_tr_b16 v[198:199], v212 offset:7168
    s_add_u32 s92, s50, 5
    v_mov_b32 v0, s92
    v_mfma_f32_32x32x16_bf16 a[184:199], v[204:207], a[204:207], a[184:199]
    ds_read_b64_tr_b16 v[200:201], v211 offset:8192
    ds_read_b64_tr_b16 v[202:203], v211 offset:12288
    s_add_u32 s92, s50, 6
    v_mov_b32 v1, s92
    ds_read_b128 v[8:11], v217 offset:1408
    s_waitcnt lgkmcnt(3)
    v_mfma_f32_32x32x16_bf16 v[160:175], v[192:195], v[108:111], v[160:175]
    ds_read_b64_tr_b16 v[204:205], v212 offset:8192
    ds_read_b64_tr_b16 v[206:207], v212 offset:12288
    ds_read_b128 v[12:15], v217 offset:1440
    ds_read_b128 v[16:19], v217 offset:1472
    v_mfma_f32_32x32x16_bf16 v[176:191], v[196:199], v[108:111], v[176:191]
    ds_read_b64_tr_b16 v[192:193], v214 offset:8192
    ds_read_b64_tr_b16 v[194:195], v214 offset:12288
    s_add_u32 m0, s79, 67584
    s_add_u32 s95, s88, 81920
    buffer_load_dwordx4 v216, s[20:23], s95 offen lds
    s_waitcnt lgkmcnt(4)
    v_mfma_f32_32x32x16_bf16 v[160:175], v[200:203], v[112:115], v[160:175]
    ds_read_b64_tr_b16 v[196:197], v211 offset:9216
    ds_read_b64_tr_b16 v[198:199], v211 offset:13312
    s_waitcnt vmcnt(5)
    ds_read_b64_tr_b16 a[48:49], v220 offset:0
    v_mfma_f32_32x32x16_bf16 v[176:191], v[204:207], v[112:115], v[176:191]
    ds_read_b64_tr_b16 v[200:201], v212 offset:9216
    ds_read_b64_tr_b16 v[202:203], v212 offset:13312
    ds_read_b64_tr_b16 a[50:51], v220 offset:1024
    ds_read_b64_tr_b16 a[52:53], v209 offset:0
    ds_read_b64_tr_b16 a[54:55], v209 offset:1024
    ds_read_b64_tr_b16 a[56:57], v220 offset:2048
    s_waitcnt lgkmcnt(7)
    v_mfma_f32_32x32x16_bf16 a[184:199], v[192:195], a[204:207], a[184:199]
    ds_read_b64_tr_b16 v[204:205], v211 offset:10240
    ds_read_b64_tr_b16 v[206:207], v211 offset:14336
    s_add_u32 m0, s79, 68608
    s_add_u32 s95, s88, 90112
    buffer_load_dwordx4 v216, s[20:23], s95 offen lds
    v_mfma_f32_32x32x16_bf16 v[160:175], v[196:199], v[116:119], v[160:175]
    ds_read_b64_tr_b16 v[192:193], v212 offset:10240
    ds_read_b64_tr_b16 v[194:195], v212 offset:14336
    ds_read_b64_tr_b16 a[58:59], v220 offset:3072
    ds_read_b64_tr_b16 a[60:61], v209 offset:2048
    ds_read_b64_tr_b16 a[62:63], v209 offset:3072
    s_waitcnt lgkmcnt(5)
    v_mfma_f32_32x32x16_bf16 v[176:191], v[200:203], v[116:119], v[176:191]
    ds_read_b64_tr_b16 v[196:197], v214 offset:10240
    ds_read_b64_tr_b16 v[198:199], v214 offset:14336
    ds_read_b64_tr_b16 a[64:65], v220 offset:4096
    ds_read_b64_tr_b16 a[66:67], v220 offset:5120
    v_mfma_f32_32x32x16_bf16 v[160:175], v[204:207], v[120:123], v[160:175]
    ds_read_b64_tr_b16 v[200:201], v211 offset:11264
    ds_read_b64_tr_b16 v[202:203], v211 offset:15360
    ds_read_b64_tr_b16 a[68:69], v209 offset:4096
    ds_read_b64_tr_b16 a[70:71], v209 offset:5120
    s_waitcnt lgkmcnt(0)
    v_mfma_f32_32x32x16_bf16 v[176:191], v[192:195], v[120:123], v[176:191]
    ds_read_b64_tr_b16 v[204:205], v212 offset:11264
    ds_read_b64_tr_b16 v[206:207], v212 offset:15360
    s_add_u32 m0, s78, 131072
    s_add_u32 s95, s88, 278528
    buffer_load_dwordx4 v216, s[20:23], s95 offen lds
    v_mfma_f32_32x32x16_bf16 a[184:199], v[196:199], a[204:207], a[184:199]
    s_add_u32 m0, s78, 132096
    s_add_u32 s95, s88, 286720
    buffer_load_dwordx4 v216, s[20:23], s95 offen lds
    s_add_u32 m0, s78, 133120
    s_add_u32 s95, s88, 294912
    buffer_load_dwordx4 v216, s[20:23], s95 offen lds
    s_waitcnt lgkmcnt(0)
    v_mfma_f32_32x32x16_bf16 v[160:175], v[200:203], v[124:127], v[160:175]
    s_add_u32 m0, s78, 134144
    s_add_u32 s95, s88, 303104
    buffer_load_dwordx4 v216, s[20:23], s95 offen lds
    v_mfma_f32_32x32x16_bf16 v[176:191], v[204:207], v[124:127], v[176:191]
    s_add_u32 m0, s78, 135168
    s_add_u32 s95, s88, 311296
    buffer_load_dwordx4 v216, s[20:23], s95 offen lds
    s_add_u32 m0, s78, 136192
    s_add_u32 s95, s88, 319488
    buffer_load_dwordx4 v216, s[20:23], s95 offen lds
    ds_read_b128 v[20:23], v217 offset:1504
    ds_read_b128 v[40:43], v217 offset:0
    ds_read_b128 v[44:47], v217 offset:32
    ds_read_b128 v[48:51], v217 offset:64
    ds_read_b128 v[52:55], v217 offset:96
    s_waitcnt lgkmcnt(4)
    v_fma_f32 v128, -v218, v8, v128
    v_fma_f32 v129, -v218, v9, v129
    v_fma_f32 v130, -v218, v10, v130
    v_fma_f32 v131, -v218, v11, v131
    v_fma_f32 v132, -v218, v12, v132
    v_fma_f32 v133, -v218, v13, v133
    v_fma_f32 v134, -v218, v14, v134
    v_fma_f32 v135, -v218, v15, v135
    v_fma_f32 v136, -v218, v16, v136
    v_fma_f32 v137, -v218, v17, v137
    v_fma_f32 v138, -v218, v18, v138
    v_fma_f32 v139, -v218, v19, v139
    v_fma_f32 v140, -v218, v20, v140
    v_fma_f32 v141, -v218, v21, v141
    v_fma_f32 v142, -v218, v22, v142
    v_fma_f32 v143, -v218, v23, v143
    s_waitcnt lgkmcnt(0)
    v_fma_f32 v128, -v218, v40, v128
    v_fma_f32 v129, -v218, v41, v129
    v_fma_f32 v130, -v218, v42, v130
    v_fma_f32 v131, -v218, v43, v131
    v_fma_f32 v132, -v218, v44, v132
    v_fma_f32 v133, -v218, v45, v133
    v_fma_f32 v134, -v218, v46, v134
    v_fma_f32 v135, -v218, v47, v135
    v_fma_f32 v136, -v218, v48, v136
    v_fma_f32 v137, -v218, v49, v137
    v_fma_f32 v138, -v218, v50, v138
    v_fma_f32 v139, -v218, v51, v139
    v_fma_f32 v140, -v218, v52, v140
    v_fma_f32 v141, -v218, v53, v141
    v_fma_f32 v142, -v218, v54, v142
    v_fma_f32 v143, -v218, v55, v143
    v_cvt_pk_bf16_f32 v8, v128, v129
    v_cvt_pk_bf16_f32 v9, v130, v131
    v_cvt_pk_bf16_f32 v10, v132, v133
    v_cvt_pk_bf16_f32 v11, v134, v135
    v_pk_max_i16 v8, v8, 0
    v_pk_max_i16 v9, v9, 0
    v_pk_max_i16 v10, v10, 0
    v_pk_max_i16 v11, v11, 0
    v_cvt_pk_bf16_f32 v12, v136, v137
    v_cvt_pk_bf16_f32 v13, v138, v139
    v_cvt_pk_bf16_f32 v14, v140, v141
    v_cvt_pk_bf16_f32 v15, v142, v143
    v_pk_max_i16 v12, v12, 0
    v_pk_max_i16 v13, v13, 0
    v_pk_max_i16 v14, v14, 0
    v_pk_max_i16 v15, v15, 0
    buffer_store_dwordx4 v[8:11], v223, s[40:43], s84 offen offset:0 sc1
    buffer_store_dwordx4 v[12:15], v223, s[40:43], s84 offen offset:1024 sc1
    ds_read_b128 v[24:27], v217 offset:1536
    ds_read_b128 v[28:31], v217 offset:1568
    ds_read_b128 v[32:35], v217 offset:1600
    ds_read_b128 v[36:39], v217 offset:1632
    ds_read_b128 v[40:43], v217 offset:128
    ds_read_b128 v[44:47], v217 offset:160
    ds_read_b128 v[48:51], v217 offset:192
    ds_read_b128 v[52:55], v217 offset:224
    s_waitcnt lgkmcnt(4)
    v_fma_f32 v144, -v218, v24, v144
    v_fma_f32 v145, -v218, v25, v145
    v_fma_f32 v146, -v218, v26, v146
    v_fma_f32 v147, -v218, v27, v147
    v_fma_f32 v148, -v218, v28, v148
    v_fma_f32 v149, -v218, v29, v149
    v_fma_f32 v150, -v218, v30, v150
    v_fma_f32 v151, -v218, v31, v151
    v_fma_f32 v152, -v218, v32, v152
    v_fma_f32 v153, -v218, v33, v153
    v_fma_f32 v154, -v218, v34, v154
    v_fma_f32 v155, -v218, v35, v155
    v_fma_f32 v156, -v218, v36, v156
    v_fma_f32 v157, -v218, v37, v157
    v_fma_f32 v158, -v218, v38, v158
    v_fma_f32 v159, -v218, v39, v159
    s_waitcnt lgkmcnt(0)
    v_fma_f32 v144, -v218, v40, v144
    v_fma_f32 v145, -v218, v41, v145
    v_fma_f32 v146, -v218, v42, v146
    v_fma_f32 v147, -v218, v43, v147
    v_fma_f32 v148, -v218, v44, v148
    v_fma_f32 v149, -v218, v45, v149
    v_fma_f32 v150, -v218, v46, v150
    v_fma_f32 v151, -v218, v47, v151
    v_fma_f32 v152, -v218, v48, v152
    v_fma_f32 v153, -v218, v49, v153
    v_fma_f32 v154, -v218, v50, v154
    v_fma_f32 v155, -v218, v51, v155
    v_fma_f32 v156, -v218, v52, v156
    v_fma_f32 v157, -v218, v53, v157
    v_fma_f32 v158, -v218, v54, v158
    v_fma_f32 v159, -v218, v55, v159
    v_cvt_pk_bf16_f32 v24, v144, v145
    v_cvt_pk_bf16_f32 v25, v146, v147
    v_cvt_pk_bf16_f32 v26, v148, v149
    v_cvt_pk_bf16_f32 v27, v150, v151
    v_pk_max_i16 v24, v24, 0
    v_pk_max_i16 v25, v25, 0
    v_pk_max_i16 v26, v26, 0
    v_pk_max_i16 v27, v27, 0
    v_cvt_pk_bf16_f32 v28, v152, v153
    v_cvt_pk_bf16_f32 v29, v154, v155
    v_cvt_pk_bf16_f32 v30, v156, v157
    v_cvt_pk_bf16_f32 v31, v158, v159
    v_pk_max_i16 v28, v28, 0
    v_pk_max_i16 v29, v29, 0
    v_pk_max_i16 v30, v30, 0
    v_pk_max_i16 v31, v31, 0
    buffer_store_dwordx4 v[24:27], v223, s[40:43], s84 offen offset:2048 sc1
    buffer_store_dwordx4 v[28:31], v223, s[40:43], s84 offen offset:3072 sc1
    v_lshlrev_b32 v209, 2, v222
    v_add_u32 v209, 1769472, v209
    s_and_b32 s92, s44, 1
    s_lshl_b32 s92, s92, 7
    s_lshr_b32 s93, s44, 1
    s_mul_i32 s93, s93, 1408
    s_add_u32 s92, s92, s93
    v_add_u32 v215, s92, v217
    s_mov_b32 exec_lo, 1
    s_mov_b32 exec_hi, 1
    ds_write_b128 v215, a[184:187] offset:256
    ds_write_b128 v215, a[188:191] offset:288
    ds_write_b128 v215, a[192:195] offset:320
    ds_write_b128 v215, a[196:199] offset:352
    s_mov_b64 exec, -1
    s_waitcnt lgkmcnt(0)
    s_barrier
    ds_read_b128 v[64:67], v217 offset:1664
    ds_read_b128 v[68:71], v217 offset:1696
    ds_read_b128 v[72:75], v217 offset:1728
    ds_read_b128 v[76:79], v217 offset:1760
    ds_read_b128 v[96:99], v217 offset:256
    ds_read_b128 v[100:103], v217 offset:288
    ds_read_b128 v[104:107], v217 offset:320
    ds_read_b128 v[108:111], v217 offset:352
    s_waitcnt vmcnt(0)
    s_cmp_eq_u32 s52, 1
    s_cbranch_scc0 L_safe_25
    buffer_store_dword v0, v208, s[28:31], 0 offen
L_back_26:
    s_waitcnt lgkmcnt(4)
    v_pk_fma_f32 v[160:161], v[64:65], v[218:219], v[160:161] op_sel_hi:[1,0,1] neg_lo:[0,1,0] neg_hi:[0,1,0]
    v_pk_fma_f32 v[162:163], v[66:67], v[218:219], v[162:163] op_sel_hi:[1,0,1] neg_lo:[0,1,0] neg_hi:[0,1,0]
    v_pk_fma_f32 v[164:165], v[68:69], v[218:219], v[164:165] op_sel_hi:[1,0,1] neg_lo:[0,1,0] neg_hi:[0,1,0]
    v_pk_fma_f32 v[166:167], v[70:71], v[218:219], v[166:167] op_sel_hi:[1,0,1] neg_lo:[0,1,0] neg_hi:[0,1,0]
    v_pk_fma_f32 v[168:169], v[72:73], v[218:219], v[168:169] op_sel_hi:[1,0,1] neg_lo:[0,1,0] neg_hi:[0,1,0]
    v_pk_fma_f32 v[170:171], v[74:75], v[218:219], v[170:171] op_sel_hi:[1,0,1] neg_lo:[0,1,0] neg_hi:[0,1,0]
    v_pk_fma_f32 v[172:173], v[76:77], v[218:219], v[172:173] op_sel_hi:[1,0,1] neg_lo:[0,1,0] neg_hi:[0,1,0]
    v_pk_fma_f32 v[174:175], v[78:79], v[218:219], v[174:175] op_sel_hi:[1,0,1] neg_lo:[0,1,0] neg_hi:[0,1,0]
    s_waitcnt lgkmcnt(0)
    v_pk_fma_f32 v[160:161], v[96:97], v[218:219], v[160:161] op_sel_hi:[1,0,1] neg_lo:[0,1,0] neg_hi:[0,1,0]
    v_pk_fma_f32 v[162:163], v[98:99], v[218:219], v[162:163] op_sel_hi:[1,0,1] neg_lo:[0,1,0] neg_hi:[0,1,0]
    v_pk_fma_f32 v[164:165], v[100:101], v[218:219], v[164:165] op_sel_hi:[1,0,1] neg_lo:[0,1,0] neg_hi:[0,1,0]
    v_pk_fma_f32 v[166:167], v[102:103], v[218:219], v[166:167] op_sel_hi:[1,0,1] neg_lo:[0,1,0] neg_hi:[0,1,0]
    v_pk_fma_f32 v[168:169], v[104:105], v[218:219], v[168:169] op_sel_hi:[1,0,1] neg_lo:[0,1,0] neg_hi:[0,1,0]
    v_pk_fma_f32 v[170:171], v[106:107], v[218:219], v[170:171] op_sel_hi:[1,0,1] neg_lo:[0,1,0] neg_hi:[0,1,0]
    v_pk_fma_f32 v[172:173], v[108:109], v[218:219], v[172:173] op_sel_hi:[1,0,1] neg_lo:[0,1,0] neg_hi:[0,1,0]
    v_pk_fma_f32 v[174:175], v[110:111], v[218:219], v[174:175] op_sel_hi:[1,0,1] neg_lo:[0,1,0] neg_hi:[0,1,0]
    v_cvt_pk_bf16_f32 v64, v160, v161
    v_cvt_pk_bf16_f32 v65, v162, v163
    v_cvt_pk_bf16_f32 v66, v164, v165
    v_cvt_pk_bf16_f32 v67, v166, v167
    v_pk_max_i16 v64, v64, 0
    v_pk_max_i16 v65, v65, 0
    v_pk_max_i16 v66, v66, 0
    v_pk_max_i16 v67, v67, 0
    v_cvt_pk_bf16_f32 v68, v168, v169
    v_cvt_pk_bf16_f32 v69, v170, v171
    v_cvt_pk_bf16_f32 v70, v172, v173
    v_cvt_pk_bf16_f32 v71, v174, v175
    v_pk_max_i16 v68, v68, 0
    v_pk_max_i16 v69, v69, 0
    v_pk_max_i16 v70, v70, 0
    v_pk_max_i16 v71, v71, 0
    buffer_store_dwordx4 v[64:67], v223, s[40:43], s85 offen offset:0 sc1
    buffer_store_dwordx4 v[68:71], v223, s[40:43], s85 offen offset:1024 sc1
    ds_read_b128 v[80:83], v217 offset:1792
    ds_read_b128 v[84:87], v217 offset:1824
    ds_read_b128 v[88:91], v217 offset:1856
    ds_read_b128 v[92:95], v217 offset:1888
    ds_read_b128 v[96:99], v217 offset:384
    ds_read_b128 v[100:103], v217 offset:416
    ds_read_b128 v[104:107], v217 offset:448
    ds_read_b128 v[108:111], v217 offset:480
    s_waitcnt lgkmcnt(4)
    v_pk_fma_f32 v[176:177], v[80:81], v[218:219], v[176:177] op_sel_hi:[1,0,1] neg_lo:[0,1,0] neg_hi:[0,1,0]
    v_pk_fma_f32 v[178:179], v[82:83], v[218:219], v[178:179] op_sel_hi:[1,0,1] neg_lo:[0,1,0] neg_hi:[0,1,0]
    v_pk_fma_f32 v[180:181], v[84:85], v[218:219], v[180:181] op_sel_hi:[1,0,1] neg_lo:[0,1,0] neg_hi:[0,1,0]
    v_pk_fma_f32 v[182:183], v[86:87], v[218:219], v[182:183] op_sel_hi:[1,0,1] neg_lo:[0,1,0] neg_hi:[0,1,0]
    v_pk_fma_f32 v[184:185], v[88:89], v[218:219], v[184:185] op_sel_hi:[1,0,1] neg_lo:[0,1,0] neg_hi:[0,1,0]
    v_pk_fma_f32 v[186:187], v[90:91], v[218:219], v[186:187] op_sel_hi:[1,0,1] neg_lo:[0,1,0] neg_hi:[0,1,0]
    v_pk_fma_f32 v[188:189], v[92:93], v[218:219], v[188:189] op_sel_hi:[1,0,1] neg_lo:[0,1,0] neg_hi:[0,1,0]
    v_pk_fma_f32 v[190:191], v[94:95], v[218:219], v[190:191] op_sel_hi:[1,0,1] neg_lo:[0,1,0] neg_hi:[0,1,0]
    s_waitcnt lgkmcnt(0)
    v_pk_fma_f32 v[176:177], v[96:97], v[218:219], v[176:177] op_sel_hi:[1,0,1] neg_lo:[0,1,0] neg_hi:[0,1,0]
    v_pk_fma_f32 v[178:179], v[98:99], v[218:219], v[178:179] op_sel_hi:[1,0,1] neg_lo:[0,1,0] neg_hi:[0,1,0]
    v_pk_fma_f32 v[180:181], v[100:101], v[218:219], v[180:181] op_sel_hi:[1,0,1] neg_lo:[0,1,0] neg_hi:[0,1,0]
    v_pk_fma_f32 v[182:183], v[102:103], v[218:219], v[182:183] op_sel_hi:[1,0,1] neg_lo:[0,1,0] neg_hi:[0,1,0]
    v_pk_fma_f32 v[184:185], v[104:105], v[218:219], v[184:185] op_sel_hi:[1,0,1] neg_lo:[0,1,0] neg_hi:[0,1,0]
    v_pk_fma_f32 v[186:187], v[106:107], v[218:219], v[186:187] op_sel_hi:[1,0,1] neg_lo:[0,1,0] neg_hi:[0,1,0]
    v_pk_fma_f32 v[188:189], v[108:109], v[218:219], v[188:189] op_sel_hi:[1,0,1] neg_lo:[0,1,0] neg_hi:[0,1,0]
    v_pk_fma_f32 v[190:191], v[110:111], v[218:219], v[190:191] op_sel_hi:[1,0,1] neg_lo:[0,1,0] neg_hi:[0,1,0]
    v_cvt_pk_bf16_f32 v80, v176, v177
    v_cvt_pk_bf16_f32 v81, v178, v179
    v_cvt_pk_bf16_f32 v82, v180, v181
    v_cvt_pk_bf16_f32 v83, v182, v183
    v_pk_max_i16 v80, v80, 0
    v_pk_max_i16 v81, v81, 0
    v_pk_max_i16 v82, v82, 0
    v_pk_max_i16 v83, v83, 0
    v_cvt_pk_bf16_f32 v84, v184, v185
    v_cvt_pk_bf16_f32 v85, v186, v187
    v_cvt_pk_bf16_f32 v86, v188, v189
    v_cvt_pk_bf16_f32 v87, v190, v191
    v_pk_max_i16 v84, v84, 0
    v_pk_max_i16 v85, v85, 0
    v_pk_max_i16 v86, v86, 0
    v_pk_max_i16 v87, v87, 0
    buffer_store_dwordx4 v[80:83], v223, s[40:43], s85 offen offset:2048 sc1
    buffer_store_dwordx4 v[84:87], v223, s[40:43], s85 offen offset:3072 sc1
    s_lshl_b32 s92, s46, 2
    s_add_u32 s92, s92, s44
    s_lshl_b32 s93, s47, 6
    s_add_u32 s93, s93, s92
    s_lshl_b32 s84, s93, 10
    s_lshl_b32 s93, s92, 10
    s_lshl_b32 s94, s47, 9
    s_add_u32 s85, s93, s94
    s_lshl_b32 s86, s92, 6
    s_mov_b32 s87, s93
    s_add_u32 s92, s84, 0
    s_add_u32 s93, s92, 32768
    buffer_load_dwordx4 v[176:179], v223, s[28:31], s92 offen sc1
    buffer_load_dwordx4 v[180:183], v223, s[28:31], s93 offen sc1
    v_and_b32 v184, 31, v222
    v_lshrrev_b32 v185, 5, v222
    v_lshlrev_b32 v215, 3, v184
    v_lshl_add_u32 v215, v185, 2, v215
    s_lshl_b32 s92, s47, 8
    s_add_u32 s92, s92, 163200
    v_lshlrev_b32 v188, 2, v184
    v_add_u32 v188, s92, v188
    s_mul_i32 s92, s44, 28
    s_and_b32 s93, s44, 1
    s_lshl_b32 s94, s93, 2
    s_add_u32 s94, s94, s92
    s_xor_b32 s93, s93, 1
    s_mul_i32 s93, s93, 24
    s_add_u32 s93, s93, s92
    s_mul_i32 s92, s47, 224
    s_add_u32 s94, s94, s92
    s_add_u32 s93, s93, s92
    s_lshl_b32 s94, s94, 10
    s_lshl_b32 s93, s93, 10
    s_add_u32 s94, s94, 262144
    s_add_u32 s93, s93, 262144
    v_add_u32 v217, s94, v223
    v_add_u32 v220, 114688, v217
    v_add_u32 v140, s93, v223
    v_add_u32 v141, 114688, v140
    s_waitcnt vmcnt(2)
    s_cmp_eq_u32 s52, 1
    s_cbranch_scc0 L_safe_27
    buffer_store_dword v1, v208, s[28:31], 0 offen
L_back_28:
    s_barrier
    s_add_u32 m0, s79, 81920
    s_add_u32 s95, s88, 98304
    buffer_load_dwordx4 v216, s[20:23], s95 offen lds
    s_add_u32 m0, s79, 82944
    s_add_u32 s95, s88, 106496
    buffer_load_dwordx4 v216, s[20:23], s95 offen lds
    s_add_u32 m0, s79, 83968
    s_add_u32 s95, s88, 114688
    buffer_load_dwordx4 v216, s[20:23], s95 offen lds
    s_add_u32 m0, s79, 84992
    s_add_u32 s95, s88, 122880
    buffer_load_dwordx4 v216, s[20:23], s95 offen lds
    v_and_b32 v128, 3, v222
    v_bfe_u32 v130, v222, 4, 1
    v_lshl_add_u32 v128, v130, 2, v128
    s_lshl_b32 s92, s44, 1
    v_add_u32 v128, s92, v128
    v_and_b32 v128, 7, v128
    v_lshlrev_b32 v128, 3, v128
    v_bfe_u32 v130, v222, 2, 2
    v_lshl_add_u32 v128, v130, 7, v128
    v_bfe_u32 v130, v222, 3, 1
    v_lshl_add_u32 v128, v130, 6, v128
    v_lshrrev_b32 v130, 5, v222
    v_lshl_add_u32 v128, v130, 9, v128
    v_xor_b32 v129, 64, v128
    s_add_u32 s92, s79, 98304
    v_add_u32 v132, s92, v128
    v_add_u32 v133, s92, v129
    ds_read_b64_tr_b16 a[96:97], v132 offset:0
    ds_read_b64_tr_b16 a[98:99], v132 offset:1024
    ds_read_b64_tr_b16 a[100:101], v133 offset:0
    ds_read_b64_tr_b16 a[102:103], v133 offset:1024
    ds_read_b64_tr_b16 a[104:105], v132 offset:2048
    ds_read_b64_tr_b16 a[106:107], v132 offset:3072
    ds_read_b64_tr_b16 a[108:109], v133 offset:2048
    ds_read_b64_tr_b16 a[110:111], v133 offset:3072
    s_waitcnt lgkmcnt(0)
    s_add_u32 m0, s79, 98304
    s_add_u32 s95, s88, 196608
    buffer_load_dwordx4 v216, s[20:23], s95 offen lds
    s_add_u32 m0, s79, 99328
    s_add_u32 s95, s88, 204800
    buffer_load_dwordx4 v216, s[20:23], s95 offen lds
    s_add_u32 m0, s79, 100352
    s_add_u32 s95, s88, 212992
    buffer_load_dwordx4 v216, s[20:23], s95 offen lds
    s_add_u32 m0, s79, 101376
    s_add_u32 s95, s88, 221184
    buffer_load_dwordx4 v216, s[20:23], s95 offen lds
    s_add_u32 s92, s79, 114688
    v_add_u32 v132, s92, v128
    v_add_u32 v133, s92, v129
    ds_read_b64_tr_b16 a[112:113], v132 offset:0
    ds_read_b64_tr_b16 a[114:115], v132 offset:1024
    ds_read_b64_tr_b16 a[116:117], v133 offset:0
    ds_read_b64_tr_b16 a[118:119], v133 offset:1024
    ds_read_b64_tr_b16 a[120:121], v132 offset:2048
    ds_read_b64_tr_b16 a[122:123], v132 offset:3072
    ds_read_b64_tr_b16 a[124:125], v133 offset:2048
    ds_read_b64_tr_b16 a[126:127], v133 offset:3072
    s_waitcnt lgkmcnt(0)
    s_add_u32 m0, s79, 114688
    s_add_u32 s95, s88, 229376
    buffer_load_dwordx4 v216, s[20:23], s95 offen lds
    s_add_u32 m0, s79, 115712
    s_add_u32 s95, s88, 237568
    buffer_load_dwordx4 v216, s[20:23], s95 offen lds
    s_add_u32 m0, s79, 116736
    s_add_u32 s95, s88, 245760
    buffer_load_dwordx4 v216, s[20:23], s95 offen lds
    s_add_u32 m0, s79, 117760
    s_add_u32 s95, s88, 253952
    buffer_load_dwordx4 v216, s[20:23], s95 offen lds
    s_add_u32 s92, s79, 65536
    v_add_u32 v132, s92, v128
    v_add_u32 v133, s92, v129
    ds_read_b64_tr_b16 a[128:129], v132 offset:0
    ds_read_b64_tr_b16 a[130:131], v132 offset:1024
    ds_read_b64_tr_b16 a[132:133], v133 offset:0
    ds_read_b64_tr_b16 a[134:135], v133 offset:1024
    ds_read_b64_tr_b16 a[136:137], v132 offset:2048
    ds_read_b64_tr_b16 a[138:139], v132 offset:3072
    ds_read_b64_tr_b16 a[140:141], v133 offset:2048
    ds_read_b64_tr_b16 a[142:143], v133 offset:3072
    s_waitcnt lgkmcnt(0)
    s_add_u32 m0, s79, 65536
    s_add_u32 s95, s88, 327680
    buffer_load_dwordx4 v216, s[20:23], s95 offen lds
    s_add_u32 m0, s79, 66560
    s_add_u32 s95, s88, 335872
    buffer_load_dwordx4 v216, s[20:23], s95 offen lds
    s_add_u32 m0, s79, 67584
    s_add_u32 s95, s88, 344064
    buffer_load_dwordx4 v216, s[20:23], s95 offen lds
    s_add_u32 m0, s79, 68608
    s_add_u32 s95, s88, 352256
    buffer_load_dwordx4 v216, s[20:23], s95 offen lds
    s_add_u32 s92, s78, 131072
    v_add_u32 v132, s92, v128
    v_add_u32 v133, s92, v129
    ds_read_b64_tr_b16 a[72:73], v132 offset:0
    ds_read_b64_tr_b16 a[74:75], v132 offset:1024
    ds_read_b64_tr_b16 a[76:77], v133 offset:0
    ds_read_b64_tr_b16 a[78:79], v133 offset:1024
    ds_read_b64_tr_b16 a[80:81], v132 offset:2048
    ds_read_b64_tr_b16 a[82:83], v132 offset:3072
    ds_read_b64_tr_b16 a[84:85], v133 offset:2048
    ds_read_b64_tr_b16 a[86:87], v133 offset:3072
    ds_read_b64_tr_b16 a[88:89], v132 offset:4096
    ds_read_b64_tr_b16 a[90:91], v132 offset:5120
    ds_read_b64_tr_b16 a[92:93], v133 offset:4096
    ds_read_b64_tr_b16 a[94:95], v133 offset:5120
    s_waitcnt lgkmcnt(0)
    s_add_u32 m0, s78, 131072
    s_add_u32 s95, s88, 360448
    buffer_load_dwordx4 v216, s[20:23], s95 offen lds
    s_add_u32 m0, s78, 132096
    s_add_u32 s95, s88, 368640
    buffer_load_dwordx4 v216, s[20:23], s95 offen lds
    s_add_u32 m0, s78, 133120
    s_add_u32 s95, s88, 376832
    buffer_load_dwordx4 v216, s[20:23], s95 offen lds
    s_add_u32 m0, s78, 134144
    s_add_u32 s95, s88, 385024
    buffer_load_dwordx4 v216, s[20:23], s95 offen lds
    v_lshlrev_b32 v136, 3, v222
    v_add_u32 v136, 159744, v136
    ds_read_b64 v[138:139], v136
    ds_read_b64 v[142:143], v136 offset:1408
    s_waitcnt lgkmcnt(0)
    v_pk_add_f32 v[138:139], v[138:139], v[142:143]
    s_barrier
    ds_write_b64 v136, v[138:139] offset:1408
    s_add_u32 s92, s79, 81920
    v_add_u32 v132, s92, v128
    v_add_u32 v133, s92, v129
    s_waitcnt vmcnt(16)
    ds_read_b64_tr_b16 a[144:145], v132 offset:0
    ds_read_b64_tr_b16 a[146:147], v132 offset:1024
    ds_read_b64_tr_b16 a[148:149], v133 offset:0
    ds_read_b64_tr_b16 a[150:151], v133 offset:1024
    ds_read_b64_tr_b16 a[152:153], v132 offset:2048
    ds_read_b64_tr_b16 a[154:155], v132 offset:3072
    ds_read_b64_tr_b16 a[156:157], v133 offset:2048
    ds_read_b64_tr_b16 a[158:159], v133 offset:3072
    s_add_u32 s92, s79, 98304
    v_add_u32 v132, s92, v128
    v_add_u32 v133, s92, v129
    s_waitcnt vmcnt(12)
    ds_read_b64_tr_b16 a[160:161], v132 offset:0
    ds_read_b64_tr_b16 a[162:163], v132 offset:1024
    ds_read_b64_tr_b16 a[164:165], v133 offset:0
    ds_read_b64_tr_b16 a[166:167], v133 offset:1024
    ds_read_b64_tr_b16 a[168:169], v132 offset:2048
    ds_read_b64_tr_b16 a[170:171], v132 offset:3072
    ds_read_b64_tr_b16 a[172:173], v133 offset:2048
    ds_read_b64_tr_b16 a[174:175], v133 offset:3072
    s_add_u32 s92, s79, 114688
    v_add_u32 v132, s92, v128
    v_add_u32 v133, s92, v129
    s_waitcnt vmcnt(8)
    ds_read_b64_tr_b16 a[176:177], v132 offset:0
    ds_read_b64_tr_b16 a[178:179], v132 offset:1024
    ds_read_b64_tr_b16 a[180:181], v133 offset:0
    ds_read_b64_tr_b16 a[182:183], v133 offset:1024
    ds_read_b64_tr_b16 a[184:185], v132 offset:2048
    ds_read_b64_tr_b16 a[186:187], v132 offset:3072
    ds_read_b64_tr_b16 a[188:189], v133 offset:2048
    ds_read_b64_tr_b16 a[190:191], v133 offset:3072
    s_add_u32 s92, s79, 65536
    v_add_u32 v132, s92, v128
    v_add_u32 v133, s92, v129
    s_waitcnt vmcnt(4)
    ds_read_b64_tr_b16 a[192:193], v132 offset:0
    ds_read_b64_tr_b16 a[194:195], v132 offset:1024
    ds_read_b64_tr_b16 a[196:197], v133 offset:0
    ds_read_b64_tr_b16 a[198:199], v133 offset:1024
    ds_read_b64_tr_b16 a[200:201], v132 offset:2048
    ds_read_b64_tr_b16 a[202:203], v132 offset:3072
    ds_read_b64_tr_b16 a[204:205], v133 offset:2048
    ds_read_b64_tr_b16 a[206:207], v133 offset:3072
    s_add_u32 s92, s78, 131072
    v_add_u32 v132, s92, v128
    v_add_u32 v133, s92, v129
    s_waitcnt vmcnt(0)
    ds_read_b64_tr_b16 a[208:209], v132 offset:0
    ds_read_b64_tr_b16 a[210:211], v132 offset:1024
    ds_read_b64_tr_b16 a[212:213], v133 offset:0
    ds_read_b64_tr_b16 a[214:215], v133 offset:1024
    ds_read_b64_tr_b16 a[216:217], v132 offset:2048
    ds_read_b64_tr_b16 a[218:219], v132 offset:3072
    ds_read_b64_tr_b16 a[220:221], v133 offset:2048
    ds_read_b64_tr_b16 a[222:223], v133 offset:3072
    s_waitcnt lgkmcnt(0)
    s_barrier
    ds_read2_b32 v[218:219], v188 offset0:0 offset1:32
    s_lshl_b32 s92, s44, 8
    s_add_u32 s92, s92, 157696
    v_lshlrev_b32 v156, 2, v222
    v_add_u32 v156, s92, v156
    s_add_u32 s92, s44, 0
    s_and_b32 s92, s92, 3
    s_mul_i32 s93, s92, 6144
    s_add_u32 s93, s93, 131072
    v_add_u32 v214, s93, v223
    s_lshr_b32 s93, s92, 1
    s_mul_i32 s93, s93, 0
    s_add_u32 s93, s93, 4294934528
    v_add_u32 v155, s93, v214
    s_add_u32 s92, s44, 1
    s_and_b32 s92, s92, 3
    s_mul_i32 s93, s92, 6144
    s_add_u32 s93, s93, 131072
    v_add_u32 v211, s93, v223
    s_lshr_b32 s93, s92, 1
    s_mul_i32 s93, s93, 0
    s_add_u32 s93, s93, 4294934528
    v_add_u32 v152, s93, v211
    s_add_u32 s92, s44, 2
    s_and_b32 s92, s92, 3
    s_mul_i32 s93, s92, 6144
    s_add_u32 s93, s93, 133120
    v_add_u32 v212, s93, v223
    s_lshr_b32 s93, s92, 1
    s_mul_i32 s93, s93, 0
    s_add_u32 s93, s93, 4294934528
    v_add_u32 v153, s93, v212
    s_add_u32 s92, s44, 3
    s_and_b32 s92, s92, 3
    s_mul_i32 s93, s92, 6144
    s_add_u32 s93, s93, 135168
    v_add_u32 v213, s93, v223
    s_lshr_b32 s93, s92, 1
    s_mul_i32 s93, s93, 0
    s_add_u32 s93, s93, 4294934528
    v_add_u32 v154, s93, v213
    s_add_u32 s91, s50, 5
L_poll_29:
    buffer_load_dword v184, v209, s[28:31], 0 offen sc1
    s_waitcnt vmcnt(0)
    v_subrev_u32 v184, s91, v184
    v_cmp_gt_u32 vcc, 32, v184
    s_nop 0
    s_andn2_b64 s[96:97], s[58:59], vcc
    s_cbranch_scc1 L_chk_30
L_done_31:
    buffer_load_dwordx4 v[64:67], v220, s[28:31], s66 offen offset:0 sc1
    buffer_load_dwordx4 v[68:71], v220, s[28:31], s66 offen offset:1024 sc1
    buffer_load_dwordx4 v[72:75], v220, s[28:31], s66 offen offset:2048 sc1
    buffer_load_dwordx4 v[76:79], v220, s[28:31], s66 offen offset:3072 sc1
    buffer_load_dwordx4 v[80:83], v220, s[28:31], s68 offen offset:0 sc1
    buffer_load_dwordx4 v[84:87], v220, s[28:31], s68 offen offset:1024 sc1
    buffer_load_dwordx4 v[88:91], v220, s[28:31], s68 offen offset:2048 sc1
    buffer_load_dwordx4 v[92:95], v220, s[28:31], s68 offen offset:3072 sc1
    buffer_load_dwordx4 v[96:99], v220, s[28:31], s70 offen offset:0 sc1
    buffer_load_dwordx4 v[100:103], v220, s[28:31], s70 offen offset:1024 sc1
    buffer_load_dwordx4 v[104:107], v220, s[28:31], s70 offen offset:2048 sc1
    buffer_load_dwordx4 v[108:111], v220, s[28:31], s70 offen offset:3072 sc1
    buffer_load_dword v184, v209, s[28:31], 0 offen sc1
    v_lshlrev_b32 v160, 16, v176
    v_and_b32 v161, 0xffff0000, v176
    v_lshlrev_b32 v162, 16, v177
    v_and_b32 v163, 0xffff0000, v177
    v_lshlrev_b32 v164, 16, v178
    v_and_b32 v165, 0xffff0000, v178
    v_lshlrev_b32 v166, 16, v179
    v_and_b32 v167, 0xffff0000, v179
    v_lshlrev_b32 v168, 16, v180
    v_and_b32 v169, 0xffff0000, v180
    v_lshlrev_b32 v170, 16, v181
    v_and_b32 v171, 0xffff0000, v181
    v_lshlrev_b32 v172, 16, v182
    v_and_b32 v173, 0xffff0000, v182
    v_lshlrev_b32 v174, 16, v183
    v_and_b32 v175, 0xffff0000, v183
    s_waitcnt vmcnt(12) lgkmcnt(0)
    v_mfma_f32_32x32x16_bf16 v[32:47], a[0:3], v[64:67], 0
    v_mfma_f32_32x32x16_bf16 v[48:63], a[4:7], v[64:67], 0
    buffer_load_dwordx4 v[112:115], v217, s[28:31], s66 offen offset:0 sc1
    s_waitcnt vmcnt(12)
    v_mfma_f32_32x32x16_bf16 v[32:47], a[8:11], v[68:71], v[32:47]
    v_mfma_f32_32x32x16_bf16 v[48:63], a[12:15], v[68:71], v[48:63]
    buffer_load_dwordx4 v[116:119], v217, s[28:31], s66 offen offset:1024 sc1
    s_waitcnt vmcnt(12)
    v_mfma_f32_32x32x16_bf16 v[32:47], a[16:19], v[72:75], v[32:47]
    v_mfma_f32_32x32x16_bf16 v[48:63], a[20:23], v[72:75], v[48:63]
    buffer_load_dwordx4 v[120:123], v217, s[28:31], s66 offen offset:2048 sc1
    s_waitcnt vmcnt(12)
    v_mfma_f32_32x32x16_bf16 v[32:47], a[24:27], v[76:79], v[32:47]
    v_mfma_f32_32x32x16_bf16 v[48:63], a[28:31], v[76:79], v[48:63]
    buffer_load_dwordx4 v[124:127], v217, s[28:31], s66 offen offset:3072 sc1
    s_waitcnt vmcnt(12)
    v_mfma_f32_32x32x16_bf16 v[32:47], a[32:35], v[80:83], v[32:47]
    v_mfma_f32_32x32x16_bf16 v[48:63], a[36:39], v[80:83], v[48:63]
    buffer_load_dwordx4 v[64:67], v217, s[28:31], s68 offen offset:0 sc1
    s_waitcnt vmcnt(12)
    v_mfma_f32_32x32x16_bf16 v[32:47], a[40:43], v[84:87], v[32:47]
    v_mfma_f32_32x32x16_bf16 v[48:63], a[44:47], v[84:87], v[48:63]
    buffer_load_dwordx4 v[68:71], v217, s[28:31], s68 offen offset:1024 sc1
    s_waitcnt vmcnt(12)
    v_mfma_f32_32x32x16_bf16 v[32:47], a[48:51], v[88:91], v[32:47]
    v_mfma_f32_32x32x16_bf16 v[48:63], a[52:55], v[88:91], v[48:63]
    buffer_load_dwordx4 v[72:75], v217, s[28:31], s68 offen offset:2048 sc1
    s_waitcnt vmcnt(12)
    v_mfma_f32_32x32x16_bf16 v[32:47], a[56:59], v[92:95], v[32:47]
    v_mfma_f32_32x32x16_bf16 v[48:63], a[60:63], v[92:95], v[48:63]
    buffer_load_dwordx4 v[76:79], v217, s[28:31], s68 offen offset:3072 sc1
    s_waitcnt vmcnt(12)
    v_mfma_f32_32x32x16_bf16 v[32:47], a[64:67], v[96:99], v[32:47]
    v_mfma_f32_32x32x16_bf16 v[48:63], a[68:71], v[96:99], v[48:63]
    buffer_load_dwordx4 v[80:83], v217, s[28:31], s70 offen offset:0 sc1
    s_waitcnt vmcnt(12)
    v_mfma_f32_32x32x16_bf16 v[32:47], a[72:75], v[100:103], v[32:47]
    v_mfma_f32_32x32x16_bf16 v[48:63], a[76:79], v[100:103], v[48:63]
    buffer_load_dwordx4 v[84:87], v217, s[28:31], s70 offen offset:1024 sc1
    s_waitcnt vmcnt(12)
    v_mfma_f32_32x32x16_bf16 v[32:47], a[80:83], v[104:107], v[32:47]
    v_mfma_f32_32x32x16_bf16 v[48:63], a[84:87], v[104:107], v[48:63]
    buffer_load_dwordx4 v[88:91], v217, s[28:31], s70 offen offset:2048 sc1
    s_waitcnt vmcnt(12)
    v_mfma_f32_32x32x16_bf16 v[32:47], a[88:91], v[108:111], v[32:47]
    v_mfma_f32_32x32x16_bf16 v[48:63], a[92:95], v[108:111], v[48:63]
    buffer_load_dwordx4 v[92:95], v217, s[28:31], s70 offen offset:3072 sc1
    s_waitcnt vmcnt(11)
    v_mfma_f32_32x32x16_bf16 v[0:15], a[0:3], v[112:115], 0
    v_mfma_f32_32x32x16_bf16 v[16:31], a[4:7], v[112:115], 0
    s_add_u32 s91, s50, 6
    v_subrev_u32 v184, s91, v184
    v_cmp_gt_u32 vcc, 32, v184
    s_nop 0
    s_andn2_b64 s[96:97], s[58:59], vcc
    s_cbranch_scc1 L_slow_32
L_pback_33:
    buffer_load_dwordx4 v[96:99], v141, s[28:31], s66 offen offset:0 sc1
    s_waitcnt vmcnt(11)
    v_mfma_f32_32x32x16_bf16 v[0:15], a[8:11], v[116:119], v[0:15]
    v_mfma_f32_32x32x16_bf16 v[16:31], a[12:15], v[116:119], v[16:31]
    buffer_load_dwordx4 v[100:103], v141, s[28:31], s66 offen offset:1024 sc1
    s_waitcnt vmcnt(11)
    v_mfma_f32_32x32x16_bf16 v[0:15], a[16:19], v[120:123], v[0:15]
    v_mfma_f32_32x32x16_bf16 v[16:31], a[20:23], v[120:123], v[16:31]
    buffer_load_dwordx4 v[104:107], v141, s[28:31], s66 offen offset:2048 sc1
    s_waitcnt vmcnt(11)
    v_mfma_f32_32x32x16_bf16 v[0:15], a[24:27], v[124:127], v[0:15]
    v_mfma_f32_32x32x16_bf16 v[16:31], a[28:31], v[124:127], v[16:31]
    buffer_load_dwordx4 v[108:111], v141, s[28:31], s66 offen offset:3072 sc1
    s_waitcnt vmcnt(11)
    v_mfma_f32_32x32x16_bf16 v[0:15], a[32:35], v[64:67], v[0:15]
    v_mfma_f32_32x32x16_bf16 v[16:31], a[36:39], v[64:67], v[16:31]
    buffer_load_dwordx4 v[112:115], v220, s[28:31], s67 offen offset:0 sc1
    s_waitcnt vmcnt(11)
    v_mfma_f32_32x32x16_bf16 v[0:15], a[40:43], v[68:71], v[0:15]
    v_mfma_f32_32x32x16_bf16 v[16:31], a[44:47], v[68:71], v[16:31]
    buffer_load_dwordx4 v[116:119], v220, s[28:31], s67 offen offset:1024 sc1
    s_waitcnt vmcnt(11)
    v_mfma_f32_32x32x16_bf16 v[0:15], a[48:51], v[72:75], v[0:15]
    v_mfma_f32_32x32x16_bf16 v[16:31], a[52:55], v[72:75], v[16:31]
    buffer_load_dwordx4 v[120:123], v220, s[28:31], s67 offen offset:2048 sc1
    s_waitcnt vmcnt(11)
    v_mfma_f32_32x32x16_bf16 v[0:15], a[56:59], v[76:79], v[0:15]
    v_mfma_f32_32x32x16_bf16 v[16:31], a[60:63], v[76:79], v[16:31]
    buffer_load_dwordx4 v[124:127], v220, s[28:31], s67 offen offset:3072 sc1
    s_waitcnt vmcnt(11)
    v_mfma_f32_32x32x16_bf16 v[0:15], a[64:67], v[80:83], v[0:15]
    v_mfma_f32_32x32x16_bf16 v[16:31], a[68:71], v[80:83], v[16:31]
    buffer_load_dwordx4 v[64:67], v220, s[28:31], s69 offen offset:0 sc1
    s_waitcnt vmcnt(11)
    v_mfma_f32_32x32x16_bf16 v[0:15], a[72:75], v[84:87], v[0:15]
    v_mfma_f32_32x32x16_bf16 v[16:31], a[76:79], v[84:87], v[16:31]
    buffer_load_dwordx4 v[68:71], v220, s[28:31], s69 offen offset:1024 sc1
    s_waitcnt vmcnt(11)
    v_mfma_f32_32x32x16_bf16 v[0:15], a[80:83], v[88:91], v[0:15]
    v_mfma_f32_32x32x16_bf16 v[16:31], a[84:87], v[88:91], v[16:31]
    buffer_load_dwordx4 v[72:75], v220, s[28:31], s69 offen offset:2048 sc1
    s_waitcnt vmcnt(11)
    v_mfma_f32_32x32x16_bf16 v[0:15], a[88:91], v[92:95], v[0:15]
    v_mfma_f32_32x32x16_bf16 v[16:31], a[92:95], v[92:95], v[16:31]
    buffer_load_dwordx4 v[76:79], v220, s[28:31], s69 offen offset:3072 sc1
    s_waitcnt vmcnt(11)
    v_mfma_f32_32x32x16_bf16 v[32:47], a[96:99], v[96:99], v[32:47]
    v_mfma_f32_32x32x16_bf16 v[48:63], a[100:103], v[96:99], v[48:63]
    buffer_load_dwordx4 v[80:83], v220, s[28:31], s71 offen offset:0 sc1
    s_waitcnt vmcnt(11)
    v_mfma_f32_32x32x16_bf16 v[32:47], a[104:107], v[100:103], v[32:47]
    v_mfma_f32_32x32x16_bf16 v[48:63], a[108:111], v[100:103], v[48:63]
    buffer_load_dwordx4 v[84:87], v220, s[28:31], s71 offen offset:1024 sc1
    s_waitcnt vmcnt(11)
    v_mfma_f32_32x32x16_bf16 v[32:47], a[112:115], v[104:107], v[32:47]
    v_mfma_f32_32x32x16_bf16 v[48:63], a[116:119], v[104:107], v[48:63]
    buffer_load_dwordx4 v[88:91], v220, s[28:31], s71 offen offset:2048 sc1
    s_waitcnt vmcnt(11)
    v_mfma_f32_32x32x16_bf16 v[32:47], a[120:123], v[108:111], v[32:47]
    v_mfma_f32_32x32x16_bf16 v[48:63], a[124:127], v[108:111], v[48:63]
    buffer_load_dwordx4 v[92:95], v220, s[28:31], s71 offen offset:3072 sc1
    s_waitcnt vmcnt(11)
    v_mfma_f32_32x32x16_bf16 v[32:47], a[128:131], v[112:115], v[32:47]
    v_mfma_f32_32x32x16_bf16 v[48:63], a[132:135], v[112:115], v[48:63]
    buffer_load_dwordx4 v[96:99], v140, s[28:31], s66 offen offset:0 sc1
    s_waitcnt vmcnt(11)
    v_mfma_f32_32x32x16_bf16 v[32:47], a[136:139], v[116:119], v[32:47]
    v_mfma_f32_32x32x16_bf16 v[48:63], a[140:143], v[116:119], v[48:63]
    buffer_load_dwordx4 v[100:103], v140, s[28:31], s66 offen offset:1024 sc1
    s_waitcnt vmcnt(11)
    v_mfma_f32_32x32x16_bf16 v[32:47], a[144:147], v[120:123], v[32:47]
    v_mfma_f32_32x32x16_bf16 v[48:63], a[148:151], v[120:123], v[48:63]
    buffer_load_dwordx4 v[104:107], v140, s[28:31], s66 offen offset:2048 sc1
    s_waitcnt vmcnt(11)
    v_mfma_f32_32x32x16_bf16 v[32:47], a[152:155], v[124:127], v[32:47]
    v_mfma_f32_32x32x16_bf16 v[48:63], a[156:159], v[124:127], v[48:63]
    buffer_load_dwordx4 v[108:111], v140, s[28:31], s66 offen offset:3072 sc1
    s_waitcnt vmcnt(11)
    v_mfma_f32_32x32x16_bf16 v[32:47], a[160:163], v[64:67], v[32:47]
    v_mfma_f32_32x32x16_bf16 v[48:63], a[164:167], v[64:67], v[48:63]
    buffer_load_dwordx4 v[112:115], v217, s[28:31], s67 offen offset:0 sc1
    s_waitcnt vmcnt(11)
    v_mfma_f32_32x32x16_bf16 v[32:47], a[168:171], v[68:71], v[32:47]
    v_mfma_f32_32x32x16_bf16 v[48:63], a[172:175], v[68:71], v[48:63]
    buffer_load_dwordx4 v[116:119], v217, s[28:31], s67 offen offset:1024 sc1
    s_waitcnt vmcnt(11)
    v_mfma_f32_32x32x16_bf16 v[32:47], a[176:179], v[72:75], v[32:47]
    s_lshl_b32 s92, s45, 6
    v_mfma_f32_32x32x16_bf16 v[48:63], a[180:183], v[72:75], v[48:63]
    buffer_load_dwordx4 v[120:123], v217, s[28:31], s67 offen offset:2048 sc1
    s_waitcnt vmcnt(11)
    v_mfma_f32_32x32x16_bf16 v[32:47], a[184:187], v[76:79], v[32:47]
    v_lshrrev_b32 v159, 2, v222
    v_mfma_f32_32x32x16_bf16 v[48:63], a[188:191], v[76:79], v[48:63]
    buffer_load_dwordx4 v[124:127], v217, s[28:31], s67 offen offset:3072 sc1
    v_mul_u32_u24 v159, 3072, v159
    s_waitcnt vmcnt(11)
    v_mfma_f32_32x32x16_bf16 v[32:47], a[192:195], v[80:83], v[32:47]
    v_mfma_f32_32x32x16_bf16 v[48:63], a[196:199], v[80:83], v[48:63]
    buffer_load_dwordx4 v[64:67], v217, s[28:31], s69 offen offset:0 sc1
    v_and_b32 v158, 3, v222
    s_waitcnt vmcnt(11)
    v_mfma_f32_32x32x16_bf16 v[32:47], a[200:203], v[84:87], v[32:47]
    v_lshlrev_b32 v158, 4, v158
    v_mfma_f32_32x32x16_bf16 v[48:63], a[204:207], v[84:87], v[48:63]
    buffer_load_dwordx4 v[68:71], v217, s[28:31], s69 offen offset:1024 sc1
    s_waitcnt vmcnt(11)
    v_mfma_f32_32x32x16_bf16 v[32:47], a[208:211], v[88:91], v[32:47]
    v_add3_u32 v158, v158, v159, s92
    v_mfma_f32_32x32x16_bf16 v[48:63], a[212:215], v[88:91], v[48:63]
    buffer_load_dwordx4 v[72:75], v217, s[28:31], s69 offen offset:2048 sc1
    s_mul_i32 s74, s44, 98304
    s_waitcnt vmcnt(11)
    v_mfma_f32_32x32x16_bf16 v[32:47], a[216:219], v[92:95], v[32:47]
    v_mfma_f32_32x32x16_bf16 v[48:63], a[220:223], v[92:95], v[48:63]
    buffer_load_dwordx4 v[76:79], v217, s[28:31], s69 offen offset:3072 sc1
    s_lshl_b32 s75, s44, 11
    s_waitcnt vmcnt(11)
    v_mfma_f32_32x32x16_bf16 v[0:15], a[96:99], v[96:99], v[0:15]
    v_mfma_f32_32x32x16_bf16 v[16:31], a[100:103], v[96:99], v[16:31]
    buffer_load_dwordx4 v[80:83], v217, s[28:31], s71 offen offset:0 sc1
    s_waitcnt vmcnt(11)
    v_mfma_f32_32x32x16_bf16 v[0:15], a[104:107], v[100:103], v[0:15]
    s_nop 2
    ds_write_b128 v211, v[36:39] offset:0
    ds_write_b128 v211, v[52:55] offset:1024
    v_mfma_f32_32x32x16_bf16 v[16:31], a[108:111], v[100:103], v[16:31]
    buffer_load_dwordx4 v[84:87], v217, s[28:31], s71 offen offset:1024 sc1
    ds_write_b128 v212, v[40:43] offset:0
    ds_write_b128 v212, v[56:59] offset:1024
    s_waitcnt vmcnt(11)
    v_mfma_f32_32x32x16_bf16 v[0:15], a[112:115], v[104:107], v[0:15]
    ds_write_b128 v213, v[44:47] offset:0
    ds_write_b128 v213, v[60:63] offset:1024
    v_mfma_f32_32x32x16_bf16 v[16:31], a[116:119], v[104:107], v[16:31]
    buffer_load_dwordx4 v[88:91], v217, s[28:31], s71 offen offset:2048 sc1
    s_waitcnt vmcnt(11)
    v_mfma_f32_32x32x16_bf16 v[0:15], a[120:123], v[108:111], v[0:15]
    v_mfma_f32_32x32x16_bf16 v[16:31], a[124:127], v[108:111], v[16:31]
    buffer_load_dwordx4 v[92:95], v217, s[28:31], s71 offen offset:3072 sc1
    s_waitcnt vmcnt(11)
    v_mfma_f32_32x32x16_bf16 v[0:15], a[128:131], v[112:115], v[0:15]
    s_lshr_b32 s92, s2, 3
    s_mul_i32 s92, s92, 49152
    s_add_u32 s92, s92, 2432
    s_cmp_eq_u32 s44, 1
    s_cselect_b32 s92, s92, 2130706432
    v_mfma_f32_32x32x16_bf16 v[16:31], a[132:135], v[112:115], v[16:31]
    v_min_u32 v159, 15, v222
    v_mul_u32_u24 v159, 3072, v159
    v_add_u32 v159, s92, v159
    s_mov_b32 m0, 162688
    s_nop 0
    buffer_load_dword v159, s[8:11], 0 offen lds
    s_waitcnt vmcnt(11)
    v_mfma_f32_32x32x16_bf16 v[0:15], a[136:139], v[116:119], v[0:15]
    s_add_u32 m0, s75, 65536
    s_add_u32 s95, s74, 2048
    buffer_load_dwordx4 v158, s[8:11], s95 offen lds
    v_mfma_f32_32x32x16_bf16 v[16:31], a[140:143], v[116:119], v[16:31]
    s_waitcnt lgkmcnt(0)
    s_barrier
    ds_read_b128 v[184:187], v214 offset:0
    ds_read_b128 v[188:191], v214 offset:1024
    s_waitcnt vmcnt(11)
    v_mfma_f32_32x32x16_bf16 v[0:15], a[144:147], v[120:123], v[0:15]
    ds_read_b128 v[192:195], v214 offset:2048
    ds_read_b128 v[196:199], v214 offset:3072
    ds_read_b128 v[200:203], v214 offset:4096
    ds_read_b128 v[204:207], v214 offset:5120
    s_add_u32 m0, s75, 66560
    s_add_u32 s95, s74, 51200
    buffer_load_dwordx4 v158, s[8:11], s95 offen lds
    v_mfma_f32_32x32x16_bf16 v[16:31], a[148:151], v[120:123], v[16:31]
    s_waitcnt vmcnt(11)
    v_mfma_f32_32x32x16_bf16 v[0:15], a[152:155], v[124:127], v[0:15]
    v_mfma_f32_32x32x16_bf16 v[16:31], a[156:159], v[124:127], v[16:31]
    s_add_u32 m0, s75, 73728
    s_add_u32 s95, s74, 395264
    buffer_load_dwordx4 v158, s[8:11], s95 offen lds
    s_waitcnt vmcnt(11)
    v_mfma_f32_32x32x16_bf16 v[0:15], a[160:163], v[64:67], v[0:15]
    v_mfma_f32_32x32x16_bf16 v[16:31], a[164:167], v[64:67], v[16:31]
    s_add_u32 s94, s84, 32768
    s_waitcnt lgkmcnt(4)
    v_add_f32 v32, v32, v184
    v_add_f32 v33, v33, v185
    v_add_f32 v34, v34, v186
    v_add_f32 v35, v35, v187
    s_add_u32 m0, s75, 74752
    s_add_u32 s95, s74, 444416
    buffer_load_dwordx4 v158, s[8:11], s95 offen lds
    s_waitcnt vmcnt(11)
    v_mfma_f32_32x32x16_bf16 v[0:15], a[168:171], v[68:71], v[0:15]
    v_add_f32 v48, v48, v188
    v_add_f32 v49, v49, v189
    v_add_f32 v50, v50, v190
    v_add_f32 v51, v51, v191
    v_mfma_f32_32x32x16_bf16 v[16:31], a[172:175], v[68:71], v[16:31]
    s_waitcnt lgkmcnt(2)
    v_add_f32 v32, v32, v192
    v_add_f32 v33, v33, v193
    v_add_f32 v34, v34, v194
    v_add_f32 v35, v35, v195
    v_add_f32 v48, v48, v196
    s_waitcnt vmcnt(10)
    v_mfma_f32_32x32x16_bf16 v[0:15], a[176:179], v[72:75], v[0:15]
    v_add_f32 v49, v49, v197
    v_add_f32 v50, v50, v198
    v_add_f32 v51, v51, v199
    s_waitcnt lgkmcnt(0)
    v_add_f32 v32, v32, v200
    s_add_u32 m0, s75, 81920
    s_add_u32 s95, s74, 788480
    buffer_load_dwordx4 v158, s[8:11], s95 offen lds
    v_mfma_f32_32x32x16_bf16 v[16:31], a[180:183], v[72:75], v[16:31]
    v_add_f32 v33, v33, v201
    v_add_f32 v34, v34, v202
    v_add_f32 v35, v35, v203
    v_add_f32 v48, v48, v204
    v_add_f32 v49, v49, v205
    v_add_f32 v50, v50, v206
    s_waitcnt vmcnt(10)
    v_mfma_f32_32x32x16_bf16 v[0:15], a[184:187], v[76:79], v[0:15]
    v_add_f32 v51, v51, v207
    v_fma_f32 v168, v32, v219, v168
    v_fma_f32 v169, v33, v219, v169
    v_fma_f32 v170, v34, v219, v170
    s_add_u32 m0, s75, 82944
    s_add_u32 s95, s74, 837632
    buffer_load_dwordx4 v158, s[8:11], s95 offen lds
    v_mfma_f32_32x32x16_bf16 v[16:31], a[188:191], v[76:79], v[16:31]
    v_fma_f32 v171, v35, v219, v171
    v_fma_f32 v172, v48, v219, v172
    v_fma_f32 v173, v49, v219, v173
    v_fma_f32 v174, v50, v219, v174
    v_fma_f32 v175, v51, v219, v175
    v_cvt_pk_bf16_f32 v180, v168, v169
    s_waitcnt vmcnt(10)
    v_mfma_f32_32x32x16_bf16 v[0:15], a[192:195], v[80:83], v[0:15]
    v_cvt_pk_bf16_f32 v181, v170, v171
    v_cvt_pk_bf16_f32 v182, v172, v173
    v_cvt_pk_bf16_f32 v183, v174, v175
    s_cmp_eq_u32 s52, 1
    s_cbranch_scc0 L_safe_37
    buffer_store_dwordx4 v[180:183], v223, s[28:31], s94 offen
L_back_38:
    v_mfma_f32_32x32x16_bf16 v[16:31], a[196:199], v[80:83], v[16:31]
    v_add_f32 v36, v168, v169
    v_mul_f32 v38, v168, v168
    v_fma_f32 v38, v169, v169, v38
    v_add_f32 v36, v36, v170
    v_fma_f32 v38, v170, v170, v38
    s_add_u32 m0, s75, 90112
    s_add_u32 s95, s74, 1181696
    buffer_load_dwordx4 v158, s[8:11], s95 offen lds
    s_waitcnt vmcnt(11)
    v_mfma_f32_32x32x16_bf16 v[0:15], a[200:203], v[84:87], v[0:15]
    v_add_f32 v36, v36, v171
    v_fma_f32 v38, v171, v171, v38
    v_add_f32 v36, v36, v172
    v_fma_f32 v38, v172, v172, v38
    v_mfma_f32_32x32x16_bf16 v[16:31], a[204:207], v[84:87], v[16:31]
    v_add_f32 v36, v36, v173
    v_fma_f32 v38, v173, v173, v38
    v_add_f32 v36, v36, v174
    v_fma_f32 v38, v174, v174, v38
    v_add_f32 v36, v36, v175
    v_fma_f32 v38, v175, v175, v38
    s_add_u32 m0, s75, 91136
    s_add_u32 s95, s74, 1230848
    buffer_load_dwordx4 v158, s[8:11], s95 offen lds
    s_waitcnt vmcnt(11)
    v_mfma_f32_32x32x16_bf16 v[0:15], a[208:211], v[88:91], v[0:15]
    v_permlane32_swap_b32 v36, v38
    v_add_f32 v36, v36, v38
    ds_write_b32 v156, v36 offset:1024
    v_and_b32 v192, 31, v222
    v_cmp_le_u32 vcc, 24, v192
    v_mfma_f32_32x32x16_bf16 v[16:31], a[212:215], v[88:91], v[16:31]
    v_mov_b32 v193, 2130706432
    s_add_u32 s94, s87, 1703936
    s_add_u32 s83, s86, 1738752
    v_subrev_u32 v195, 192, v215
    v_cndmask_b32 v194, v193, v223, vcc
    v_cndmask_b32 v195, v193, v195, vcc
    s_waitcnt vmcnt(10)
    v_mfma_f32_32x32x16_bf16 v[0:15], a[216:219], v[92:95], v[0:15]
    buffer_store_dwordx4 v[180:183], v194, s[36:39], s94 offen sc1
    buffer_store_dword v36, v195, s[36:39], s83 offen sc1
    s_add_u32 s94, s51, 2
    v_mov_b32 v197, s94
    v_mfma_f32_32x32x16_bf16 v[16:31], a[220:223], v[92:95], v[16:31]
    s_lshl_b32 s94, s46, 7
    s_add_u32 s94, s94, 1770496
    v_lshlrev_b32 v193, 2, v192
    s_cmp_eq_u32 s44, 0
    s_cselect_b32 s94, s94, 2130706432
    v_add_u32 v193, s94, v193
    s_nop 0
    ds_write_b128 v152, v[4:7] offset:0
    s_nop 3
    ds_write_b128 v152, v[20:23] offset:1024
    ds_write_b128 v153, v[8:11] offset:0
    ds_write_b128 v153, v[24:27] offset:1024
    ds_write_b128 v154, v[12:15] offset:0
    ds_write_b128 v154, v[28:31] offset:1024
    s_waitcnt vmcnt(0)
    s_waitcnt lgkmcnt(0)
    s_barrier
    ds_read_b128 v[128:131], v155 offset:0
    ds_read_b128 v[132:135], v155 offset:1024
    ds_read_b128 v[136:139], v155 offset:2048
    ds_read_b128 v[140:143], v155 offset:3072
    ds_read_b128 v[144:147], v155 offset:4096
    ds_read_b128 v[148:151], v155 offset:5120
    buffer_store_dword v197, v193, s[36:39], 0 offen sc1
    s_add_u32 s92, s84, 0
    s_waitcnt lgkmcnt(4)
    v_pk_add_f32 v[0:1], v[0:1], v[128:129]
    v_pk_add_f32 v[2:3], v[2:3], v[130:131]
    v_pk_add_f32 v[16:17], v[16:17], v[132:133]
    v_pk_add_f32 v[18:19], v[18:19], v[134:135]
    s_waitcnt lgkmcnt(2)
    v_pk_add_f32 v[0:1], v[0:1], v[136:137]
    v_pk_add_f32 v[2:3], v[2:3], v[138:139]
    v_pk_add_f32 v[16:17], v[16:17], v[140:141]
    v_pk_add_f32 v[18:19], v[18:19], v[142:143]
    s_waitcnt lgkmcnt(0)
    v_pk_add_f32 v[0:1], v[0:1], v[144:145]
    v_pk_add_f32 v[2:3], v[2:3], v[146:147]
    v_pk_add_f32 v[16:17], v[16:17], v[148:149]
    v_pk_add_f32 v[18:19], v[18:19], v[150:151]
    v_pk_fma_f32 v[160:161], v[0:1], v[218:219], v[160:161] op_sel_hi:[1,0,1]
    v_pk_fma_f32 v[162:163], v[2:3], v[218:219], v[162:163] op_sel_hi:[1,0,1]
    v_pk_fma_f32 v[164:165], v[16:17], v[218:219], v[164:165] op_sel_hi:[1,0,1]
    v_pk_fma_f32 v[166:167], v[18:19], v[218:219], v[166:167] op_sel_hi:[1,0,1]
    v_cvt_pk_bf16_f32 v176, v160, v161
    v_cvt_pk_bf16_f32 v177, v162, v163
    v_cvt_pk_bf16_f32 v178, v164, v165
    v_cvt_pk_bf16_f32 v179, v166, v167
    s_cmp_eq_u32 s52, 1
    s_cbranch_scc0 L_safe_39
    buffer_store_dwordx4 v[176:179], v223, s[28:31], s92 offen
L_back_40:
    v_pk_add_f32 v[4:5], v[160:161], v[162:163]
    v_pk_mul_f32 v[6:7], v[160:161], v[160:161]
    v_pk_add_f32 v[4:5], v[4:5], v[164:165]
    v_pk_fma_f32 v[6:7], v[162:163], v[162:163], v[6:7]
    v_pk_add_f32 v[4:5], v[4:5], v[166:167]
    v_pk_fma_f32 v[6:7], v[164:165], v[164:165], v[6:7]
    v_add_f32 v4, v4, v5
    v_pk_fma_f32 v[6:7], v[166:167], v[166:167], v[6:7]
    v_add_f32 v6, v6, v7
    s_nop 1
    v_permlane32_swap_b32 v4, v6
    v_add_f32 v4, v4, v6
    ds_write_b32 v156, v4 offset:0
    s_add_u32 s92, s50, 7
    v_mov_b32 v220, s92
    v_mov_b32 v210, v158
    v_and_b32 v80, 3, v222
    v_lshlrev_b32 v80, 3, v80
    v_bfe_u32 v86, v222, 2, 2
    v_lshl_add_u32 v80, v86, 6, v80
    v_bfe_u32 v86, v222, 4, 1
    v_lshl_add_u32 v80, v86, 5, v80
    v_lshrrev_b32 v86, 5, v222
    v_lshl_add_u32 v80, v86, 8, v80
    v_add_u32 v81, 0x10000, v80
    s_lshl_b32 s92, s44, 9
    v_add_u32 v83, s92, v80
    v_add_u32 v84, 0x10000, v83
    s_lshl_b32 s92, s45, 2
    s_add_u32 s92, s92, s44
    s_lshl_b32 s92, s92, 2
    s_add_u32 s92, s92, 1769472
    v_mov_b32 v88, 2130706432
    v_writelane_b32 v88, s92, 0
    v_lshlrev_b32 v89, 2, v222
    v_add_u32 v89, 1769472, v89
    v_lshrrev_b32 v86, 4, v222
    v_and_b32 v85, 15, v222
    v_lshlrev_b32 v85, 4, v85
    v_lshl_add_u32 v85, v86, 10, v85
    s_lshl_b32 s92, s44, 8
    s_add_u32 s92, s92, 1572864
    v_add_u32 v85, s92, v85
    s_lshl_b32 s92, s44, 15
    s_add_u32 s92, s92, 0
    v_add_u32 v82, s92, v223
    s_min_u32 s92, s45, 13
    s_lshl_b32 s93, s92, 8
    v_bfe_u32 v86, v222, 4, 1
    v_lshlrev_b32 v86, 2, v86
    v_and_b32 v90, 7, v222
    v_xor_b32 v90, v90, v86
    v_lshlrev_b32 v90, 4, v90
    v_lshrrev_b32 v86, 3, v222
    v_mul_u32_u24 v86, 3584, v86
    v_add3_u32 v90, v90, v86, s93
    s_mul_i32 s76, s44, 28672
    s_lshl_b32 s77, s44, 10
    v_and_b32 v87, 7, v222
    v_lshlrev_b32 v87, 7, v87
    v_add_u32 v87, 1770496, v87
    s_waitcnt vmcnt(0)
    s_cmp_eq_u32 s52, 1
    s_cbranch_scc0 L_safe_41
    buffer_store_dword v220, v208, s[28:31], 0 offen
L_back_42:
    s_waitcnt lgkmcnt(0)
    s_barrier
    ds_read_b64_tr_b16 v[96:97], v80 offset:32768
    ds_read_b64_tr_b16 v[98:99], v80 offset:34816
    ds_read_b64_tr_b16 v[100:101], v81 offset:0
    ds_read_b64_tr_b16 v[102:103], v81 offset:2048
    ds_read_b64_tr_b16 v[104:105], v80 offset:0
    ds_read_b64_tr_b16 v[106:107], v80 offset:2048
    ds_read_b64_tr_b16 v[108:109], v80 offset:33280
    ds_read_b64_tr_b16 v[110:111], v80 offset:35328
    ds_read_b64_tr_b16 v[112:113], v81 offset:512
    ds_read_b64_tr_b16 v[114:115], v81 offset:2560
    s_add_u32 s91, s50, 7
L_poll_43:
    buffer_load_dword v86, v89, s[28:31], 0 offen sc1
    s_waitcnt vmcnt(0)
    v_subrev_u32 v86, s91, v86
    v_cmp_gt_u32 vcc, 32, v86
    s_nop 0
    s_andn2_b64 s[96:97], s[54:55], vcc
    s_cbranch_scc1 L_chk_44
L_done_45:
    buffer_load_dwordx4 v[120:123], v82, s[28:31], s66 offen offset:0 sc1
    buffer_load_dwordx4 v[124:127], v82, s[28:31], s66 offen offset:1024 sc1
    buffer_load_dwordx4 v[128:131], v82, s[28:31], s66 offen offset:2048 sc1
    buffer_load_dwordx4 v[132:135], v82, s[28:31], s66 offen offset:3072 sc1
    buffer_load_dwordx4 v[136:139], v82, s[28:31], s67 offen offset:0 sc1
    buffer_load_dwordx4 v[140:143], v82, s[28:31], s67 offen offset:1024 sc1
    buffer_load_dwordx4 v[144:147], v82, s[28:31], s67 offen offset:2048 sc1
    buffer_load_dwordx4 v[148:151], v82, s[28:31], s67 offen offset:3072 sc1
    buffer_load_dwordx4 v[152:155], v82, s[28:31], s68 offen offset:0 sc1
    buffer_load_dwordx4 v[156:159], v82, s[28:31], s68 offen offset:1024 sc1
    buffer_load_dword v196, v87, s[28:31], 0 offen sc1
    s_waitcnt vmcnt(10) lgkmcnt(4)
    v_mfma_f32_32x32x16_bf16 v[16:31], v[96:99], v[120:123], 0
    ds_read_b64_tr_b16 v[116:117], v80 offset:512
    ds_read_b64_tr_b16 v[118:119], v80 offset:2560
    s_and_b32 s92, s44, 1
    s_lshl_b32 s93, s92, 10
    v_mfma_f32_32x32x16_bf16 v[32:47], v[100:103], v[120:123], 0
    ds_read_b64_tr_b16 v[96:97], v80 offset:33792
    ds_read_b64_tr_b16 v[98:99], v80 offset:35840
    s_add_u32 s93, s93, 157696
    v_lshlrev_b32 v52, 2, v222
    v_add_u32 v52, s93, v52
    ds_read2st64_b32 v[48:49], v52 offset0:0 offset1:1
    v_mfma_f32_32x32x16_bf16 v[0:15], v[104:107], v[120:123], 0
    ds_read_b64_tr_b16 v[100:101], v81 offset:1024
    ds_read_b64_tr_b16 v[102:103], v81 offset:3072
    buffer_load_dwordx4 v[160:163], v82, s[28:31], s68 offen offset:2048 sc1
    ds_read2st64_b32 v[50:51], v52 offset0:2 offset1:3
    s_lshl_b32 s92, s92, 8
    s_waitcnt vmcnt(10) lgkmcnt(6)
    v_mfma_f32_32x32x16_bf16 v[16:31], v[108:111], v[124:127], v[16:31]
    ds_read_b64_tr_b16 v[104:105], v80 offset:1024
    ds_read_b64_tr_b16 v[106:107], v80 offset:3072
    s_lshl_b32 s93, s47, 9
    s_add_u32 s92, s92, s93
    s_lshl_b32 s93, s46, 10
    v_mfma_f32_32x32x16_bf16 v[32:47], v[112:115], v[124:127], v[32:47]
    ds_read_b64_tr_b16 v[108:109], v80 offset:34304
    ds_read_b64_tr_b16 v[110:111], v80 offset:36352
    s_add_u32 s92, s92, s93
    s_add_u32 s94, s92, 1572864
    v_and_b32 v52, 31, v222
    v_mfma_f32_32x32x16_bf16 v[0:15], v[116:119], v[124:127], v[0:15]
    ds_read_b64_tr_b16 v[112:113], v81 offset:1536
    ds_read_b64_tr_b16 v[114:115], v81 offset:3584
    buffer_load_dwordx4 v[120:123], v82, s[28:31], s68 offen offset:3072 sc1
    v_lshrrev_b32 v53, 5, v222
    v_lshlrev_b32 v52, 3, v52
    v_lshl_add_u32 v52, v53, 2, v52
    s_waitcnt vmcnt(10) lgkmcnt(4)
    v_mfma_f32_32x32x16_bf16 v[16:31], v[96:99], v[128:131], v[16:31]
    ds_read_b64_tr_b16 v[116:117], v80 offset:1536
    ds_read_b64_tr_b16 v[118:119], v80 offset:3584
    s_add_u32 s92, s50, 8
    v_mov_b32 v53, s92
    v_mfma_f32_32x32x16_bf16 v[32:47], v[100:103], v[128:131], v[32:47]
    ds_read_b64_tr_b16 v[96:97], v80 offset:36864
    ds_read_b64_tr_b16 v[98:99], v80 offset:38912
    v_add_f32 v48, v48, v49
    v_add_f32 v50, v50, v51
    v_mfma_f32_32x32x16_bf16 v[0:15], v[104:107], v[128:131], v[0:15]
    ds_read_b64_tr_b16 v[100:101], v81 offset:4096
    ds_read_b64_tr_b16 v[102:103], v81 offset:6144
    buffer_load_dwordx4 v[124:127], v82, s[28:31], s69 offen offset:0 sc1
    v_add_f32 v48, v48, v50
    s_cmp_eq_u32 s52, 1
    s_cbranch_scc0 L_safe_46
    buffer_store_dword v48, v52, s[28:31], s94 offen
L_back_47:
    s_waitcnt vmcnt(11) lgkmcnt(4)
    v_mfma_f32_32x32x16_bf16 v[16:31], v[108:111], v[132:135], v[16:31]
    ds_read_b64_tr_b16 v[104:105], v80 offset:4096
    ds_read_b64_tr_b16 v[106:107], v80 offset:6144
    v_and_b32 v86, 31, v222
    v_mfma_f32_32x32x16_bf16 v[32:47], v[112:115], v[132:135], v[32:47]
    ds_read_b64_tr_b16 v[108:109], v80 offset:37376
    ds_read_b64_tr_b16 v[110:111], v80 offset:39424
    s_lshl_b32 s92, s44, 10
    s_add_u32 s92, s92, 1703936
    v_add_u32 v91, s92, v223
    v_cmp_le_u32 vcc, 24, v86
    v_mfma_f32_32x32x16_bf16 v[0:15], v[116:119], v[132:135], v[0:15]
    ds_read_b64_tr_b16 v[112:113], v81 offset:4608
    ds_read_b64_tr_b16 v[114:115], v81 offset:6656
    buffer_load_dwordx4 v[128:131], v82, s[28:31], s69 offen offset:1024 sc1
    v_mov_b32 v86, 2130706432
    v_cndmask_b32 v91, v86, v91, vcc
    s_waitcnt vmcnt(11) lgkmcnt(4)
    v_mfma_f32_32x32x16_bf16 v[16:31], v[96:99], v[136:139], v[16:31]
    ds_read_b64_tr_b16 v[116:117], v80 offset:4608
    ds_read_b64_tr_b16 v[118:119], v80 offset:6656
    v_mfma_f32_32x32x16_bf16 v[32:47], v[100:103], v[136:139], v[32:47]
    ds_read_b64_tr_b16 v[96:97], v80 offset:37888
    ds_read_b64_tr_b16 v[98:99], v80 offset:39936
    s_add_u32 s91, s50, 2
    s_waitcnt vmcnt(5)
    v_subrev_u32 v196, s91, v196
    v_cmp_gt_u32 vcc, 32, v196
    s_nop 0
    s_andn2_b64 s[96:97], s[62:63], vcc
    s_cbranch_scc1 L_slow_50
L_pback_51:
    v_mfma_f32_32x32x16_bf16 v[0:15], v[104:107], v[136:139], v[0:15]
    ds_read_b64_tr_b16 v[100:101], v81 offset:5120
    ds_read_b64_tr_b16 v[102:103], v81 offset:7168
    buffer_load_dwordx4 v[132:135], v82, s[28:31], s69 offen offset:2048 sc1
    s_mov_b32 s95, 1738752
    buffer_load_dwordx4 v[196:199], v223, s[32:35], s95 offen sc1
    s_mov_b32 s95, 1739776
    buffer_load_dwordx4 v[200:203], v223, s[32:35], s95 offen sc1
    s_waitcnt lgkmcnt(4)
    v_mfma_f32_32x32x16_bf16 v[16:31], v[108:111], v[140:143], v[16:31]
    ds_read_b64_tr_b16 v[104:105], v80 offset:5120
    ds_read_b64_tr_b16 v[106:107], v80 offset:7168
    buffer_load_dwordx4 v[164:167], v91, s[32:35], s66 offen sc1
    buffer_load_dwordx4 v[168:171], v91, s[32:35], s67 offen sc1
    v_mfma_f32_32x32x16_bf16 v[32:47], v[112:115], v[140:143], v[32:47]
    ds_read_b64_tr_b16 v[108:109], v80 offset:38400
    ds_read_b64_tr_b16 v[110:111], v80 offset:40448
    buffer_load_dwordx4 v[172:175], v91, s[32:35], s68 offen sc1
    buffer_load_dwordx4 v[176:179], v91, s[32:35], s69 offen sc1
    buffer_load_dwordx4 v[180:183], v91, s[32:35], s70 offen sc1
    v_mfma_f32_32x32x16_bf16 v[0:15], v[116:119], v[140:143], v[0:15]
    ds_read_b64_tr_b16 v[112:113], v81 offset:5632
    ds_read_b64_tr_b16 v[114:115], v81 offset:7680
    buffer_load_dwordx4 v[136:139], v82, s[28:31], s69 offen offset:3072 sc1
    buffer_load_dwordx4 v[184:187], v91, s[32:35], s71 offen sc1
    buffer_load_dwordx4 v[188:191], v91, s[32:35], s72 offen sc1
    buffer_load_dwordx4 v[192:195], v91, s[32:35], s73 offen sc1
    s_waitcnt lgkmcnt(4)
    v_mfma_f32_32x32x16_bf16 v[16:31], v[96:99], v[144:147], v[16:31]
    ds_read_b64_tr_b16 v[116:117], v80 offset:5632
    ds_read_b64_tr_b16 v[118:119], v80 offset:7680
    s_lshr_b32 s92, s2, 3
    s_mul_i32 s92, s92, 57344
    v_mfma_f32_32x32x16_bf16 v[32:47], v[100:103], v[144:147], v[32:47]
    ds_read_b64_tr_b16 v[96:97], v80 offset:40960
    ds_read_b64_tr_b16 v[98:99], v80 offset:43008
    s_add_u32 s92, s92, 384
    s_cmp_eq_u32 s44, 3
    s_cselect_b32 s92, s92, 2130706432
    v_min_u32 v94, 55, v222
    v_mfma_f32_32x32x16_bf16 v[0:15], v[104:107], v[144:147], v[0:15]
    ds_read_b64_tr_b16 v[100:101], v81 offset:8192
    ds_read_b64_tr_b16 v[102:103], v81 offset:10240
    buffer_load_dwordx4 v[140:143], v82, s[28:31], s70 offen offset:0 sc1
    v_mul_u32_u24 v94, 1024, v94
    v_add_u32 v94, s92, v94
    s_waitcnt lgkmcnt(4)
    v_mfma_f32_32x32x16_bf16 v[16:31], v[108:111], v[148:151], v[16:31]
    ds_read_b64_tr_b16 v[104:105], v80 offset:8192
    ds_read_b64_tr_b16 v[106:107], v80 offset:10240
    s_mov_b32 m0, 162688
    s_nop 0
    buffer_load_dword v94, s[16:19], 0 offen lds
    v_mfma_f32_32x32x16_bf16 v[32:47], v[112:115], v[148:151], v[32:47]
    ds_read_b64_tr_b16 v[108:109], v80 offset:41472
    ds_read_b64_tr_b16 v[110:111], v80 offset:43520
    s_or_b32 s88, s44, s48
    s_cmp_eq_u32 s88, 0
    s_cselect_b32 s88, 0xffffff00, -1
    s_cselect_b32 s86, -16, -1
    v_mfma_f32_32x32x16_bf16 v[0:15], v[116:119], v[148:151], v[0:15]
    ds_read_b64_tr_b16 v[112:113], v81 offset:8704
    ds_read_b64_tr_b16 v[114:115], v81 offset:10752
    buffer_load_dwordx4 v[144:147], v82, s[28:31], s70 offen offset:1024 sc1
    s_mov_b32 s87, s86
    v_mov_b32 v204, 0xf149f2ca
    s_waitcnt lgkmcnt(4)
    v_mfma_f32_32x32x16_bf16 v[16:31], v[96:99], v[152:155], v[16:31]
    ds_read_b64_tr_b16 v[116:117], v80 offset:8704
    ds_read_b64_tr_b16 v[118:119], v80 offset:10752
    v_cndmask_b32_e64 v208, v204, 0, s[86:87]
    v_mov_b32 v212, 0
    v_mfma_f32_32x32x16_bf16 v[32:47], v[100:103], v[152:155], v[32:47]
    ds_read_b64_tr_b16 v[96:97], v80 offset:41984
    ds_read_b64_tr_b16 v[98:99], v80 offset:44032
    s_and_b32 s86, s88, 286331153
    s_mov_b32 s87, s86
    v_cndmask_b32_e64 v205, v204, 0, s[86:87]
    s_mov_b32 s86, 286331153
    v_mfma_f32_32x32x16_bf16 v[0:15], v[104:107], v[152:155], v[0:15]
    ds_read_b64_tr_b16 v[100:101], v81 offset:9216
    ds_read_b64_tr_b16 v[102:103], v81 offset:11264
    buffer_load_dwordx4 v[148:151], v82, s[28:31], s70 offen offset:2048 sc1
    s_mov_b32 s87, s86
    v_cndmask_b32_e64 v213, 0, v204, s[86:87]
    s_waitcnt lgkmcnt(4)
    v_mfma_f32_32x32x16_bf16 v[16:31], v[108:111], v[156:159], v[16:31]
    ds_read_b64_tr_b16 v[104:105], v80 offset:9216
    ds_read_b64_tr_b16 v[106:107], v80 offset:11264
    v_mov_b32 v209, v208
    s_and_b32 s86, s88, 858993459
    s_mov_b32 s87, s86
    v_mfma_f32_32x32x16_bf16 v[32:47], v[112:115], v[156:159], v[32:47]
    ds_read_b64_tr_b16 v[108:109], v80 offset:42496
    ds_read_b64_tr_b16 v[110:111], v80 offset:44544
    v_cndmask_b32_e64 v206, v204, 0, s[86:87]
    s_mov_b32 s86, 858993459
    s_mov_b32 s87, s86
    v_mfma_f32_32x32x16_bf16 v[0:15], v[116:119], v[156:159], v[0:15]
    ds_read_b64_tr_b16 v[112:113], v81 offset:9728
    ds_read_b64_tr_b16 v[114:115], v81 offset:11776
    buffer_load_dwordx4 v[152:155], v82, s[28:31], s70 offen offset:3072 sc1
    v_cndmask_b32_e64 v214, 0, v204, s[86:87]
    v_mov_b32 v210, v208
    s_and_b32 s86, s88, 2004318071
    s_waitcnt vmcnt(21) lgkmcnt(4)
    v_mfma_f32_32x32x16_bf16 v[16:31], v[96:99], v[160:163], v[16:31]
    ds_read_b64_tr_b16 v[116:117], v80 offset:9728
    ds_read_b64_tr_b16 v[118:119], v80 offset:11776
    s_mov_b32 s87, s86
    v_cndmask_b32_e64 v207, v204, 0, s[86:87]
    v_mfma_f32_32x32x16_bf16 v[32:47], v[100:103], v[160:163], v[32:47]
    ds_read_b64_tr_b16 v[96:97], v80 offset:45056
    ds_read_b64_tr_b16 v[98:99], v80 offset:47104
    s_mov_b32 s86, 2004318071
    s_mov_b32 s87, s86
    v_cndmask_b32_e64 v215, 0, v204, s[86:87]
    v_mfma_f32_32x32x16_bf16 v[0:15], v[104:107], v[160:163], v[0:15]
    ds_read_b64_tr_b16 v[100:101], v81 offset:12288
    ds_read_b64_tr_b16 v[102:103], v81 offset:14336
    buffer_load_dwordx4 v[156:159], v82, s[28:31], s71 offen offset:0 sc1
    v_mov_b32 v211, v208
    v_and_b32 v94, 31, v222
    v_lshrrev_b32 v95, 5, v222
    s_waitcnt vmcnt(21) lgkmcnt(4)
    v_mfma_f32_32x32x16_bf16 v[16:31], v[108:111], v[120:123], v[16:31]
    ds_read_b64_tr_b16 v[104:105], v80 offset:12288
    ds_read_b64_tr_b16 v[106:107], v80 offset:14336
    s_lshl_b32 s92, s44, 9
    s_add_u32 s92, s92, 131072
    v_mfma_f32_32x32x16_bf16 v[32:47], v[112:115], v[120:123], v[32:47]
    ds_read_b64_tr_b16 v[108:109], v80 offset:45568
    ds_read_b64_tr_b16 v[110:111], v80 offset:47616
    v_lshlrev_b32 v94, 4, v94
    v_add_u32 v94, s92, v94
    v_mul_u32_u24 v95, 2176, v95
    v_add3_u32 v217, v94, v95, 64
    v_mfma_f32_32x32x16_bf16 v[0:15], v[116:119], v[120:123], v[0:15]
    ds_read_b64_tr_b16 v[112:113], v81 offset:12800
    ds_read_b64_tr_b16 v[114:115], v81 offset:14848
    buffer_load_dwordx4 v[160:163], v82, s[28:31], s71 offen offset:1024 sc1
    v_add_u32 v217, 64, v217
    v_lshl_add_u32 v220, v95, 1, v94
    s_waitcnt vmcnt(21) lgkmcnt(4)
    v_mfma_f32_32x32x16_bf16 v[16:31], v[96:99], v[124:127], v[16:31]
    ds_read_b64_tr_b16 v[116:117], v80 offset:12800
    ds_read_b64_tr_b16 v[118:119], v80 offset:14848
    v_and_b32 v94, 3, v222
    v_bfe_u32 v216, v222, 4, 1
    v_lshl_add_u32 v94, v216, 2, v94
    s_add_u32 m0, s77, 98304
    s_add_u32 s95, s76, 0
    buffer_load_dwordx4 v90, s[16:19], s95 offen lds
    v_mfma_f32_32x32x16_bf16 v[32:47], v[100:103], v[124:127], v[32:47]
    ds_read_b64_tr_b16 v[96:97], v83 offset:32768
    ds_read_b64_tr_b16 v[98:99], v83 offset:34816
    v_bfe_u32 v216, v222, 2, 2
    v_lshl_add_u32 v94, v94, 2, v216
    v_lshlrev_b32 v94, 4, v94
    v_mfma_f32_32x32x16_bf16 v[0:15], v[104:107], v[124:127], v[0:15]
    ds_read_b64_tr_b16 v[100:101], v84 offset:0
    ds_read_b64_tr_b16 v[102:103], v84 offset:2048
    buffer_load_dwordx4 v[120:123], v82, s[28:31], s71 offen offset:2048 sc1
    v_lshl_add_u32 v94, v95, 1, v94
    s_add_u32 s92, s92, 8704
    v_add_u32 v216, s92, v94
    s_waitcnt vmcnt(21) lgkmcnt(4)
    v_mfma_f32_32x32x16_bf16 v[16:31], v[108:111], v[128:131], v[16:31]
    ds_read_b64_tr_b16 v[104:105], v83 offset:36864
    ds_read_b64_tr_b16 v[106:107], v83 offset:38912
    s_lshl_b32 s84, s44, 15
    s_lshl_b32 s92, s45, 11
    v_mfma_f32_32x32x16_bf16 v[32:47], v[112:115], v[128:131], v[32:47]
    ds_read_b64_tr_b16 v[108:109], v84 offset:4096
    ds_read_b64_tr_b16 v[110:111], v84 offset:6144
    s_add_u32 s84, s84, s92
    s_add_u32 s84, s84, 262144
    s_add_u32 m0, s77, 102400
    s_add_u32 s95, s76, 114688
    buffer_load_dwordx4 v90, s[16:19], s95 offen lds
    v_mfma_f32_32x32x16_bf16 v[0:15], v[116:119], v[128:131], v[0:15]
    ds_read_b64_tr_b16 v[112:113], v83 offset:40960
    ds_read_b64_tr_b16 v[114:115], v83 offset:43008
    buffer_load_dwordx4 v[124:127], v82, s[28:31], s71 offen offset:3072 sc1
    s_cmp_eq_u32 s52, 1
    s_cbranch_scc0 L_safe_48
    buffer_store_dword v53, v88, s[28:31], 0 offen
L_back_49:
    s_waitcnt vmcnt(20) lgkmcnt(4)
    v_mfma_f32_32x32x16_bf16 v[48:63], v[96:99], v[164:167], 0
    ds_read_b64_tr_b16 v[116:117], v84 offset:8192
    ds_read_b64_tr_b16 v[118:119], v84 offset:10240
    v_add_f32 v196, v196, v200
    v_mfma_f32_32x32x16_bf16 v[64:79], v[100:103], v[164:167], 0
    ds_read_b64_tr_b16 v[96:97], v83 offset:45056
    ds_read_b64_tr_b16 v[98:99], v83 offset:47104
    v_add_f32 v197, v197, v201
    v_add_f32 v198, v198, v202
    v_add_f32 v199, v199, v203
    s_waitcnt vmcnt(19)
    v_mfma_f32_32x32x16_bf16 v[48:63], v[104:107], v[168:171], v[48:63]
    ds_read_b64_tr_b16 v[100:101], v84 offset:12288
    ds_read_b64_tr_b16 v[102:103], v84 offset:14336
    v_add_f32_dpp v196, v196, v196 row_ror:4 row_mask:0xf bank_mask:0xf
    v_add_f32_dpp v197, v197, v197 row_ror:4 row_mask:0xf bank_mask:0xf
    s_waitcnt lgkmcnt(4)
    v_mfma_f32_32x32x16_bf16 v[64:79], v[108:111], v[168:171], v[64:79]
    ds_read_b64_tr_b16 v[104:105], v83 offset:49152
    ds_read_b64_tr_b16 v[106:107], v83 offset:51200
    s_add_u32 m0, s77, 106496
    s_add_u32 s95, s76, 229376
    buffer_load_dwordx4 v90, s[16:19], s95 offen lds
    s_waitcnt vmcnt(19)
    v_mfma_f32_32x32x16_bf16 v[48:63], v[112:115], v[172:175], v[48:63]
    ds_read_b64_tr_b16 v[108:109], v84 offset:16384
    ds_read_b64_tr_b16 v[110:111], v84 offset:18432
    v_add_f32_dpp v198, v198, v198 row_ror:4 row_mask:0xf bank_mask:0xf
    v_add_f32_dpp v199, v199, v199 row_ror:4 row_mask:0xf bank_mask:0xf
    v_mfma_f32_32x32x16_bf16 v[64:79], v[116:119], v[172:175], v[64:79]
    ds_read_b64_tr_b16 v[112:113], v83 offset:53248
    ds_read_b64_tr_b16 v[114:115], v83 offset:55296
    v_add_f32_dpp v196, v196, v196 row_ror:8 row_mask:0xf bank_mask:0xf
    v_add_f32_dpp v197, v197, v197 row_ror:8 row_mask:0xf bank_mask:0xf
    v_add_f32_dpp v198, v198, v198 row_ror:8 row_mask:0xf bank_mask:0xf
    s_waitcnt vmcnt(18) lgkmcnt(4)
    v_mfma_f32_32x32x16_bf16 v[48:63], v[96:99], v[176:179], v[48:63]
    ds_read_b64_tr_b16 v[116:117], v84 offset:20480
    ds_read_b64_tr_b16 v[118:119], v84 offset:22528
    v_add_f32_dpp v199, v199, v199 row_ror:8 row_mask:0xf bank_mask:0xf
    v_lshrrev_b32 v86, 4, v222
    v_mfma_f32_32x32x16_bf16 v[64:79], v[100:103], v[176:179], v[64:79]
    ds_read_b64_tr_b16 v[96:97], v83 offset:57344
    ds_read_b64_tr_b16 v[98:99], v83 offset:59392
    s_add_u32 m0, s77, 110592
    s_add_u32 s95, s76, 344064
    buffer_load_dwordx4 v90, s[16:19], s95 offen lds
    s_waitcnt vmcnt(18)
    v_mfma_f32_32x32x16_bf16 v[48:63], v[104:107], v[180:183], v[48:63]
    ds_read_b64_tr_b16 v[100:101], v84 offset:24576
    ds_read_b64_tr_b16 v[102:103], v84 offset:26624
    v_and_b32 v87, 1, v86
    v_permlane32_swap_b32 v196, v198
    s_waitcnt lgkmcnt(4)
    v_mfma_f32_32x32x16_bf16 v[64:79], v[108:111], v[180:183], v[64:79]
    ds_read_b64_tr_b16 v[104:105], v83 offset:61440
    ds_read_b64_tr_b16 v[106:107], v83 offset:63488
    v_permlane32_swap_b32 v197, v199
    v_lshlrev_b32 v87, 7, v87
    s_waitcnt vmcnt(16)
    v_mfma_f32_32x32x16_bf16 v[48:63], v[112:115], v[184:187], v[48:63]
    ds_read_b64_tr_b16 v[108:109], v84 offset:28672
    ds_read_b64_tr_b16 v[110:111], v84 offset:30720
    v_lshrrev_b32 v86, 1, v86
    v_add_f32 v196, v196, v198
    v_mfma_f32_32x32x16_bf16 v[64:79], v[116:119], v[184:187], v[64:79]
    ds_read_b64_tr_b16 v[112:113], v80 offset:46080
    ds_read_b64_tr_b16 v[114:115], v80 offset:48128
    v_add_f32 v197, v197, v199
    v_lshl_add_u32 v87, v86, 2, v87
    v_and_b32 v86, 3, v222
    s_waitcnt vmcnt(15) lgkmcnt(4)
    v_mfma_f32_32x32x16_bf16 v[48:63], v[96:99], v[188:191], v[48:63]
    ds_read_b64_tr_b16 v[116:117], v81 offset:13312
    ds_read_b64_tr_b16 v[118:119], v81 offset:15360
    s_add_u32 m0, s77, 114688
    s_add_u32 s95, s76, 458752
    buffer_load_dwordx4 v90, s[16:19], s95 offen lds
    v_mfma_f32_32x32x16_bf16 v[64:79], v[100:103], v[188:191], v[64:79]
    ds_read_b64_tr_b16 v[96:97], v80 offset:13312
    ds_read_b64_tr_b16 v[98:99], v80 offset:15360
    v_permlane16_swap_b32 v196, v197
    v_lshl_add_u32 v87, v86, 3, v87
    v_add_f32 v196, v196, v197
    s_waitcnt vmcnt(15)
    v_mfma_f32_32x32x16_bf16 v[48:63], v[104:107], v[192:195], v[48:63]
    ds_read_b64_tr_b16 v[100:101], v80 offset:46592
    ds_read_b64_tr_b16 v[102:103], v80 offset:48640
    v_add_u32 v87, s90, v87
    ds_write_b32 v87, v196
    s_waitcnt lgkmcnt(5)
    v_mfma_f32_32x32x16_bf16 v[64:79], v[108:111], v[192:195], v[64:79]
    ds_read_b64_tr_b16 v[104:105], v81 offset:13824
    ds_read_b64_tr_b16 v[106:107], v81 offset:15872
    v_and_b32 v86, 7, v222
    v_lshlrev_b32 v86, 2, v86
    v_mfma_f32_32x32x16_bf16 v[16:31], v[112:115], v[132:135], v[16:31]
    ds_read_b64_tr_b16 v[108:109], v80 offset:13824
    ds_read_b64_tr_b16 v[110:111], v80 offset:15872
    s_add_u32 m0, s77, 118784
    s_add_u32 s95, s76, 573440
    buffer_load_dwordx4 v90, s[16:19], s95 offen lds
    v_mfma_f32_32x32x16_bf16 v[32:47], v[116:119], v[132:135], v[32:47]
    ds_read_b64_tr_b16 v[112:113], v80 offset:49152
    ds_read_b64_tr_b16 v[114:115], v80 offset:51200
    v_add_u32 v87, s90, v86
    s_waitcnt lgkmcnt(6)
    ds_read2_b32 v[198:199], v87 offset0:0 offset1:32
    s_waitcnt lgkmcnt(5)
    v_mfma_f32_32x32x16_bf16 v[0:15], v[96:99], v[132:135], v[0:15]
    ds_read_b64_tr_b16 v[116:117], v81 offset:16384
    ds_read_b64_tr_b16 v[118:119], v81 offset:18432
    buffer_load_dwordx4 v[128:131], v82, s[28:31], s72 offen offset:0 sc1
    s_mul_i32 s92, s44, 2048
    v_mfma_f32_32x32x16_bf16 v[16:31], v[100:103], v[136:139], v[16:31]
    ds_read_b64_tr_b16 v[96:97], v80 offset:16384
    ds_read_b64_tr_b16 v[98:99], v80 offset:18432
    s_add_u32 s92, s92, 148480
    v_add_u32 v94, s92, v223
    v_mfma_f32_32x32x16_bf16 v[32:47], v[104:107], v[136:139], v[32:47]
    ds_read_b64_tr_b16 v[100:101], v80 offset:49664
    ds_read_b64_tr_b16 v[102:103], v80 offset:51712
    s_waitcnt lgkmcnt(6)
    v_mul_f32 v92, 0x3b000000, v198
    v_mul_f32 v199, 0x3b000000, v199
    s_waitcnt lgkmcnt(4)
    v_mfma_f32_32x32x16_bf16 v[0:15], v[108:111], v[136:139], v[0:15]
    ds_read_b64_tr_b16 v[104:105], v81 offset:16896
    ds_read_b64_tr_b16 v[106:107], v81 offset:18944
    buffer_load_dwordx4 v[132:135], v82, s[28:31], s72 offen offset:1024 sc1
    s_add_u32 m0, s77, 122880
    s_add_u32 s95, s76, 688128
    buffer_load_dwordx4 v90, s[16:19], s95 offen lds
    s_waitcnt vmcnt(18)
    v_mfma_f32_32x32x16_bf16 v[16:31], v[112:115], v[140:143], v[16:31]
    ds_read_b64_tr_b16 v[108:109], v80 offset:16896
    ds_read_b64_tr_b16 v[110:111], v80 offset:18944
    v_fma_f32 v199, -v92, v92, v199
    v_mfma_f32_32x32x16_bf16 v[32:47], v[116:119], v[140:143], v[32:47]
    ds_read_b64_tr_b16 v[112:113], v80 offset:50176
    ds_read_b64_tr_b16 v[114:115], v80 offset:52224
    v_max_f32 v199, 0, v199
    v_add_f32 v199, 0x3727c5ac, v199
    v_rsq_f32 v93, v199
    s_waitcnt lgkmcnt(4)
    v_mfma_f32_32x32x16_bf16 v[0:15], v[96:99], v[140:143], v[0:15]
    ds_read_b64_tr_b16 v[116:117], v81 offset:17408
    ds_read_b64_tr_b16 v[118:119], v81 offset:19456
    buffer_load_dwordx4 v[136:139], v82, s[28:31], s72 offen offset:2048 sc1
    v_mov_b32_dpp v60, v56 row_shl:8 row_mask:0xa bank_mask:0x3
    s_waitcnt vmcnt(17)
    v_mfma_f32_32x32x16_bf16 v[16:31], v[100:103], v[144:147], v[16:31]
    ds_read_b64_tr_b16 v[96:97], v80 offset:17408
    ds_read_b64_tr_b16 v[98:99], v80 offset:19456
    s_add_u32 m0, s77, 126976
    s_add_u32 s95, s76, 802816
    buffer_load_dwordx4 v90, s[16:19], s95 offen lds
    v_mfma_f32_32x32x16_bf16 v[32:47], v[104:107], v[144:147], v[32:47]
    ds_read_b64_tr_b16 v[100:101], v80 offset:50688
    ds_read_b64_tr_b16 v[102:103], v80 offset:52736
    v_mov_b32_dpp v52, v48 row_shl:8 row_mask:0xa bank_mask:0x3
    v_mov_b32_dpp v61, v57 row_shl:8 row_mask:0xa bank_mask:0x3
    v_mov_b32_dpp v53, v49 row_shl:8 row_mask:0xa bank_mask:0x3
    s_waitcnt lgkmcnt(4)
    v_mfma_f32_32x32x16_bf16 v[0:15], v[108:111], v[144:147], v[0:15]
    ds_read_b64_tr_b16 v[104:105], v81 offset:17920
    ds_read_b64_tr_b16 v[106:107], v81 offset:19968
    buffer_load_dwordx4 v[140:143], v82, s[28:31], s72 offen offset:3072 sc1
    v_mov_b32_dpp v62, v58 row_shl:8 row_mask:0xa bank_mask:0x3
    s_waitcnt vmcnt(18)
    v_mfma_f32_32x32x16_bf16 v[16:31], v[112:115], v[148:151], v[16:31]
    ds_read_b64_tr_b16 v[108:109], v80 offset:17920
    ds_read_b64_tr_b16 v[110:111], v80 offset:19968
    v_mov_b32_dpp v54, v50 row_shl:8 row_mask:0xa bank_mask:0x3
    v_mov_b32_dpp v63, v59 row_shl:8 row_mask:0xa bank_mask:0x3
    v_mfma_f32_32x32x16_bf16 v[32:47], v[116:119], v[148:151], v[32:47]
    ds_read_b64_tr_b16 v[112:113], v80 offset:53248
    ds_read_b64_tr_b16 v[114:115], v80 offset:55296
    v_mov_b32_dpp v55, v51 row_shl:8 row_mask:0xa bank_mask:0x3
    v_permlane16_swap_b32 v52, v60
    v_permlane16_swap_b32 v53, v61
    s_waitcnt lgkmcnt(4)
    v_mfma_f32_32x32x16_bf16 v[0:15], v[96:99], v[148:151], v[0:15]
    ds_read_b64_tr_b16 v[116:117], v81 offset:20480
    ds_read_b64_tr_b16 v[118:119], v81 offset:22528
    buffer_load_dwordx4 v[144:147], v82, s[28:31], s73 offen offset:0 sc1
    v_permlane16_swap_b32 v54, v62
    s_waitcnt vmcnt(18)
    v_mfma_f32_32x32x16_bf16 v[16:31], v[100:103], v[152:155], v[16:31]
    ds_read_b64_tr_b16 v[96:97], v80 offset:20480
    ds_read_b64_tr_b16 v[98:99], v80 offset:22528
    v_permlane16_swap_b32 v55, v63
    ds_write_b128 v94, v[60:63] offset:0
    v_mfma_f32_32x32x16_bf16 v[32:47], v[104:107], v[152:155], v[32:47]
    ds_read_b64_tr_b16 v[100:101], v80 offset:53760
    ds_read_b64_tr_b16 v[102:103], v80 offset:55808
    v_mov_b32_dpp v76, v72 row_shl:8 row_mask:0xa bank_mask:0x3
    v_mov_b32_dpp v68, v64 row_shl:8 row_mask:0xa bank_mask:0x3
    v_mov_b32_dpp v77, v73 row_shl:8 row_mask:0xa bank_mask:0x3
    s_waitcnt lgkmcnt(5)
    v_mfma_f32_32x32x16_bf16 v[0:15], v[108:111], v[152:155], v[0:15]
    ds_read_b64_tr_b16 v[104:105], v81 offset:20992
    ds_read_b64_tr_b16 v[106:107], v81 offset:23040
    buffer_load_dwordx4 v[148:151], v82, s[28:31], s73 offen offset:1024 sc1
    v_mov_b32_dpp v69, v65 row_shl:8 row_mask:0xa bank_mask:0x3
    s_waitcnt vmcnt(18)
    v_mfma_f32_32x32x16_bf16 v[16:31], v[112:115], v[156:159], v[16:31]
    ds_read_b64_tr_b16 v[108:109], v80 offset:20992
    ds_read_b64_tr_b16 v[110:111], v80 offset:23040
    v_mov_b32_dpp v78, v74 row_shl:8 row_mask:0xa bank_mask:0x3
    v_mov_b32_dpp v70, v66 row_shl:8 row_mask:0xa bank_mask:0x3
    v_mfma_f32_32x32x16_bf16 v[32:47], v[116:119], v[156:159], v[32:47]
    ds_read_b64_tr_b16 v[112:113], v80 offset:54272
    ds_read_b64_tr_b16 v[114:115], v80 offset:56320
    v_mov_b32_dpp v79, v75 row_shl:8 row_mask:0xa bank_mask:0x3
    v_mov_b32_dpp v71, v67 row_shl:8 row_mask:0xa bank_mask:0x3
    v_permlane16_swap_b32 v68, v76
    s_waitcnt lgkmcnt(4)
    v_mfma_f32_32x32x16_bf16 v[0:15], v[96:99], v[156:159], v[0:15]
    ds_read_b64_tr_b16 v[116:117], v81 offset:21504
    ds_read_b64_tr_b16 v[118:119], v81 offset:23552
    buffer_load_dwordx4 v[152:155], v82, s[28:31], s73 offen offset:2048 sc1
    v_permlane16_swap_b32 v69, v77
    s_waitcnt vmcnt(18)
    v_mfma_f32_32x32x16_bf16 v[16:31], v[100:103], v[160:163], v[16:31]
    ds_read_b64_tr_b16 v[96:97], v80 offset:21504
    ds_read_b64_tr_b16 v[98:99], v80 offset:23552
    v_permlane16_swap_b32 v70, v78
    v_permlane16_swap_b32 v71, v79
    v_mfma_f32_32x32x16_bf16 v[32:47], v[104:107], v[160:163], v[32:47]
    ds_read_b64_tr_b16 v[100:101], v80 offset:54784
    ds_read_b64_tr_b16 v[102:103], v80 offset:56832
    ds_write_b128 v94, v[76:79] offset:1024
    s_waitcnt lgkmcnt(5)
    v_mfma_f32_32x32x16_bf16 v[0:15], v[108:111], v[160:163], v[0:15]
    ds_read_b64_tr_b16 v[104:105], v81 offset:22016
    ds_read_b64_tr_b16 v[106:107], v81 offset:24064
    buffer_load_dwordx4 v[156:159], v82, s[28:31], s73 offen offset:3072 sc1
    s_waitcnt vmcnt(17)
    v_mfma_f32_32x32x16_bf16 v[16:31], v[112:115], v[120:123], v[16:31]
    ds_read_b64_tr_b16 v[108:109], v80 offset:22016
    ds_read_b64_tr_b16 v[110:111], v80 offset:24064
    v_mfma_f32_32x32x16_bf16 v[32:47], v[116:119], v[120:123], v[32:47]
    ds_read_b64_tr_b16 v[112:113], v80 offset:57344
    ds_read_b64_tr_b16 v[114:115], v80 offset:59392
    s_waitcnt lgkmcnt(6)
    s_barrier
    buffer_load_dword v196, v89, s[28:31], 0 offen sc1
    s_waitcnt lgkmcnt(4)
    v_mfma_f32_32x32x16_bf16 v[0:15], v[96:99], v[120:123], v[0:15]
    ds_read_b64_tr_b16 v[116:117], v81 offset:24576
    ds_read_b64_tr_b16 v[118:119], v81 offset:26624
    s_add_u32 m0, s77, 65536
    s_add_u32 s95, s76, 917504
    buffer_load_dwordx4 v90, s[16:19], s95 offen lds
    s_waitcnt vmcnt(17)
    v_mfma_f32_32x32x16_bf16 v[16:31], v[100:103], v[124:127], v[16:31]
    ds_read_b64_tr_b16 v[96:97], v80 offset:24576
    ds_read_b64_tr_b16 v[98:99], v80 offset:26624
    v_and_b32 v94, 7, v222
    v_bfe_u32 v86, v222, 3, 1
    v_mfma_f32_32x32x16_bf16 v[32:47], v[104:107], v[124:127], v[32:47]
    ds_read_b64_tr_b16 v[100:101], v80 offset:57856
    ds_read_b64_tr_b16 v[102:103], v80 offset:59904
    v_bfe_u32 v95, v222, 4, 1
    v_lshlrev_b32 v94, 4, v94
    v_lshl_add_u32 v68, v86, 9, v94
    s_waitcnt lgkmcnt(4)
    v_mfma_f32_32x32x16_bf16 v[0:15], v[108:111], v[124:127], v[0:15]
    ds_read_b64_tr_b16 v[104:105], v81 offset:25088
    ds_read_b64_tr_b16 v[106:107], v81 offset:27136
    v_lshl_add_u32 v68, v95, 10, v68
    s_lshl_b32 s92, s44, 7
    s_waitcnt vmcnt(11)
    v_mfma_f32_32x32x16_bf16 v[16:31], v[112:115], v[128:131], v[16:31]
    ds_read_b64_tr_b16 v[108:109], v80 offset:25088
    ds_read_b64_tr_b16 v[110:111], v80 offset:27136
    s_add_u32 m0, s77, 69632
    s_add_u32 s95, s76, 1032192
    buffer_load_dwordx4 v90, s[16:19], s95 offen lds
    v_mfma_f32_32x32x16_bf16 v[32:47], v[116:119], v[128:131], v[32:47]
    ds_read_b64_tr_b16 v[112:113], v80 offset:58368
    ds_read_b64_tr_b16 v[114:115], v80 offset:60416
    s_add_u32 s92, s92, 148480
    v_add_u32 v68, s92, v68
    ds_read_b128 v[48:51], v68 offset:0
    s_waitcnt lgkmcnt(5)
    v_mfma_f32_32x32x16_bf16 v[0:15], v[96:99], v[128:131], v[0:15]
    ds_read_b64_tr_b16 v[116:117], v81 offset:25600
    ds_read_b64_tr_b16 v[118:119], v81 offset:27648
    ds_read_b128 v[52:55], v68 offset:2048
    ds_read_b128 v[56:59], v68 offset:4096
    s_waitcnt vmcnt(11)
    v_mfma_f32_32x32x16_bf16 v[16:31], v[100:103], v[132:135], v[16:31]
    ds_read_b64_tr_b16 v[96:97], v80 offset:25600
    ds_read_b64_tr_b16 v[98:99], v80 offset:27648
    ds_read_b128 v[60:63], v68 offset:6144
    v_lshlrev_b32 v69, 4, v86
    v_mfma_f32_32x32x16_bf16 v[32:47], v[104:107], v[132:135], v[32:47]
    ds_read_b64_tr_b16 v[100:101], v80 offset:58880
    ds_read_b64_tr_b16 v[102:103], v80 offset:60928
    v_lshl_add_u32 v69, v95, 7, v69
    s_lshl_b32 s92, s44, 5
    s_add_u32 s92, s92, 160768
    s_waitcnt lgkmcnt(7)
    v_mfma_f32_32x32x16_bf16 v[0:15], v[108:111], v[132:135], v[0:15]
    ds_read_b64_tr_b16 v[104:105], v81 offset:26112
    ds_read_b64_tr_b16 v[106:107], v81 offset:28160
    s_add_u32 m0, s77, 73728
    s_add_u32 s95, s76, 1146880
    buffer_load_dwordx4 v90, s[16:19], s95 offen lds
    s_waitcnt vmcnt(10)
    v_mfma_f32_32x32x16_bf16 v[16:31], v[112:115], v[136:139], v[16:31]
    ds_read_b64_tr_b16 v[108:109], v80 offset:26112
    ds_read_b64_tr_b16 v[110:111], v80 offset:28160
    v_add_u32 v69, s92, v69
    ds_read_b128 v[64:67], v69
    v_mfma_f32_32x32x16_bf16 v[32:47], v[116:119], v[136:139], v[32:47]
    ds_read_b64_tr_b16 v[112:113], v80 offset:61440
    ds_read_b64_tr_b16 v[114:115], v80 offset:63488
    v_mul_u32_u24 v95, 8704, v95
    v_mul_u32_u24 v86, 2176, v86
    v_add3_u32 v94, v94, v95, v86
    s_waitcnt lgkmcnt(5)
    v_mfma_f32_32x32x16_bf16 v[0:15], v[96:99], v[136:139], v[0:15]
    ds_read_b64_tr_b16 v[116:117], v81 offset:28672
    ds_read_b64_tr_b16 v[118:119], v81 offset:30720
    s_lshr_b32 s92, s44, 1
    s_mul_i32 s92, s92, 4352
    s_waitcnt vmcnt(8)
    v_mfma_f32_32x32x16_bf16 v[16:31], v[100:103], v[140:143], v[16:31]
    ds_read_b64_tr_b16 v[96:97], v80 offset:28672
    ds_read_b64_tr_b16 v[98:99], v80 offset:30720
    s_add_u32 m0, s77, 77824
    s_add_u32 s95, s76, 1261568
    buffer_load_dwordx4 v90, s[16:19], s95 offen lds
    v_mfma_f32_32x32x16_bf16 v[32:47], v[104:107], v[140:143], v[32:47]
    ds_read_b64_tr_b16 v[100:101], v80 offset:61952
    ds_read_b64_tr_b16 v[102:103], v80 offset:64000
    s_and_b32 s93, s44, 1
    s_lshl_b32 s93, s93, 3
    s_add_u32 s92, s92, s93
    s_waitcnt lgkmcnt(4)
    v_mfma_f32_32x32x16_bf16 v[0:15], v[108:111], v[140:143], v[0:15]
    ds_read_b64_tr_b16 v[104:105], v81 offset:29184
    ds_read_b64_tr_b16 v[106:107], v81 offset:31232
    s_add_u32 s92, s92, 131072
    v_add_u32 v94, s92, v94
    s_waitcnt vmcnt(8)
    v_mfma_f32_32x32x16_bf16 v[16:31], v[112:115], v[144:147], v[16:31]
    ds_read_b64_tr_b16 v[108:109], v80 offset:29184
    ds_read_b64_tr_b16 v[110:111], v80 offset:31232
    v_add_f32 v48, v48, v52
    v_mfma_f32_32x32x16_bf16 v[32:47], v[116:119], v[144:147], v[32:47]
    ds_read_b64_tr_b16 v[112:113], v80 offset:62464
    ds_read_b64_tr_b16 v[114:115], v80 offset:64512
    s_add_u32 s91, s50, 8
    s_waitcnt vmcnt(4)
    v_subrev_u32 v196, s91, v196
    v_cmp_gt_u32 vcc, 32, v196
    s_nop 0
    s_andn2_b64 s[96:97], s[54:55], vcc
    s_cbranch_scc1 L_slow_55
L_pback_56:
    s_waitcnt lgkmcnt(4)
    v_mfma_f32_32x32x16_bf16 v[0:15], v[96:99], v[144:147], v[0:15]
    ds_read_b64_tr_b16 v[116:117], v81 offset:29696
    ds_read_b64_tr_b16 v[118:119], v81 offset:31744
    v_mfma_f32_32x32x16_bf16 v[16:31], v[100:103], v[148:151], v[16:31]
    ds_read_b64_tr_b16 v[96:97], v80 offset:29696
    ds_read_b64_tr_b16 v[98:99], v80 offset:31744
    v_add_f32 v49, v49, v53
    v_add_f32 v50, v50, v54
    v_mfma_f32_32x32x16_bf16 v[32:47], v[104:107], v[148:151], v[32:47]
    ds_read_b64_tr_b16 v[100:101], v80 offset:62976
    ds_read_b64_tr_b16 v[102:103], v80 offset:65024
    v_add_f32 v51, v51, v55
    v_add_f32 v48, v48, v56
    v_add_f32 v49, v49, v57
    s_waitcnt lgkmcnt(4)
    v_mfma_f32_32x32x16_bf16 v[0:15], v[108:111], v[148:151], v[0:15]
    ds_read_b64_tr_b16 v[104:105], v81 offset:30208
    ds_read_b64_tr_b16 v[106:107], v81 offset:32256
    v_add_f32 v50, v50, v58
    buffer_load_dwordx4 v[196:199], v85, s[28:31], s66 offen sc1
    v_mfma_f32_32x32x16_bf16 v[16:31], v[112:115], v[152:155], v[16:31]
    ds_read_b64_tr_b16 v[108:109], v80 offset:30208
    ds_read_b64_tr_b16 v[110:111], v80 offset:32256
    v_add_f32 v51, v51, v59
    buffer_load_dwordx4 v[200:203], v85, s[28:31], s67 offen sc1
    v_mfma_f32_32x32x16_bf16 v[32:47], v[116:119], v[152:155], v[32:47]
    v_add_f32 v48, v48, v60
    v_add_f32 v49, v49, v61
    v_add_f32 v50, v50, v62
    v_add_f32 v51, v51, v63
    v_lshrrev_b32 v86, 5, v222
    s_waitcnt lgkmcnt(2)
    v_mfma_f32_32x32x16_bf16 v[0:15], v[96:99], v[152:155], v[0:15]
    v_lshlrev_b32 v86, 4, v86
    v_add_u32 v86, 160768, v86
    v_fma_f32 v48, -v92, v64, v48
    v_mfma_f32_32x32x16_bf16 v[16:31], v[100:103], v[156:159], v[16:31]
    v_fma_f32 v49, -v92, v65, v49
    v_fma_f32 v50, -v92, v66, v50
    v_fma_f32 v51, -v92, v67, v51
    v_mul_f32 v48, v48, v93
    v_mfma_f32_32x32x16_bf16 v[32:47], v[104:107], v[156:159], v[32:47]
    v_mul_f32 v49, v49, v93
    v_mul_f32 v50, v50, v93
    v_mul_f32 v51, v51, v93
    v_cvt_pk_bf16_f32 v52, v48, v49
    v_cvt_pk_bf16_f32 v53, v50, v51
    s_waitcnt lgkmcnt(0)
    v_mfma_f32_32x32x16_bf16 v[0:15], v[108:111], v[156:159], v[0:15]
    ds_write_b64 v94, v[52:53]
    s_waitcnt lgkmcnt(0)
    ds_read_b128 v[48:51], v86 offset:0
    ds_read_b128 v[52:55], v86 offset:32
    ds_read_b128 v[56:59], v86 offset:64
    ds_read_b128 v[60:63], v86 offset:96
    ds_read_b128 v[64:67], v86 offset:128
    ds_read_b128 v[68:71], v86 offset:160
    ds_read_b128 v[72:75], v86 offset:192
    ds_read_b128 v[76:79], v86 offset:224
    ds_read_b128 v[164:167], v86 offset:256
    ds_read_b128 v[168:171], v86 offset:288
    ds_read_b128 v[172:175], v86 offset:320
    ds_read_b128 v[176:179], v86 offset:352
    s_waitcnt vmcnt(0)
    v_add_f32 v196, v196, v200
    v_add_f32 v197, v197, v201
    v_add_f32 v198, v198, v202
    v_add_f32 v199, v199, v203
    v_lshrrev_b32 v87, 4, v222
    v_and_b32 v85, 1, v87
    v_permlane32_swap_b32 v196, v198
    v_permlane32_swap_b32 v197, v199
    v_lshlrev_b32 v85, 7, v85
    v_lshrrev_b32 v87, 1, v87
    v_add_f32 v196, v196, v198
    v_add_f32 v197, v197, v199
    v_lshl_add_u32 v85, v87, 2, v85
    v_and_b32 v87, 15, v222
    v_permlane16_swap_b32 v196, v197
    v_lshl_add_u32 v85, v87, 3, v85
    v_add_f32 v196, v196, v197
    v_add_u32 v85, s90, v85
    ds_write_b32 v85, v196
    v_and_b32 v87, 31, v222
    v_lshlrev_b32 v87, 2, v87
    v_add_u32 v85, s90, v87
    s_waitcnt lgkmcnt(0)
    ds_read2_b32 v[198:199], v85 offset0:0 offset1:32
    s_waitcnt lgkmcnt(0)
    v_mul_f32 v218, 0x3b000000, v198
    v_mul_f32 v199, 0x3b000000, v199
    v_fma_f32 v199, -v218, v218, v199
    v_max_f32 v199, 0, v199
    v_add_f32 v199, 0x3727c5ac, v199
    v_rsq_f32 v219, v199
    s_nop 0
    v_pk_fma_f32 v[16:17], v[48:49], v[218:219], v[16:17] op_sel_hi:[1,0,1] neg_lo:[0,1,0] neg_hi:[0,1,0]
    v_pk_fma_f32 v[18:19], v[50:51], v[218:219], v[18:19] op_sel_hi:[1,0,1] neg_lo:[0,1,0] neg_hi:[0,1,0]
    v_pk_fma_f32 v[20:21], v[52:53], v[218:219], v[20:21] op_sel_hi:[1,0,1] neg_lo:[0,1,0] neg_hi:[0,1,0]
    v_pk_fma_f32 v[22:23], v[54:55], v[218:219], v[22:23] op_sel_hi:[1,0,1] neg_lo:[0,1,0] neg_hi:[0,1,0]
    v_pk_fma_f32 v[24:25], v[56:57], v[218:219], v[24:25] op_sel_hi:[1,0,1] neg_lo:[0,1,0] neg_hi:[0,1,0]
    v_pk_fma_f32 v[26:27], v[58:59], v[218:219], v[26:27] op_sel_hi:[1,0,1] neg_lo:[0,1,0] neg_hi:[0,1,0]
    v_pk_fma_f32 v[28:29], v[60:61], v[218:219], v[28:29] op_sel_hi:[1,0,1] neg_lo:[0,1,0] neg_hi:[0,1,0]
    v_pk_fma_f32 v[30:31], v[62:63], v[218:219], v[30:31] op_sel_hi:[1,0,1] neg_lo:[0,1,0] neg_hi:[0,1,0]
    v_pk_mul_f32 v[16:17], v[16:17], v[218:219] op_sel:[0,1] op_sel_hi:[1,1]
    v_pk_mul_f32 v[18:19], v[18:19], v[218:219] op_sel:[0,1] op_sel_hi:[1,1]
    v_pk_mul_f32 v[20:21], v[20:21], v[218:219] op_sel:[0,1] op_sel_hi:[1,1]
    v_pk_mul_f32 v[22:23], v[22:23], v[218:219] op_sel:[0,1] op_sel_hi:[1,1]
    v_pk_mul_f32 v[24:25], v[24:25], v[218:219] op_sel:[0,1] op_sel_hi:[1,1]
    v_pk_mul_f32 v[26:27], v[26:27], v[218:219] op_sel:[0,1] op_sel_hi:[1,1]
    v_pk_mul_f32 v[28:29], v[28:29], v[218:219] op_sel:[0,1] op_sel_hi:[1,1]
    v_pk_mul_f32 v[30:31], v[30:31], v[218:219] op_sel:[0,1] op_sel_hi:[1,1]
    v_cvt_pk_bf16_f32 v96, v16, v17
    v_cvt_pk_bf16_f32 v97, v18, v19
    v_cvt_pk_bf16_f32 v98, v20, v21
    v_cvt_pk_bf16_f32 v99, v22, v23
    v_cvt_pk_bf16_f32 v100, v24, v25
    v_cvt_pk_bf16_f32 v101, v26, v27
    v_cvt_pk_bf16_f32 v102, v28, v29
    v_cvt_pk_bf16_f32 v103, v30, v31
    ds_write_b128 v217, v[96:99] offset:0
    ds_write_b128 v217, v[100:103] offset:4352
    v_pk_fma_f32 v[32:33], v[64:65], v[218:219], v[32:33] op_sel_hi:[1,0,1] neg_lo:[0,1,0] neg_hi:[0,1,0]
    v_pk_fma_f32 v[34:35], v[66:67], v[218:219], v[34:35] op_sel_hi:[1,0,1] neg_lo:[0,1,0] neg_hi:[0,1,0]
    v_pk_fma_f32 v[36:37], v[68:69], v[218:219], v[36:37] op_sel_hi:[1,0,1] neg_lo:[0,1,0] neg_hi:[0,1,0]
    v_pk_fma_f32 v[38:39], v[70:71], v[218:219], v[38:39] op_sel_hi:[1,0,1] neg_lo:[0,1,0] neg_hi:[0,1,0]
    v_pk_fma_f32 v[40:41], v[72:73], v[218:219], v[40:41] op_sel_hi:[1,0,1] neg_lo:[0,1,0] neg_hi:[0,1,0]
    v_pk_fma_f32 v[42:43], v[74:75], v[218:219], v[42:43] op_sel_hi:[1,0,1] neg_lo:[0,1,0] neg_hi:[0,1,0]
    v_pk_fma_f32 v[44:45], v[76:77], v[218:219], v[44:45] op_sel_hi:[1,0,1] neg_lo:[0,1,0] neg_hi:[0,1,0]
    v_pk_fma_f32 v[46:47], v[78:79], v[218:219], v[46:47] op_sel_hi:[1,0,1] neg_lo:[0,1,0] neg_hi:[0,1,0]
    v_pk_mul_f32 v[32:33], v[32:33], v[218:219] op_sel:[0,1] op_sel_hi:[1,1]
    v_pk_mul_f32 v[34:35], v[34:35], v[218:219] op_sel:[0,1] op_sel_hi:[1,1]
    v_pk_mul_f32 v[36:37], v[36:37], v[218:219] op_sel:[0,1] op_sel_hi:[1,1]
    v_pk_mul_f32 v[38:39], v[38:39], v[218:219] op_sel:[0,1] op_sel_hi:[1,1]
    v_pk_mul_f32 v[40:41], v[40:41], v[218:219] op_sel:[0,1] op_sel_hi:[1,1]
    v_pk_mul_f32 v[42:43], v[42:43], v[218:219] op_sel:[0,1] op_sel_hi:[1,1]
    v_pk_mul_f32 v[44:45], v[44:45], v[218:219] op_sel:[0,1] op_sel_hi:[1,1]
    v_pk_mul_f32 v[46:47], v[46:47], v[218:219] op_sel:[0,1] op_sel_hi:[1,1]
    v_cvt_pk_bf16_f32 v104, v32, v33
    v_cvt_pk_bf16_f32 v105, v34, v35
    v_cvt_pk_bf16_f32 v106, v36, v37
    v_cvt_pk_bf16_f32 v107, v38, v39
    v_cvt_pk_bf16_f32 v108, v40, v41
    v_cvt_pk_bf16_f32 v109, v42, v43
    v_cvt_pk_bf16_f32 v110, v44, v45
    v_cvt_pk_bf16_f32 v111, v46, v47
    ds_write_b128 v217, v[104:107] offset:8704
    ds_write_b128 v217, v[108:111] offset:13056
    v_pk_fma_f32 v[0:1], v[164:165], v[218:219], v[0:1] op_sel_hi:[1,0,1] neg_lo:[0,1,0] neg_hi:[0,1,0]
    v_pk_fma_f32 v[2:3], v[166:167], v[218:219], v[2:3] op_sel_hi:[1,0,1] neg_lo:[0,1,0] neg_hi:[0,1,0]
    v_pk_fma_f32 v[4:5], v[168:169], v[218:219], v[4:5] op_sel_hi:[1,0,1] neg_lo:[0,1,0] neg_hi:[0,1,0]
    v_pk_fma_f32 v[6:7], v[170:171], v[218:219], v[6:7] op_sel_hi:[1,0,1] neg_lo:[0,1,0] neg_hi:[0,1,0]
    v_pk_fma_f32 v[8:9], v[172:173], v[218:219], v[8:9] op_sel_hi:[1,0,1] neg_lo:[0,1,0] neg_hi:[0,1,0]
    v_pk_fma_f32 v[10:11], v[174:175], v[218:219], v[10:11] op_sel_hi:[1,0,1] neg_lo:[0,1,0] neg_hi:[0,1,0]
    v_pk_fma_f32 v[12:13], v[176:177], v[218:219], v[12:13] op_sel_hi:[1,0,1] neg_lo:[0,1,0] neg_hi:[0,1,0]
    v_pk_fma_f32 v[14:15], v[178:179], v[218:219], v[14:15] op_sel_hi:[1,0,1] neg_lo:[0,1,0] neg_hi:[0,1,0]
    v_cvt_pk_bf16_f32 v112, v0, v1
    v_cvt_pk_bf16_f32 v113, v2, v3
    v_cvt_pk_bf16_f32 v114, v4, v5
    v_cvt_pk_bf16_f32 v115, v6, v7
    v_cvt_pk_bf16_f32 v116, v8, v9
    v_cvt_pk_bf16_f32 v117, v10, v11
    v_cvt_pk_bf16_f32 v118, v12, v13
    v_cvt_pk_bf16_f32 v119, v14, v15
    v_mul_f32 v144, 0x3eb8aa3b, v219
    v_permlane32_swap_b32 v112, v116
    v_permlane32_swap_b32 v113, v117
    v_permlane32_swap_b32 v114, v118
    v_permlane32_swap_b32 v115, v119
    s_waitcnt lgkmcnt(0)
    s_barrier
    ds_read_b128 v[16:19], v220 offset:0
    ds_read_b128 v[20:23], v220 offset:2176
    ds_read_b128 v[24:27], v220 offset:64
    ds_read_b128 v[28:31], v220 offset:2240
    ds_read_b128 v[32:35], v220 offset:128
    ds_read_b128 v[36:39], v220 offset:2304
    ds_read_b64_tr_b16 v[40:41], v216 offset:0
    ds_read_b64_tr_b16 v[42:43], v216 offset:2176
    ds_read_b64_tr_b16 v[44:45], v216 offset:8
    ds_read_b64_tr_b16 v[46:47], v216 offset:2184
    ds_read_b64_tr_b16 v[48:49], v216 offset:64
    ds_read_b64_tr_b16 v[50:51], v216 offset:2240
    ds_read_b64_tr_b16 v[52:53], v216 offset:72
    ds_read_b64_tr_b16 v[54:55], v216 offset:2248
    ds_read_b64_tr_b16 v[56:57], v216 offset:128
    ds_read_b64_tr_b16 v[58:59], v216 offset:2304
    ds_read_b64_tr_b16 v[60:61], v216 offset:136
    ds_read_b64_tr_b16 v[62:63], v216 offset:2312
    s_waitcnt lgkmcnt(12)
    v_mfma_f32_4x4x4_16b_bf16 v[64:67], v[16:17], v[112:113], v[204:207]
    v_mfma_f32_4x4x4_16b_bf16 v[68:71], v[24:25], v[112:113], v[208:211]
    v_mfma_f32_4x4x4_16b_bf16 v[72:75], v[32:33], v[112:113], v[212:215]
    v_mfma_f32_4x4x4_16b_bf16 v[64:67], v[18:19], v[114:115], v[64:67]
    v_mfma_f32_4x4x4_16b_bf16 v[68:71], v[26:27], v[114:115], v[68:71]
    v_mfma_f32_4x4x4_16b_bf16 v[72:75], v[34:35], v[114:115], v[72:75]
    v_mfma_f32_4x4x4_16b_bf16 v[64:67], v[20:21], v[116:117], v[64:67]
    v_mfma_f32_4x4x4_16b_bf16 v[68:71], v[28:29], v[116:117], v[68:71]
    v_mfma_f32_4x4x4_16b_bf16 v[72:75], v[36:37], v[116:117], v[72:75]
    v_mfma_f32_4x4x4_16b_bf16 v[64:67], v[22:23], v[118:119], v[64:67]
    v_mfma_f32_4x4x4_16b_bf16 v[68:71], v[30:31], v[118:119], v[68:71]
    v_mfma_f32_4x4x4_16b_bf16 v[72:75], v[38:39], v[118:119], v[72:75]
    s_nop 2
    v_max3_f32 v145, v64, v65, v66
    v_max3_f32 v145, v145, v67, v68
    v_max3_f32 v145, v145, v69, v70
    v_max3_f32 v145, v145, v71, v72
    v_max3_f32 v145, v145, v73, v74
    v_max_f32 v145, v145, v75
    v_mul_f32 v145, v145, v144
    v_pk_fma_f32 v[64:65], v[64:65], v[144:145], v[144:145] op_sel:[0,0,1] op_sel_hi:[1,0,1] neg_lo:[0,0,1] neg_hi:[0,0,1]
    v_pk_fma_f32 v[66:67], v[66:67], v[144:145], v[144:145] op_sel:[0,0,1] op_sel_hi:[1,0,1] neg_lo:[0,0,1] neg_hi:[0,0,1]
    v_pk_fma_f32 v[68:69], v[68:69], v[144:145], v[144:145] op_sel:[0,0,1] op_sel_hi:[1,0,1] neg_lo:[0,0,1] neg_hi:[0,0,1]
    v_pk_fma_f32 v[70:71], v[70:71], v[144:145], v[144:145] op_sel:[0,0,1] op_sel_hi:[1,0,1] neg_lo:[0,0,1] neg_hi:[0,0,1]
    v_pk_fma_f32 v[72:73], v[72:73], v[144:145], v[144:145] op_sel:[0,0,1] op_sel_hi:[1,0,1] neg_lo:[0,0,1] neg_hi:[0,0,1]
    v_pk_fma_f32 v[74:75], v[74:75], v[144:145], v[144:145] op_sel:[0,0,1] op_sel_hi:[1,0,1] neg_lo:[0,0,1] neg_hi:[0,0,1]
    v_exp_f32 v64, v64
    v_exp_f32 v65, v65
    v_exp_f32 v66, v66
    v_exp_f32 v67, v67
    v_exp_f32 v68, v68
    v_exp_f32 v69, v69
    v_exp_f32 v70, v70
    v_exp_f32 v71, v71
    v_exp_f32 v72, v72
    v_exp_f32 v73, v73
    v_exp_f32 v74, v74
    v_exp_f32 v75, v75
    v_pk_add_f32 v[144:145], v[64:65], v[66:67]
    v_pk_add_f32 v[144:145], v[144:145], v[68:69]
    v_pk_add_f32 v[144:145], v[144:145], v[70:71]
    v_pk_add_f32 v[144:145], v[144:145], v[72:73]
    v_pk_add_f32 v[144:145], v[144:145], v[74:75]
    v_add_f32 v144, v144, v145
    v_rcp_f32 v144, v144
    v_mov_b32 v210, v90
    v_pk_mul_f32 v[64:65], v[64:65], v[144:145] op_sel_hi:[1,0]
    v_pk_mul_f32 v[66:67], v[66:67], v[144:145] op_sel_hi:[1,0]
    v_pk_mul_f32 v[68:69], v[68:69], v[144:145] op_sel_hi:[1,0]
    v_pk_mul_f32 v[70:71], v[70:71], v[144:145] op_sel_hi:[1,0]
    v_pk_mul_f32 v[72:73], v[72:73], v[144:145] op_sel_hi:[1,0]
    v_pk_mul_f32 v[74:75], v[74:75], v[144:145] op_sel_hi:[1,0]
    v_cvt_pk_bf16_f32 v120, v64, v65
    v_cvt_pk_bf16_f32 v121, v66, v67
    v_cvt_pk_bf16_f32 v122, v68, v69
    v_cvt_pk_bf16_f32 v123, v70, v71
    v_cvt_pk_bf16_f32 v124, v72, v73
    v_cvt_pk_bf16_f32 v125, v74, v75
    s_lshl_b32 s92, s45, 2
    s_add_u32 s92, s92, s44
    s_lshl_b32 s92, s92, 2
    s_add_u32 s92, s92, 1769472
    v_mov_b32 v208, 2130706432
    v_writelane_b32 v208, s92, 0
    v_lshlrev_b32 v209, 2, v222
    v_add_u32 v209, 1769472, v209
    s_waitcnt lgkmcnt(8)
    v_mfma_f32_4x4x4_16b_bf16 v[128:131], v[40:41], v[120:121], 0
    v_mfma_f32_4x4x4_16b_bf16 v[132:135], v[42:43], v[120:121], 0
    v_mfma_f32_4x4x4_16b_bf16 v[136:139], v[44:45], v[120:121], 0
    v_mfma_f32_4x4x4_16b_bf16 v[140:143], v[46:47], v[120:121], 0
    s_waitcnt lgkmcnt(4)
    v_mfma_f32_4x4x4_16b_bf16 v[128:131], v[48:49], v[122:123], v[128:131]
    v_mfma_f32_4x4x4_16b_bf16 v[132:135], v[50:51], v[122:123], v[132:135]
    v_mfma_f32_4x4x4_16b_bf16 v[136:139], v[52:53], v[122:123], v[136:139]
    v_mfma_f32_4x4x4_16b_bf16 v[140:143], v[54:55], v[122:123], v[140:143]
    s_waitcnt lgkmcnt(0)
    v_mfma_f32_4x4x4_16b_bf16 v[128:131], v[56:57], v[124:125], v[128:131]
    v_mfma_f32_4x4x4_16b_bf16 v[132:135], v[58:59], v[124:125], v[132:135]
    v_mfma_f32_4x4x4_16b_bf16 v[136:139], v[60:61], v[124:125], v[136:139]
    v_mfma_f32_4x4x4_16b_bf16 v[140:143], v[62:63], v[124:125], v[140:143]
    s_add_u32 s92, s50, 9
    v_mov_b32 v10, s92
    v_cvt_pk_bf16_f32 v0, v128, v129
    v_cvt_pk_bf16_f32 v1, v130, v131
    v_cvt_pk_bf16_f32 v2, v132, v133
    v_cvt_pk_bf16_f32 v3, v134, v135
    v_cvt_pk_bf16_f32 v4, v136, v137
    v_cvt_pk_bf16_f32 v5, v138, v139
    v_cvt_pk_bf16_f32 v6, v140, v141
    v_cvt_pk_bf16_f32 v7, v142, v143
    s_cmp_eq_u32 s52, 1
    s_cbranch_scc0 L_safe_60
    buffer_store_dwordx4 v[0:3], v223, s[28:31], s84 offen offset:0
    buffer_store_dwordx4 v[4:7], v223, s[28:31], s84 offen offset:1024
L_back_61:
    s_lshl_b32 s92, s46, 2
    s_add_u32 s92, s92, s44
    s_lshl_b32 s93, s47, 6
    s_add_u32 s93, s93, s92
    s_lshl_b32 s84, s93, 10
    s_lshl_b32 s93, s92, 10
    s_lshl_b32 s94, s47, 9
    s_add_u32 s85, s93, s94
    s_lshl_b32 s86, s92, 6
    s_mov_b32 s87, s93
    s_add_u32 s92, s84, 0
    s_add_u32 s93, s92, 32768
    buffer_load_dwordx4 v[176:179], v223, s[28:31], s92 offen sc1
    buffer_load_dwordx4 v[180:183], v223, s[28:31], s93 offen sc1
    v_and_b32 v184, 31, v222
    v_lshrrev_b32 v185, 5, v222
    v_lshlrev_b32 v215, 3, v184
    v_lshl_add_u32 v215, v185, 2, v215
    s_lshl_b32 s92, s44, 3
    s_lshl_b32 s93, s47, 6
    s_add_u32 s92, s92, s93
    s_lshl_b32 s92, s92, 10
    s_add_u32 s92, s92, 262144
    v_add_u32 v217, s92, v223
    v_add_u32 v220, 32768, v217
    s_waitcnt vmcnt(2)
    s_cmp_eq_u32 s52, 1
    s_cbranch_scc0 L_safe_62
    buffer_store_dword v10, v208, s[28:31], 0 offen
L_back_63:
    s_barrier
    s_lshl_b32 s92, s44, 8
    s_add_u32 s92, s92, 157696
    v_lshlrev_b32 v156, 2, v222
    v_add_u32 v156, s92, v156
    s_add_u32 s92, s44, 0
    s_and_b32 s92, s92, 3
    s_mul_i32 s93, s92, 6144
    s_add_u32 s93, s93, 131072
    v_add_u32 v214, s93, v223
    s_lshr_b32 s93, s92, 1
    s_mul_i32 s93, s93, 0
    s_add_u32 s93, s93, 0
    v_add_u32 v155, s93, v214
    s_add_u32 s92, s44, 1
    s_and_b32 s92, s92, 3
    s_mul_i32 s93, s92, 6144
    s_add_u32 s93, s93, 131072
    v_add_u32 v211, s93, v223
    s_lshr_b32 s93, s92, 1
    s_mul_i32 s93, s93, 0
    s_add_u32 s93, s93, 0
    v_add_u32 v152, s93, v211
    s_add_u32 s92, s44, 2
    s_and_b32 s92, s92, 3
    s_mul_i32 s93, s92, 6144
    s_add_u32 s93, s93, 133120
    v_add_u32 v212, s93, v223
    s_lshr_b32 s93, s92, 1
    s_mul_i32 s93, s93, 0
    s_add_u32 s93, s93, 0
    v_add_u32 v153, s93, v212
    s_add_u32 s92, s44, 3
    s_and_b32 s92, s92, 3
    s_mul_i32 s93, s92, 6144
    s_add_u32 s93, s93, 135168
    v_add_u32 v213, s93, v223
    s_lshr_b32 s93, s92, 1
    s_mul_i32 s93, s93, 0
    s_add_u32 s93, s93, 0
    v_add_u32 v154, s93, v213
    s_add_u32 s91, s50, 9
L_poll_64:
    buffer_load_dword v184, v209, s[28:31], 0 offen sc1
    s_waitcnt vmcnt(0)
    v_subrev_u32 v184, s91, v184
    v_cmp_gt_u32 vcc, 32, v184
    s_nop 0
    s_andn2_b64 s[96:97], s[56:57], vcc
    s_cbranch_scc1 L_chk_65
L_done_66:
    buffer_load_dwordx4 v[64:67], v217, s[28:31], s66 offen offset:0 sc1
    buffer_load_dwordx4 v[68:71], v217, s[28:31], s66 offen offset:1024 sc1
    buffer_load_dwordx4 v[72:75], v217, s[28:31], s66 offen offset:2048 sc1
    buffer_load_dwordx4 v[76:79], v217, s[28:31], s66 offen offset:3072 sc1
    buffer_load_dwordx4 v[80:83], v217, s[28:31], s67 offen offset:0 sc1
    buffer_load_dwordx4 v[84:87], v217, s[28:31], s67 offen offset:1024 sc1
    buffer_load_dwordx4 v[88:91], v217, s[28:31], s67 offen offset:2048 sc1
    buffer_load_dwordx4 v[92:95], v217, s[28:31], s67 offen offset:3072 sc1
    buffer_load_dwordx4 v[96:99], v220, s[28:31], s66 offen offset:0 sc1
    buffer_load_dwordx4 v[100:103], v220, s[28:31], s66 offen offset:1024 sc1
    buffer_load_dwordx4 v[104:107], v220, s[28:31], s66 offen offset:2048 sc1
    v_lshlrev_b32 v160, 16, v176
    v_and_b32 v161, 0xffff0000, v176
    v_lshlrev_b32 v162, 16, v177
    v_and_b32 v163, 0xffff0000, v177
    v_lshlrev_b32 v164, 16, v178
    v_and_b32 v165, 0xffff0000, v178
    v_lshlrev_b32 v166, 16, v179
    v_and_b32 v167, 0xffff0000, v179
    v_lshlrev_b32 v168, 16, v180
    v_and_b32 v169, 0xffff0000, v180
    v_lshlrev_b32 v170, 16, v181
    v_and_b32 v171, 0xffff0000, v181
    v_lshlrev_b32 v172, 16, v182
    v_and_b32 v173, 0xffff0000, v182
    v_lshlrev_b32 v174, 16, v183
    v_and_b32 v175, 0xffff0000, v183
    s_waitcnt vmcnt(10)
    v_mfma_f32_32x32x16_bf16 v[0:15], a[224:227], v[64:67], 0
    v_mfma_f32_32x32x16_bf16 v[16:31], a[228:231], v[64:67], 0
    buffer_load_dwordx4 v[108:111], v220, s[28:31], s66 offen offset:3072 sc1
    s_waitcnt vmcnt(10)
    v_mfma_f32_32x32x16_bf16 v[0:15], a[232:235], v[68:71], v[0:15]
    v_mfma_f32_32x32x16_bf16 v[16:31], a[236:239], v[68:71], v[16:31]
    buffer_load_dwordx4 v[112:115], v220, s[28:31], s67 offen offset:0 sc1
    s_waitcnt vmcnt(10)
    v_mfma_f32_32x32x16_bf16 v[0:15], a[240:243], v[72:75], v[0:15]
    v_mfma_f32_32x32x16_bf16 v[16:31], a[244:247], v[72:75], v[16:31]
    buffer_load_dwordx4 v[116:119], v220, s[28:31], s67 offen offset:1024 sc1
    s_waitcnt vmcnt(10)
    v_mfma_f32_32x32x16_bf16 v[0:15], a[248:251], v[76:79], v[0:15]
    v_mfma_f32_32x32x16_bf16 v[16:31], a[252:255], v[76:79], v[16:31]
    buffer_load_dwordx4 v[120:123], v220, s[28:31], s67 offen offset:2048 sc1
    s_waitcnt vmcnt(10)
    v_mfma_f32_32x32x16_bf16 v[0:15], v[224:227], v[80:83], v[0:15]
    v_mfma_f32_32x32x16_bf16 v[16:31], v[228:231], v[80:83], v[16:31]
    buffer_load_dwordx4 v[124:127], v220, s[28:31], s67 offen offset:3072 sc1
    s_waitcnt vmcnt(10)
    v_mfma_f32_32x32x16_bf16 v[0:15], v[232:235], v[84:87], v[0:15]
    v_mfma_f32_32x32x16_bf16 v[16:31], v[236:239], v[84:87], v[16:31]
    s_add_u32 m0, s77, 81920
    s_add_u32 s95, s76, 1376256
    buffer_load_dwordx4 v210, s[16:19], s95 offen lds
    s_waitcnt vmcnt(10)
    v_mfma_f32_32x32x16_bf16 v[0:15], v[240:243], v[88:91], v[0:15]
    v_mfma_f32_32x32x16_bf16 v[16:31], v[244:247], v[88:91], v[16:31]
    s_add_u32 m0, s77, 86016
    s_add_u32 s95, s76, 1490944
    buffer_load_dwordx4 v210, s[16:19], s95 offen lds
    s_waitcnt vmcnt(10)
    v_mfma_f32_32x32x16_bf16 v[0:15], v[248:251], v[92:95], v[0:15]
    v_mfma_f32_32x32x16_bf16 v[16:31], v[252:255], v[92:95], v[16:31]
    s_add_u32 m0, s77, 90112
    s_add_u32 s95, s76, 1605632
    buffer_load_dwordx4 v210, s[16:19], s95 offen lds
    s_waitcnt vmcnt(10)
    v_mfma_f32_32x32x16_bf16 v[32:47], a[224:227], v[96:99], 0
    v_mfma_f32_32x32x16_bf16 v[48:63], a[228:231], v[96:99], 0
    s_add_u32 m0, s77, 94208
    s_add_u32 s95, s76, 1720320
    buffer_load_dwordx4 v210, s[16:19], s95 offen lds
    s_waitcnt vmcnt(10)
    v_mfma_f32_32x32x16_bf16 v[32:47], a[232:235], v[100:103], v[32:47]
    ds_write_b128 v211, v[4:7] offset:0
    ds_write_b128 v211, v[20:23] offset:1024
    v_mfma_f32_32x32x16_bf16 v[48:63], a[236:239], v[100:103], v[48:63]
    ds_write_b128 v212, v[8:11] offset:0
    ds_write_b128 v212, v[24:27] offset:1024
    s_waitcnt vmcnt(9)
    v_mfma_f32_32x32x16_bf16 v[32:47], a[240:243], v[104:107], v[32:47]
    ds_write_b128 v213, v[12:15] offset:0
    ds_write_b128 v213, v[28:31] offset:1024
    v_mfma_f32_32x32x16_bf16 v[48:63], a[244:247], v[104:107], v[48:63]
    s_waitcnt vmcnt(8)
    v_mfma_f32_32x32x16_bf16 v[32:47], a[248:251], v[108:111], v[32:47]
    v_mfma_f32_32x32x16_bf16 v[48:63], a[252:255], v[108:111], v[48:63]
    s_waitcnt vmcnt(7)
    v_mfma_f32_32x32x16_bf16 v[32:47], v[224:227], v[112:115], v[32:47]
    s_waitcnt lgkmcnt(0)
    s_barrier
    ds_read_b128 v[184:187], v214 offset:0
    ds_read_b128 v[188:191], v214 offset:1024
    v_mfma_f32_32x32x16_bf16 v[48:63], v[228:231], v[112:115], v[48:63]
    ds_read_b128 v[192:195], v214 offset:2048
    ds_read_b128 v[196:199], v214 offset:3072
    ds_read_b128 v[200:203], v214 offset:4096
    ds_read_b128 v[204:207], v214 offset:5120
    s_waitcnt vmcnt(6)
    v_mfma_f32_32x32x16_bf16 v[32:47], v[232:235], v[116:119], v[32:47]
    v_mfma_f32_32x32x16_bf16 v[48:63], v[236:239], v[116:119], v[48:63]
    s_waitcnt vmcnt(5)
    v_mfma_f32_32x32x16_bf16 v[32:47], v[240:243], v[120:123], v[32:47]
    v_mfma_f32_32x32x16_bf16 v[48:63], v[244:247], v[120:123], v[48:63]
    s_waitcnt vmcnt(4)
    v_mfma_f32_32x32x16_bf16 v[32:47], v[248:251], v[124:127], v[32:47]
    v_mfma_f32_32x32x16_bf16 v[48:63], v[252:255], v[124:127], v[48:63]
    s_waitcnt lgkmcnt(0)
    s_barrier
    s_nop 8
    ds_write_b128 v152, v[36:39] offset:0
    s_add_u32 s94, s84, 0
    v_pk_add_f32 v[0:1], v[0:1], v[184:185]
    v_pk_add_f32 v[2:3], v[2:3], v[186:187]
    v_pk_add_f32 v[16:17], v[16:17], v[188:189]
    v_pk_add_f32 v[18:19], v[18:19], v[190:191]
    ds_write_b128 v152, v[52:55] offset:1024
    v_pk_add_f32 v[0:1], v[0:1], v[192:193]
    v_pk_add_f32 v[2:3], v[2:3], v[194:195]
    v_pk_add_f32 v[16:17], v[16:17], v[196:197]
    v_pk_add_f32 v[18:19], v[18:19], v[198:199]
    v_pk_add_f32 v[0:1], v[0:1], v[200:201]
    ds_write_b128 v153, v[40:43] offset:0
    v_pk_add_f32 v[2:3], v[2:3], v[202:203]
    v_pk_add_f32 v[16:17], v[16:17], v[204:205]
    v_pk_add_f32 v[18:19], v[18:19], v[206:207]
    v_pk_add_f32 v[160:161], v[0:1], v[160:161]
    v_pk_add_f32 v[162:163], v[2:3], v[162:163]
    v_pk_add_f32 v[164:165], v[16:17], v[164:165]
    v_pk_add_f32 v[166:167], v[18:19], v[166:167]
    ds_write_b128 v153, v[56:59] offset:1024
    v_cvt_pk_bf16_f32 v176, v160, v161
    v_cvt_pk_bf16_f32 v177, v162, v163
    v_cvt_pk_bf16_f32 v178, v164, v165
    v_cvt_pk_bf16_f32 v179, v166, v167
    s_cmp_eq_u32 s52, 1
    s_cbranch_scc0 L_safe_67
    buffer_store_dwordx4 v[176:179], v223, s[28:31], s94 offen
L_back_68:
    ds_write_b128 v154, v[44:47] offset:0
    v_pk_add_f32 v[4:5], v[160:161], v[162:163]
    v_pk_mul_f32 v[6:7], v[160:161], v[160:161]
    v_pk_add_f32 v[4:5], v[4:5], v[164:165]
    v_pk_fma_f32 v[6:7], v[162:163], v[162:163], v[6:7]
    v_pk_add_f32 v[4:5], v[4:5], v[166:167]
    v_pk_fma_f32 v[6:7], v[164:165], v[164:165], v[6:7]
    ds_write_b128 v154, v[60:63] offset:1024
    v_add_f32 v4, v4, v5
    v_pk_fma_f32 v[6:7], v[166:167], v[166:167], v[6:7]
    v_add_f32 v6, v6, v7
    s_nop 1
    v_permlane32_swap_b32 v4, v6
    v_add_f32 v4, v4, v6
    ds_write_b32 v156, v4 offset:0
    s_waitcnt lgkmcnt(1)
    s_barrier
    ds_read_b128 v[128:131], v155 offset:0
    ds_read_b128 v[132:135], v155 offset:1024
    ds_read_b128 v[136:139], v155 offset:2048
    ds_read_b128 v[140:143], v155 offset:3072
    ds_read_b128 v[144:147], v155 offset:4096
    ds_read_b128 v[148:151], v155 offset:5120
    s_add_u32 s92, s84, 32768
    s_waitcnt lgkmcnt(4)
    v_pk_add_f32 v[32:33], v[32:33], v[128:129]
    v_pk_add_f32 v[34:35], v[34:35], v[130:131]
    v_pk_add_f32 v[48:49], v[48:49], v[132:133]
    v_pk_add_f32 v[50:51], v[50:51], v[134:135]
    s_waitcnt lgkmcnt(2)
    v_pk_add_f32 v[32:33], v[32:33], v[136:137]
    v_pk_add_f32 v[34:35], v[34:35], v[138:139]
    v_pk_add_f32 v[48:49], v[48:49], v[140:141]
    v_pk_add_f32 v[50:51], v[50:51], v[142:143]
    s_waitcnt lgkmcnt(0)
    v_pk_add_f32 v[32:33], v[32:33], v[144:145]
    v_pk_add_f32 v[34:35], v[34:35], v[146:147]
    v_pk_add_f32 v[48:49], v[48:49], v[148:149]
    v_pk_add_f32 v[50:51], v[50:51], v[150:151]
    v_pk_add_f32 v[168:169], v[32:33], v[168:169]
    v_pk_add_f32 v[170:171], v[34:35], v[170:171]
    v_pk_add_f32 v[172:173], v[48:49], v[172:173]
    v_pk_add_f32 v[174:175], v[50:51], v[174:175]
    v_cvt_pk_bf16_f32 v180, v168, v169
    v_cvt_pk_bf16_f32 v181, v170, v171
    v_cvt_pk_bf16_f32 v182, v172, v173
    v_cvt_pk_bf16_f32 v183, v174, v175
    s_cmp_eq_u32 s52, 1
    s_cbranch_scc0 L_safe_69
    buffer_store_dwordx4 v[180:183], v223, s[28:31], s92 offen
L_back_70:
    v_pk_add_f32 v[36:37], v[168:169], v[170:171]
    v_pk_mul_f32 v[38:39], v[168:169], v[168:169]
    v_pk_add_f32 v[36:37], v[36:37], v[172:173]
    v_pk_fma_f32 v[38:39], v[170:171], v[170:171], v[38:39]
    v_pk_add_f32 v[36:37], v[36:37], v[174:175]
    v_pk_fma_f32 v[38:39], v[172:173], v[172:173], v[38:39]
    v_add_f32 v36, v36, v37
    v_pk_fma_f32 v[38:39], v[174:175], v[174:175], v[38:39]
    v_add_f32 v38, v38, v39
    s_nop 1
    v_permlane32_swap_b32 v36, v38
    v_add_f32 v36, v36, v38
    ds_write_b32 v156, v36 offset:1024
    s_add_u32 s92, s50, 10
    v_mov_b32 v220, s92
    v_and_b32 v211, 3, v222
    v_bfe_u32 v215, v222, 4, 1
    v_lshl_add_u32 v211, v215, 2, v211
    v_lshlrev_b32 v211, 3, v211
    v_bfe_u32 v215, v222, 2, 2
    v_lshl_add_u32 v211, v215, 7, v211
    v_bfe_u32 v215, v222, 3, 1
    v_lshl_add_u32 v211, v215, 6, v211
    v_lshrrev_b32 v215, 5, v222
    v_lshl_add_u32 v211, v215, 9, v211
    v_xor_b32 v212, 64, v211
    s_lshl_b32 s92, s44, 15
    s_add_u32 s92, s92, 0
    v_add_u32 v213, s92, v223
    v_add_u32 v211, 98304, v211
    v_add_u32 v212, 98304, v212
    s_waitcnt vmcnt(0)
    s_cmp_eq_u32 s52, 1
    s_cbranch_scc0 L_safe_71
    buffer_store_dword v220, v208, s[28:31], 0 offen
L_back_72:
    s_min_u32 s92, s45, 13
    s_lshl_b32 s92, s92, 3
    s_mul_i32 s93, s44, 112
    s_add_u32 s92, s92, s93
    s_lshl_b32 s92, s92, 10
    s_add_u32 s84, s92, 262144
    s_add_u32 s85, s84, 4096
    v_lshrrev_b32 v217, 5, v222
    v_lshlrev_b32 v217, 4, v217
    v_add_u32 v217, 159744, v217
    s_waitcnt lgkmcnt(0)
    s_barrier
    ds_read_b64_tr_b16 v[192:193], v211 offset:0
    ds_read_b64_tr_b16 v[194:195], v211 offset:4096
    ds_read_b64_tr_b16 v[196:197], v212 offset:0
    ds_read_b64_tr_b16 v[198:199], v212 offset:4096
    ds_read_b64_tr_b16 v[200:201], v211 offset:1024
    ds_read_b64_tr_b16 v[202:203], v211 offset:5120
    s_add_u32 s91, s50, 10
L_poll_73:
    buffer_load_dword v215, v209, s[28:31], 0 offen sc1
    s_waitcnt vmcnt(0)
    v_subrev_u32 v215, s91, v215
    v_cmp_gt_u32 vcc, 32, v215
    s_nop 0
    s_andn2_b64 s[96:97], s[54:55], vcc
    s_cbranch_scc1 L_chk_74
L_done_75:
    buffer_load_dwordx4 v[0:3], v213, s[28:31], s66 offen offset:0 sc1
    buffer_load_dwordx4 v[4:7], v213, s[28:31], s66 offen offset:1024 sc1
    buffer_load_dwordx4 v[8:11], v213, s[28:31], s66 offen offset:2048 sc1
    buffer_load_dwordx4 v[12:15], v213, s[28:31], s66 offen offset:3072 sc1
    buffer_load_dwordx4 v[16:19], v213, s[28:31], s67 offen offset:0 sc1
    buffer_load_dwordx4 v[20:23], v213, s[28:31], s67 offen offset:1024 sc1
    buffer_load_dwordx4 v[24:27], v213, s[28:31], s67 offen offset:2048 sc1
    buffer_load_dwordx4 v[28:31], v213, s[28:31], s67 offen offset:3072 sc1
    buffer_load_dwordx4 v[32:35], v213, s[28:31], s68 offen offset:0 sc1
    buffer_load_dwordx4 v[36:39], v213, s[28:31], s68 offen offset:1024 sc1
    s_waitcnt vmcnt(9) lgkmcnt(2)
    v_mfma_f32_32x32x16_bf16 v[128:143], v[192:195], v[0:3], 0
    ds_read_b64_tr_b16 v[204:205], v212 offset:1024
    ds_read_b64_tr_b16 v[206:207], v212 offset:5120
    s_and_b32 s92, s44, 1
    s_lshl_b32 s93, s92, 10
    v_mfma_f32_32x32x16_bf16 v[144:159], v[196:199], v[0:3], 0
    ds_read_b64_tr_b16 v[192:193], v211 offset:2048
    ds_read_b64_tr_b16 v[194:195], v211 offset:6144
    buffer_load_dwordx4 v[40:43], v213, s[28:31], s68 offen offset:2048 sc1
    s_add_u32 s93, s93, 157696
    v_lshlrev_b32 v164, 2, v222
    s_waitcnt vmcnt(9) lgkmcnt(2)
    v_mfma_f32_32x32x16_bf16 v[128:143], v[200:203], v[4:7], v[128:143]
    ds_read_b64_tr_b16 v[196:197], v212 offset:2048
    ds_read_b64_tr_b16 v[198:199], v212 offset:6144
    v_add_u32 v164, s93, v164
    ds_read2st64_b32 v[160:161], v164 offset0:0 offset1:1
    ds_read2st64_b32 v[162:163], v164 offset0:2 offset1:3
    v_mfma_f32_32x32x16_bf16 v[144:159], v[204:207], v[4:7], v[144:159]
    ds_read_b64_tr_b16 v[200:201], v211 offset:3072
    ds_read_b64_tr_b16 v[202:203], v211 offset:7168
    buffer_load_dwordx4 v[44:47], v213, s[28:31], s68 offen offset:3072 sc1
    s_lshl_b32 s92, s92, 8
    s_lshl_b32 s93, s47, 9
    s_waitcnt vmcnt(9) lgkmcnt(4)
    v_mfma_f32_32x32x16_bf16 v[128:143], v[192:195], v[8:11], v[128:143]
    ds_read_b64_tr_b16 v[204:205], v212 offset:3072
    ds_read_b64_tr_b16 v[206:207], v212 offset:7168
    s_add_u32 s92, s92, s93
    s_lshl_b32 s93, s46, 10
    v_mfma_f32_32x32x16_bf16 v[144:159], v[196:199], v[8:11], v[144:159]
    ds_read_b64_tr_b16 v[192:193], v211 offset:8192
    ds_read_b64_tr_b16 v[194:195], v211 offset:12288
    buffer_load_dwordx4 v[48:51], v213, s[28:31], s69 offen offset:0 sc1
    s_add_u32 s92, s92, s93
    s_add_u32 s94, s92, 1572864
    s_waitcnt vmcnt(9) lgkmcnt(2)
    v_mfma_f32_32x32x16_bf16 v[128:143], v[200:203], v[12:15], v[128:143]
    ds_read_b64_tr_b16 v[196:197], v212 offset:8192
    ds_read_b64_tr_b16 v[198:199], v212 offset:12288
    v_and_b32 v164, 31, v222
    v_lshrrev_b32 v165, 5, v222
    v_mfma_f32_32x32x16_bf16 v[144:159], v[204:207], v[12:15], v[144:159]
    ds_read_b64_tr_b16 v[200:201], v211 offset:9216
    ds_read_b64_tr_b16 v[202:203], v211 offset:13312
    buffer_load_dwordx4 v[52:55], v213, s[28:31], s69 offen offset:1024 sc1
    v_lshlrev_b32 v164, 3, v164
    v_lshl_add_u32 v164, v165, 2, v164
    s_waitcnt vmcnt(9) lgkmcnt(2)
    v_mfma_f32_32x32x16_bf16 v[128:143], v[192:195], v[16:19], v[128:143]
    ds_read_b64_tr_b16 v[204:205], v212 offset:9216
    ds_read_b64_tr_b16 v[206:207], v212 offset:13312
    s_add_u32 s92, s50, 11
    v_mov_b32 v165, s92
    v_mfma_f32_32x32x16_bf16 v[144:159], v[196:199], v[16:19], v[144:159]
    ds_read_b64_tr_b16 v[192:193], v211 offset:10240
    ds_read_b64_tr_b16 v[194:195], v211 offset:14336
    buffer_load_dwordx4 v[56:59], v213, s[28:31], s69 offen offset:2048 sc1
    v_add_f32 v160, v160, v161
    v_add_f32 v162, v162, v163
    s_waitcnt vmcnt(9) lgkmcnt(2)
    v_mfma_f32_32x32x16_bf16 v[128:143], v[200:203], v[20:23], v[128:143]
    ds_read_b64_tr_b16 v[196:197], v212 offset:10240
    ds_read_b64_tr_b16 v[198:199], v212 offset:14336
    v_add_f32 v160, v160, v162
    v_mfma_f32_32x32x16_bf16 v[144:159], v[204:207], v[20:23], v[144:159]
    ds_read_b64_tr_b16 v[200:201], v211 offset:11264
    ds_read_b64_tr_b16 v[202:203], v211 offset:15360
    buffer_load_dwordx4 v[60:63], v213, s[28:31], s69 offen offset:3072 sc1
    s_cmp_eq_u32 s52, 1
    s_cbranch_scc0 L_safe_76
    buffer_store_dword v160, v164, s[28:31], s94 offen
L_back_77:
    s_waitcnt vmcnt(10) lgkmcnt(2)
    v_mfma_f32_32x32x16_bf16 v[128:143], v[192:195], v[24:27], v[128:143]
    ds_read_b64_tr_b16 v[204:205], v212 offset:11264
    ds_read_b64_tr_b16 v[206:207], v212 offset:15360
    v_mfma_f32_32x32x16_bf16 v[144:159], v[196:199], v[24:27], v[144:159]
    v_add_u32 v211, 16384, v211
    ds_read_b64_tr_b16 v[192:193], v211 offset:0
    ds_read_b64_tr_b16 v[194:195], v211 offset:4096
    buffer_load_dwordx4 v[64:67], v213, s[28:31], s70 offen offset:0 sc1
    s_waitcnt vmcnt(10) lgkmcnt(2)
    v_mfma_f32_32x32x16_bf16 v[128:143], v[200:203], v[28:31], v[128:143]
    v_add_u32 v212, 16384, v212
    ds_read_b64_tr_b16 v[196:197], v212 offset:0
    ds_read_b64_tr_b16 v[198:199], v212 offset:4096
    v_mfma_f32_32x32x16_bf16 v[144:159], v[204:207], v[28:31], v[144:159]
    ds_read_b64_tr_b16 v[200:201], v211 offset:1024
    ds_read_b64_tr_b16 v[202:203], v211 offset:5120
    buffer_load_dwordx4 v[68:71], v213, s[28:31], s70 offen offset:1024 sc1
    s_waitcnt vmcnt(10) lgkmcnt(2)
    v_mfma_f32_32x32x16_bf16 v[128:143], v[192:195], v[32:35], v[128:143]
    ds_read_b64_tr_b16 v[204:205], v212 offset:1024
    ds_read_b64_tr_b16 v[206:207], v212 offset:5120
    v_mfma_f32_32x32x16_bf16 v[144:159], v[196:199], v[32:35], v[144:159]
    s_barrier
    ds_read_b64_tr_b16 v[192:193], v211 offset:2048
    ds_read_b64_tr_b16 v[194:195], v211 offset:6144
    buffer_load_dwordx4 v[72:75], v213, s[28:31], s70 offen offset:2048 sc1
    s_waitcnt vmcnt(10) lgkmcnt(2)
    v_mfma_f32_32x32x16_bf16 v[128:143], v[200:203], v[36:39], v[128:143]
    ds_read_b64_tr_b16 v[196:197], v212 offset:2048
    ds_read_b64_tr_b16 v[198:199], v212 offset:6144
    s_add_u32 m0, s77, 98304
    s_add_u32 s95, s76, 128
    buffer_load_dwordx4 v210, s[16:19], s95 offen lds
    v_mfma_f32_32x32x16_bf16 v[144:159], v[204:207], v[36:39], v[144:159]
    ds_read_b64_tr_b16 v[200:201], v211 offset:3072
    ds_read_b64_tr_b16 v[202:203], v211 offset:7168
    buffer_load_dwordx4 v[76:79], v213, s[28:31], s70 offen offset:3072 sc1
    s_waitcnt vmcnt(11) lgkmcnt(2)
    v_mfma_f32_32x32x16_bf16 v[128:143], v[192:195], v[40:43], v[128:143]
    ds_read_b64_tr_b16 v[204:205], v212 offset:3072
    ds_read_b64_tr_b16 v[206:207], v212 offset:7168
    v_mfma_f32_32x32x16_bf16 v[144:159], v[196:199], v[40:43], v[144:159]
    ds_read_b64_tr_b16 v[192:193], v211 offset:8192
    ds_read_b64_tr_b16 v[194:195], v211 offset:12288
    buffer_load_dwordx4 v[80:83], v213, s[28:31], s71 offen offset:0 sc1
    s_add_u32 m0, s77, 102400
    s_add_u32 s95, s76, 114816
    buffer_load_dwordx4 v210, s[16:19], s95 offen lds
    s_waitcnt vmcnt(12) lgkmcnt(2)
    v_mfma_f32_32x32x16_bf16 v[128:143], v[200:203], v[44:47], v[128:143]
    ds_read_b64_tr_b16 v[196:197], v212 offset:8192
    ds_read_b64_tr_b16 v[198:199], v212 offset:12288
    v_mfma_f32_32x32x16_bf16 v[144:159], v[204:207], v[44:47], v[144:159]
    ds_read_b64_tr_b16 v[200:201], v211 offset:9216
    ds_read_b64_tr_b16 v[202:203], v211 offset:13312
    buffer_load_dwordx4 v[84:87], v213, s[28:31], s71 offen offset:1024 sc1
    s_waitcnt vmcnt(12) lgkmcnt(2)
    v_mfma_f32_32x32x16_bf16 v[128:143], v[192:195], v[48:51], v[128:143]
    ds_read_b64_tr_b16 v[204:205], v212 offset:9216
    ds_read_b64_tr_b16 v[206:207], v212 offset:13312
    s_waitcnt vmcnt(8)
    s_cmp_eq_u32 s52, 1
    s_cbranch_scc0 L_safe_78
    buffer_store_dword v165, v208, s[28:31], 0 offen
L_back_79:
    v_mfma_f32_32x32x16_bf16 v[144:159], v[196:199], v[48:51], v[144:159]
    ds_read_b64_tr_b16 v[192:193], v211 offset:10240
    ds_read_b64_tr_b16 v[194:195], v211 offset:14336
    buffer_load_dwordx4 v[88:91], v213, s[28:31], s71 offen offset:2048 sc1
    s_add_u32 m0, s77, 106496
    s_add_u32 s95, s76, 229504
    buffer_load_dwordx4 v210, s[16:19], s95 offen lds
    s_waitcnt lgkmcnt(2)
    v_mfma_f32_32x32x16_bf16 v[128:143], v[200:203], v[52:55], v[128:143]
    ds_read_b64_tr_b16 v[196:197], v212 offset:10240
    ds_read_b64_tr_b16 v[198:199], v212 offset:14336
    v_mfma_f32_32x32x16_bf16 v[144:159], v[204:207], v[52:55], v[144:159]
    ds_read_b64_tr_b16 v[200:201], v211 offset:11264
    ds_read_b64_tr_b16 v[202:203], v211 offset:15360
    buffer_load_dwordx4 v[92:95], v213, s[28:31], s71 offen offset:3072 sc1
    s_waitcnt lgkmcnt(2)
    v_mfma_f32_32x32x16_bf16 v[128:143], v[192:195], v[56:59], v[128:143]
    ds_read_b64_tr_b16 v[204:205], v212 offset:11264
    ds_read_b64_tr_b16 v[206:207], v212 offset:15360
    s_add_u32 m0, s77, 110592
    s_add_u32 s95, s76, 344192
    buffer_load_dwordx4 v210, s[16:19], s95 offen lds
    v_mfma_f32_32x32x16_bf16 v[144:159], v[196:199], v[56:59], v[144:159]
    v_subrev_u32 v211, 49152, v211
    ds_read_b64_tr_b16 v[192:193], v211 offset:0
    ds_read_b64_tr_b16 v[194:195], v211 offset:4096
    buffer_load_dwordx4 v[96:99], v213, s[28:31], s72 offen offset:0 sc1
    s_waitcnt lgkmcnt(2)
    v_mfma_f32_32x32x16_bf16 v[128:143], v[200:203], v[60:63], v[128:143]
    v_subrev_u32 v212, 49152, v212
    ds_read_b64_tr_b16 v[196:197], v212 offset:0
    ds_read_b64_tr_b16 v[198:199], v212 offset:4096
    v_mfma_f32_32x32x16_bf16 v[144:159], v[204:207], v[60:63], v[144:159]
    ds_read_b64_tr_b16 v[200:201], v211 offset:1024
    ds_read_b64_tr_b16 v[202:203], v211 offset:5120
    buffer_load_dwordx4 v[100:103], v213, s[28:31], s72 offen offset:1024 sc1
    s_waitcnt vmcnt(14) lgkmcnt(2)
    v_mfma_f32_32x32x16_bf16 v[128:143], v[192:195], v[64:67], v[128:143]
    ds_read_b64_tr_b16 v[204:205], v212 offset:1024
    ds_read_b64_tr_b16 v[206:207], v212 offset:5120
    v_mfma_f32_32x32x16_bf16 v[144:159], v[196:199], v[64:67], v[144:159]
    s_barrier
    ds_read_b64_tr_b16 v[192:193], v211 offset:2048
    ds_read_b64_tr_b16 v[194:195], v211 offset:6144
    buffer_load_dwordx4 v[104:107], v213, s[28:31], s72 offen offset:2048 sc1
    s_waitcnt vmcnt(14) lgkmcnt(2)
    v_mfma_f32_32x32x16_bf16 v[128:143], v[200:203], v[68:71], v[128:143]
    ds_read_b64_tr_b16 v[196:197], v212 offset:2048
    ds_read_b64_tr_b16 v[198:199], v212 offset:6144
    v_mfma_f32_32x32x16_bf16 v[144:159], v[204:207], v[68:71], v[144:159]
    ds_read_b64_tr_b16 v[200:201], v211 offset:3072
    ds_read_b64_tr_b16 v[202:203], v211 offset:7168
    buffer_load_dwordx4 v[108:111], v213, s[28:31], s72 offen offset:3072 sc1
    s_waitcnt vmcnt(14) lgkmcnt(2)
    v_mfma_f32_32x32x16_bf16 v[128:143], v[192:195], v[72:75], v[128:143]
    ds_read_b64_tr_b16 v[204:205], v212 offset:3072
    ds_read_b64_tr_b16 v[206:207], v212 offset:7168
    v_mfma_f32_32x32x16_bf16 v[144:159], v[196:199], v[72:75], v[144:159]
    ds_read_b64_tr_b16 v[192:193], v211 offset:8192
    ds_read_b64_tr_b16 v[194:195], v211 offset:12288
    buffer_load_dwordx4 v[112:115], v213, s[28:31], s73 offen offset:0 sc1
    s_waitcnt vmcnt(13) lgkmcnt(2)
    v_mfma_f32_32x32x16_bf16 v[128:143], v[200:203], v[76:79], v[128:143]
    ds_read_b64_tr_b16 v[196:197], v212 offset:8192
    ds_read_b64_tr_b16 v[198:199], v212 offset:12288
    buffer_load_dword v168, v209, s[28:31], 0 offen sc1
    v_mfma_f32_32x32x16_bf16 v[144:159], v[204:207], v[76:79], v[144:159]
    ds_read_b64_tr_b16 v[200:201], v211 offset:9216
    ds_read_b64_tr_b16 v[202:203], v211 offset:13312
    buffer_load_dwordx4 v[116:119], v213, s[28:31], s73 offen offset:1024 sc1
    s_waitcnt vmcnt(14) lgkmcnt(2)
    v_mfma_f32_32x32x16_bf16 v[128:143], v[192:195], v[80:83], v[128:143]
    ds_read_b64_tr_b16 v[204:205], v212 offset:9216
    ds_read_b64_tr_b16 v[206:207], v212 offset:13312
    v_mfma_f32_32x32x16_bf16 v[144:159], v[196:199], v[80:83], v[144:159]
    ds_read_b64_tr_b16 v[192:193], v211 offset:10240
    ds_read_b64_tr_b16 v[194:195], v211 offset:14336
    buffer_load_dwordx4 v[120:123], v213, s[28:31], s73 offen offset:2048 sc1
    s_waitcnt vmcnt(13) lgkmcnt(2)
    v_mfma_f32_32x32x16_bf16 v[128:143], v[200:203], v[84:87], v[128:143]
    ds_read_b64_tr_b16 v[196:197], v212 offset:10240
    ds_read_b64_tr_b16 v[198:199], v212 offset:14336
    v_mfma_f32_32x32x16_bf16 v[144:159], v[204:207], v[84:87], v[144:159]
    ds_read_b64_tr_b16 v[200:201], v211 offset:11264
    ds_read_b64_tr_b16 v[202:203], v211 offset:15360
    buffer_load_dwordx4 v[124:127], v213, s[28:31], s73 offen offset:3072 sc1
    s_waitcnt vmcnt(12) lgkmcnt(2)
    v_mfma_f32_32x32x16_bf16 v[128:143], v[192:195], v[88:91], v[128:143]
    ds_read_b64_tr_b16 v[204:205], v212 offset:11264
    ds_read_b64_tr_b16 v[206:207], v212 offset:15360
    s_add_u32 m0, s77, 114688
    s_add_u32 s95, s76, 458880
    buffer_load_dwordx4 v210, s[16:19], s95 offen lds
    v_mfma_f32_32x32x16_bf16 v[144:159], v[196:199], v[88:91], v[144:159]
    v_add_u32 v211, 16384, v211
    ds_read_b64_tr_b16 v[192:193], v211 offset:0
    ds_read_b64_tr_b16 v[194:195], v211 offset:4096
    s_waitcnt vmcnt(11) lgkmcnt(2)
    v_mfma_f32_32x32x16_bf16 v[128:143], v[200:203], v[92:95], v[128:143]
    v_add_u32 v212, 16384, v212
    ds_read_b64_tr_b16 v[196:197], v212 offset:0
    ds_read_b64_tr_b16 v[198:199], v212 offset:4096
    s_add_u32 m0, s77, 118784
    s_add_u32 s95, s76, 573568
    buffer_load_dwordx4 v210, s[16:19], s95 offen lds
    v_mfma_f32_32x32x16_bf16 v[144:159], v[204:207], v[92:95], v[144:159]
    ds_read_b64_tr_b16 v[200:201], v211 offset:1024
    ds_read_b64_tr_b16 v[202:203], v211 offset:5120
    s_waitcnt vmcnt(10) lgkmcnt(2)
    v_mfma_f32_32x32x16_bf16 v[128:143], v[192:195], v[96:99], v[128:143]
    ds_read_b64_tr_b16 v[204:205], v212 offset:1024
    ds_read_b64_tr_b16 v[206:207], v212 offset:5120
    s_add_u32 m0, s77, 122880
    s_add_u32 s95, s76, 688256
    buffer_load_dwordx4 v210, s[16:19], s95 offen lds
    v_mfma_f32_32x32x16_bf16 v[144:159], v[196:199], v[96:99], v[144:159]
    s_barrier
    ds_read_b64_tr_b16 v[192:193], v211 offset:2048
    ds_read_b64_tr_b16 v[194:195], v211 offset:6144
    s_waitcnt vmcnt(10) lgkmcnt(2)
    v_mfma_f32_32x32x16_bf16 v[128:143], v[200:203], v[100:103], v[128:143]
    ds_read_b64_tr_b16 v[196:197], v212 offset:2048
    ds_read_b64_tr_b16 v[198:199], v212 offset:6144
    s_add_u32 m0, s77, 126976
    s_add_u32 s95, s76, 802944
    buffer_load_dwordx4 v210, s[16:19], s95 offen lds
    v_mfma_f32_32x32x16_bf16 v[144:159], v[204:207], v[100:103], v[144:159]
    ds_read_b64_tr_b16 v[200:201], v211 offset:3072
    ds_read_b64_tr_b16 v[202:203], v211 offset:7168
    s_waitcnt vmcnt(10) lgkmcnt(2)
    v_mfma_f32_32x32x16_bf16 v[128:143], v[192:195], v[104:107], v[128:143]
    ds_read_b64_tr_b16 v[204:205], v212 offset:3072
    ds_read_b64_tr_b16 v[206:207], v212 offset:7168
    s_add_u32 m0, s77, 65536
    s_add_u32 s95, s76, 917632
    buffer_load_dwordx4 v210, s[16:19], s95 offen lds
    v_mfma_f32_32x32x16_bf16 v[144:159], v[196:199], v[104:107], v[144:159]
    ds_read_b64_tr_b16 v[192:193], v211 offset:8192
    ds_read_b64_tr_b16 v[194:195], v211 offset:12288
    s_waitcnt vmcnt(10) lgkmcnt(2)
    v_mfma_f32_32x32x16_bf16 v[128:143], v[200:203], v[108:111], v[128:143]
    ds_read_b64_tr_b16 v[196:197], v212 offset:8192
    ds_read_b64_tr_b16 v[198:199], v212 offset:12288
    s_add_u32 m0, s77, 69632
    s_add_u32 s95, s76, 1032320
    buffer_load_dwordx4 v210, s[16:19], s95 offen lds
    v_mfma_f32_32x32x16_bf16 v[144:159], v[204:207], v[108:111], v[144:159]
    ds_read_b64_tr_b16 v[200:201], v211 offset:9216
    ds_read_b64_tr_b16 v[202:203], v211 offset:13312
    v_lshrrev_b32 v215, 4, v222
    v_and_b32 v213, 15, v222
    v_lshlrev_b32 v213, 4, v213
    s_waitcnt vmcnt(10) lgkmcnt(2)
    v_mfma_f32_32x32x16_bf16 v[128:143], v[192:195], v[112:115], v[128:143]
    ds_read_b64_tr_b16 v[204:205], v212 offset:9216
    ds_read_b64_tr_b16 v[206:207], v212 offset:13312
    s_add_u32 m0, s77, 73728
    s_add_u32 s95, s76, 1147008
    buffer_load_dwordx4 v210, s[16:19], s95 offen lds
    v_mfma_f32_32x32x16_bf16 v[144:159], v[196:199], v[112:115], v[144:159]
    ds_read_b64_tr_b16 v[192:193], v211 offset:10240
    ds_read_b64_tr_b16 v[194:195], v211 offset:14336
    v_lshl_add_u32 v213, v215, 10, v213
    s_lshl_b32 s92, s44, 8
    s_add_u32 s92, s92, 1572864
    s_waitcnt vmcnt(9) lgkmcnt(2)
    v_mfma_f32_32x32x16_bf16 v[128:143], v[200:203], v[116:119], v[128:143]
    ds_read_b64_tr_b16 v[196:197], v212 offset:10240
    ds_read_b64_tr_b16 v[198:199], v212 offset:14336
    s_add_u32 m0, s77, 77824
    s_add_u32 s95, s76, 1261696
    buffer_load_dwordx4 v210, s[16:19], s95 offen lds
    v_mfma_f32_32x32x16_bf16 v[144:159], v[204:207], v[116:119], v[144:159]
    ds_read_b64_tr_b16 v[200:201], v211 offset:11264
    ds_read_b64_tr_b16 v[202:203], v211 offset:15360
    v_add_u32 v213, s92, v213
    s_waitcnt vmcnt(9) lgkmcnt(2)
    v_mfma_f32_32x32x16_bf16 v[128:143], v[192:195], v[120:123], v[128:143]
    ds_read_b64_tr_b16 v[204:205], v212 offset:11264
    ds_read_b64_tr_b16 v[206:207], v212 offset:15360
    s_add_u32 s91, s50, 11
    v_subrev_u32 v168, s91, v168
    v_cmp_gt_u32 vcc, 32, v168
    s_nop 0
    s_andn2_b64 s[96:97], s[54:55], vcc
    s_cbranch_scc1 L_slow_80
L_pback_81:
    v_mfma_f32_32x32x16_bf16 v[144:159], v[196:199], v[120:123], v[144:159]
    s_barrier
    v_add_u32 v211, 16384, v211
    ds_read_b64_tr_b16 v[192:193], v211 offset:0
    ds_read_b64_tr_b16 v[194:195], v211 offset:4096
    s_waitcnt vmcnt(8) lgkmcnt(2)
    v_mfma_f32_32x32x16_bf16 v[128:143], v[200:203], v[124:127], v[128:143]
    v_add_u32 v212, 16384, v212
    ds_read_b64_tr_b16 v[196:197], v212 offset:0
    ds_read_b64_tr_b16 v[198:199], v212 offset:4096
    v_mfma_f32_32x32x16_bf16 v[144:159], v[204:207], v[124:127], v[144:159]
    ds_read_b64_tr_b16 v[200:201], v211 offset:1024
    ds_read_b64_tr_b16 v[202:203], v211 offset:5120
    s_waitcnt lgkmcnt(2)
    v_mfma_f32_32x32x16_bf16 v[160:175], v[192:195], v[0:3], 0
    ds_read_b64_tr_b16 v[204:205], v212 offset:1024
    ds_read_b64_tr_b16 v[206:207], v212 offset:5120
    v_mfma_f32_32x32x16_bf16 v[176:191], v[196:199], v[0:3], 0
    s_barrier
    ds_read_b64_tr_b16 v[192:193], v211 offset:2048
    ds_read_b64_tr_b16 v[194:195], v211 offset:6144
    s_waitcnt lgkmcnt(2)
    v_mfma_f32_32x32x16_bf16 v[160:175], v[200:203], v[4:7], v[160:175]
    ds_read_b64_tr_b16 v[196:197], v212 offset:2048
    ds_read_b64_tr_b16 v[198:199], v212 offset:6144
    s_add_u32 m0, s77, 81920
    s_add_u32 s95, s76, 1376384
    buffer_load_dwordx4 v210, s[16:19], s95 offen lds
    v_mfma_f32_32x32x16_bf16 v[176:191], v[204:207], v[4:7], v[176:191]
    ds_read_b64_tr_b16 v[200:201], v211 offset:3072
    ds_read_b64_tr_b16 v[202:203], v211 offset:7168
    s_waitcnt lgkmcnt(2)
    v_mfma_f32_32x32x16_bf16 v[160:175], v[192:195], v[8:11], v[160:175]
    ds_read_b64_tr_b16 v[204:205], v212 offset:3072
    ds_read_b64_tr_b16 v[206:207], v212 offset:7168
    buffer_load_dwordx4 v[0:3], v213, s[28:31], s66 offen sc1
    buffer_load_dwordx4 v[4:7], v213, s[28:31], s67 offen sc1
    v_mfma_f32_32x32x16_bf16 v[176:191], v[196:199], v[8:11], v[176:191]
    ds_read_b64_tr_b16 v[192:193], v211 offset:8192
    ds_read_b64_tr_b16 v[194:195], v211 offset:12288
    s_add_u32 m0, s77, 86016
    s_add_u32 s95, s76, 1491072
    buffer_load_dwordx4 v210, s[16:19], s95 offen lds
    s_waitcnt lgkmcnt(2)
    v_mfma_f32_32x32x16_bf16 v[160:175], v[200:203], v[12:15], v[160:175]
    ds_read_b64_tr_b16 v[196:197], v212 offset:8192
    ds_read_b64_tr_b16 v[198:199], v212 offset:12288
    v_mfma_f32_32x32x16_bf16 v[176:191], v[204:207], v[12:15], v[176:191]
    ds_read_b64_tr_b16 v[200:201], v211 offset:9216
    ds_read_b64_tr_b16 v[202:203], v211 offset:13312
    s_waitcnt lgkmcnt(2)
    v_mfma_f32_32x32x16_bf16 v[160:175], v[192:195], v[16:19], v[160:175]
    ds_read_b64_tr_b16 v[204:205], v212 offset:9216
    ds_read_b64_tr_b16 v[206:207], v212 offset:13312
    v_mfma_f32_32x32x16_bf16 v[176:191], v[196:199], v[16:19], v[176:191]
    ds_read_b64_tr_b16 v[192:193], v211 offset:10240
    ds_read_b64_tr_b16 v[194:195], v211 offset:14336
    s_add_u32 m0, s77, 90112
    s_add_u32 s95, s76, 1605760
    buffer_load_dwordx4 v210, s[16:19], s95 offen lds
    s_waitcnt lgkmcnt(2)
    v_mfma_f32_32x32x16_bf16 v[160:175], v[200:203], v[20:23], v[160:175]
    ds_read_b64_tr_b16 v[196:197], v212 offset:10240
    ds_read_b64_tr_b16 v[198:199], v212 offset:14336
    v_mfma_f32_32x32x16_bf16 v[176:191], v[204:207], v[20:23], v[176:191]
    ds_read_b64_tr_b16 v[200:201], v211 offset:11264
    ds_read_b64_tr_b16 v[202:203], v211 offset:15360
    s_waitcnt lgkmcnt(2)
    v_mfma_f32_32x32x16_bf16 v[160:175], v[192:195], v[24:27], v[160:175]
    ds_read_b64_tr_b16 v[204:205], v212 offset:11264
    ds_read_b64_tr_b16 v[206:207], v212 offset:15360
    s_add_u32 m0, s77, 94208
    s_add_u32 s95, s76, 1720448
    buffer_load_dwordx4 v210, s[16:19], s95 offen lds
    v_mfma_f32_32x32x16_bf16 v[176:191], v[196:199], v[24:27], v[176:191]
    s_waitcnt vmcnt(10)
    s_barrier
    v_add_u32 v211, 16384, v211
    ds_read_b64_tr_b16 v[192:193], v211 offset:0
    ds_read_b64_tr_b16 v[194:195], v211 offset:4096
    s_waitcnt lgkmcnt(2)
    v_mfma_f32_32x32x16_bf16 v[160:175], v[200:203], v[28:31], v[160:175]
    v_add_u32 v212, 16384, v212
    ds_read_b64_tr_b16 v[196:197], v212 offset:0
    ds_read_b64_tr_b16 v[198:199], v212 offset:4096
    v_mfma_f32_32x32x16_bf16 v[176:191], v[204:207], v[28:31], v[176:191]
    ds_read_b64_tr_b16 v[200:201], v211 offset:1024
    ds_read_b64_tr_b16 v[202:203], v211 offset:5120
    s_waitcnt lgkmcnt(2)
    v_mfma_f32_32x32x16_bf16 v[160:175], v[192:195], v[32:35], v[160:175]
    ds_read_b64_tr_b16 v[204:205], v212 offset:1024
    ds_read_b64_tr_b16 v[206:207], v212 offset:5120
    v_mfma_f32_32x32x16_bf16 v[176:191], v[196:199], v[32:35], v[176:191]
    ds_read_b64_tr_b16 v[192:193], v211 offset:2048
    ds_read_b64_tr_b16 v[194:195], v211 offset:6144
    s_waitcnt lgkmcnt(2)
    v_mfma_f32_32x32x16_bf16 v[160:175], v[200:203], v[36:39], v[160:175]
    ds_read_b64_tr_b16 v[196:197], v212 offset:2048
    ds_read_b64_tr_b16 v[198:199], v212 offset:6144
    v_mfma_f32_32x32x16_bf16 v[176:191], v[204:207], v[36:39], v[176:191]
    ds_read_b64_tr_b16 v[200:201], v211 offset:3072
    ds_read_b64_tr_b16 v[202:203], v211 offset:7168
    s_waitcnt lgkmcnt(2)
    v_mfma_f32_32x32x16_bf16 v[160:175], v[192:195], v[40:43], v[160:175]
    ds_read_b64_tr_b16 v[204:205], v212 offset:3072
    ds_read_b64_tr_b16 v[206:207], v212 offset:7168
    v_mfma_f32_32x32x16_bf16 v[176:191], v[196:199], v[40:43], v[176:191]
    ds_read_b64_tr_b16 v[192:193], v211 offset:8192
    ds_read_b64_tr_b16 v[194:195], v211 offset:12288
    s_waitcnt lgkmcnt(2)
    v_mfma_f32_32x32x16_bf16 v[160:175], v[200:203], v[44:47], v[160:175]
    ds_read_b64_tr_b16 v[196:197], v212 offset:8192
    ds_read_b64_tr_b16 v[198:199], v212 offset:12288
    s_waitcnt vmcnt(3)
    v_add_f32 v0, v0, v4
    v_mfma_f32_32x32x16_bf16 v[176:191], v[204:207], v[44:47], v[176:191]
    ds_read_b64_tr_b16 v[200:201], v211 offset:9216
    ds_read_b64_tr_b16 v[202:203], v211 offset:13312
    v_add_f32 v1, v1, v5
    v_add_f32 v2, v2, v6
    v_add_f32 v3, v3, v7
    s_waitcnt lgkmcnt(2)
    v_mfma_f32_32x32x16_bf16 v[160:175], v[192:195], v[48:51], v[160:175]
    ds_read_b64_tr_b16 v[204:205], v212 offset:9216
    ds_read_b64_tr_b16 v[206:207], v212 offset:13312
    v_lshrrev_b32 v215, 4, v222
    v_and_b32 v213, 1, v215
    v_mfma_f32_32x32x16_bf16 v[176:191], v[196:199], v[48:51], v[176:191]
    ds_read_b64_tr_b16 v[192:193], v211 offset:10240
    ds_read_b64_tr_b16 v[194:195], v211 offset:14336
    v_permlane32_swap_b32 v0, v2
    v_permlane32_swap_b32 v1, v3
    v_lshlrev_b32 v213, 7, v213
    s_waitcnt lgkmcnt(2)
    v_mfma_f32_32x32x16_bf16 v[160:175], v[200:203], v[52:55], v[160:175]
    ds_read_b64_tr_b16 v[196:197], v212 offset:10240
    ds_read_b64_tr_b16 v[198:199], v212 offset:14336
    v_lshrrev_b32 v215, 1, v215
    v_add_f32 v0, v0, v2
    v_mfma_f32_32x32x16_bf16 v[176:191], v[204:207], v[52:55], v[176:191]
    ds_read_b64_tr_b16 v[200:201], v211 offset:11264
    ds_read_b64_tr_b16 v[202:203], v211 offset:15360
    v_add_f32 v1, v1, v3
    v_lshl_add_u32 v213, v215, 2, v213
    v_and_b32 v215, 15, v222
    s_waitcnt lgkmcnt(2)
    v_mfma_f32_32x32x16_bf16 v[160:175], v[192:195], v[56:59], v[160:175]
    ds_read_b64_tr_b16 v[204:205], v212 offset:11264
    ds_read_b64_tr_b16 v[206:207], v212 offset:15360
    v_permlane16_swap_b32 v0, v1
    v_lshl_add_u32 v213, v215, 3, v213
    v_mfma_f32_32x32x16_bf16 v[176:191], v[196:199], v[56:59], v[176:191]
    s_barrier
    v_subrev_u32 v211, 49152, v211
    ds_read_b64_tr_b16 v[192:193], v211 offset:0
    ds_read_b64_tr_b16 v[194:195], v211 offset:4096
    s_waitcnt lgkmcnt(2)
    v_mfma_f32_32x32x16_bf16 v[160:175], v[200:203], v[60:63], v[160:175]
    v_subrev_u32 v212, 49152, v212
    ds_read_b64_tr_b16 v[196:197], v212 offset:0
    ds_read_b64_tr_b16 v[198:199], v212 offset:4096
    v_add_f32 v0, v0, v1
    v_mfma_f32_32x32x16_bf16 v[176:191], v[204:207], v[60:63], v[176:191]
    ds_read_b64_tr_b16 v[200:201], v211 offset:1024
    ds_read_b64_tr_b16 v[202:203], v211 offset:5120
    v_add_u32 v213, s90, v213
    ds_write_b32 v213, v0
    v_and_b32 v215, 31, v222
    s_waitcnt lgkmcnt(3)
    v_mfma_f32_32x32x16_bf16 v[160:175], v[192:195], v[64:67], v[160:175]
    ds_read_b64_tr_b16 v[204:205], v212 offset:1024
    ds_read_b64_tr_b16 v[206:207], v212 offset:5120
    v_lshlrev_b32 v215, 2, v215
    v_add_u32 v213, s90, v215
    v_mfma_f32_32x32x16_bf16 v[176:191], v[196:199], v[64:67], v[176:191]
    ds_read_b64_tr_b16 v[192:193], v211 offset:2048
    ds_read_b64_tr_b16 v[194:195], v211 offset:6144
    s_waitcnt lgkmcnt(2)
    v_mfma_f32_32x32x16_bf16 v[160:175], v[200:203], v[68:71], v[160:175]
    ds_read_b64_tr_b16 v[196:197], v212 offset:2048
    ds_read_b64_tr_b16 v[198:199], v212 offset:6144
    ds_read2_b32 v[2:3], v213 offset0:0 offset1:32
    v_mfma_f32_32x32x16_bf16 v[176:191], v[204:207], v[68:71], v[176:191]
    ds_read_b64_tr_b16 v[200:201], v211 offset:3072
    ds_read_b64_tr_b16 v[202:203], v211 offset:7168
    v_lshrrev_b32 v213, 5, v222
    v_lshl_add_u32 v215, v213, 9, v215
    v_add_u32 v215, s3, v215
    s_waitcnt lgkmcnt(3)
    v_mfma_f32_32x32x16_bf16 v[160:175], v[192:195], v[72:75], v[160:175]
    ds_read_b64_tr_b16 v[204:205], v212 offset:3072
    ds_read_b64_tr_b16 v[206:207], v212 offset:7168
    s_waitcnt lgkmcnt(4)
    v_mul_f32 v218, 0x3b000000, v2
    v_mfma_f32_32x32x16_bf16 v[176:191], v[196:199], v[72:75], v[176:191]
    ds_read_b64_tr_b16 v[192:193], v211 offset:8192
    ds_read_b64_tr_b16 v[194:195], v211 offset:12288
    v_mul_f32 v3, 0x3b000000, v3
    v_fma_f32 v3, -v218, v218, v3
    v_max_f32 v3, 0, v3
    s_waitcnt lgkmcnt(2)
    v_mfma_f32_32x32x16_bf16 v[160:175], v[200:203], v[76:79], v[160:175]
    ds_read_b64_tr_b16 v[196:197], v212 offset:8192
    ds_read_b64_tr_b16 v[198:199], v212 offset:12288
    v_add_f32 v3, 0x3727c5ac, v3
    v_rsq_f32 v219, v3
    v_mfma_f32_32x32x16_bf16 v[176:191], v[204:207], v[76:79], v[176:191]
    ds_read_b64_tr_b16 v[200:201], v211 offset:9216
    ds_read_b64_tr_b16 v[202:203], v211 offset:13312
    v_cndmask_b32 v2, v218, v219, s[64:65]
    ds_write_b32 v215, v2
    s_add_u32 s92, s50, 12
    s_waitcnt lgkmcnt(3)
    v_mfma_f32_32x32x16_bf16 v[160:175], v[192:195], v[80:83], v[160:175]
    ds_read_b64_tr_b16 v[204:205], v212 offset:9216
    ds_read_b64_tr_b16 v[206:207], v212 offset:13312
    v_mov_b32 v0, s92
    s_add_u32 s92, s50, 13
    v_mfma_f32_32x32x16_bf16 v[176:191], v[196:199], v[80:83], v[176:191]
    ds_read_b64_tr_b16 v[192:193], v211 offset:10240
    ds_read_b64_tr_b16 v[194:195], v211 offset:14336
    v_mov_b32 v1, s92
    ds_read_b128 v[8:11], v217 offset:1408
    ds_read_b128 v[12:15], v217 offset:1440
    s_waitcnt lgkmcnt(4)
    v_mfma_f32_32x32x16_bf16 v[160:175], v[200:203], v[84:87], v[160:175]
    ds_read_b64_tr_b16 v[196:197], v212 offset:10240
    ds_read_b64_tr_b16 v[198:199], v212 offset:14336
    ds_read_b128 v[16:19], v217 offset:1472
    ds_read_b128 v[20:23], v217 offset:1504
    v_mfma_f32_32x32x16_bf16 v[176:191], v[204:207], v[84:87], v[176:191]
    ds_read_b64_tr_b16 v[200:201], v211 offset:11264
    ds_read_b64_tr_b16 v[202:203], v211 offset:15360
    ds_read_b128 v[24:27], v217 offset:1536
    ds_read_b128 v[28:31], v217 offset:1568
    ds_read_b128 v[32:35], v217 offset:1600
    s_waitcnt lgkmcnt(7)
    v_mfma_f32_32x32x16_bf16 v[160:175], v[192:195], v[88:91], v[160:175]
    ds_read_b64_tr_b16 v[204:205], v212 offset:11264
    ds_read_b64_tr_b16 v[206:207], v212 offset:15360
    ds_read_b128 v[36:39], v217 offset:1632
    v_mfma_f32_32x32x16_bf16 v[176:191], v[196:199], v[88:91], v[176:191]
    s_waitcnt vmcnt(0)
    s_barrier
    v_add_u32 v211, 16384, v211
    ds_read_b64_tr_b16 v[192:193], v211 offset:0
    ds_read_b64_tr_b16 v[194:195], v211 offset:4096
    s_waitcnt lgkmcnt(3)
    v_mfma_f32_32x32x16_bf16 v[160:175], v[200:203], v[92:95], v[160:175]
    v_add_u32 v212, 16384, v212
    ds_read_b64_tr_b16 v[196:197], v212 offset:0
    ds_read_b64_tr_b16 v[198:199], v212 offset:4096
    v_mfma_f32_32x32x16_bf16 v[176:191], v[204:207], v[92:95], v[176:191]
    ds_read_b64_tr_b16 v[200:201], v211 offset:1024
    ds_read_b64_tr_b16 v[202:203], v211 offset:5120
    v_fma_f32 v128, -v218, v8, v128
    v_fma_f32 v129, -v218, v9, v129
    s_waitcnt lgkmcnt(2)
    v_mfma_f32_32x32x16_bf16 v[160:175], v[192:195], v[96:99], v[160:175]
    ds_read_b64_tr_b16 v[204:205], v212 offset:1024
    ds_read_b64_tr_b16 v[206:207], v212 offset:5120
    v_fma_f32 v130, -v218, v10, v130
    v_fma_f32 v131, -v218, v11, v131
    v_mfma_f32_32x32x16_bf16 v[176:191], v[196:199], v[96:99], v[176:191]
    ds_read_b64_tr_b16 v[192:193], v211 offset:2048
    ds_read_b64_tr_b16 v[194:195], v211 offset:6144
    v_fma_f32 v132, -v218, v12, v132
    v_fma_f32 v133, -v218, v13, v133
    v_fma_f32 v134, -v218, v14, v134
    s_waitcnt lgkmcnt(2)
    v_mfma_f32_32x32x16_bf16 v[160:175], v[200:203], v[100:103], v[160:175]
    ds_read_b64_tr_b16 v[196:197], v212 offset:2048
    ds_read_b64_tr_b16 v[198:199], v212 offset:6144
    v_fma_f32 v135, -v218, v15, v135
    v_fma_f32 v136, -v218, v16, v136
    v_mfma_f32_32x32x16_bf16 v[176:191], v[204:207], v[100:103], v[176:191]
    ds_read_b64_tr_b16 v[200:201], v211 offset:3072
    ds_read_b64_tr_b16 v[202:203], v211 offset:7168
    v_fma_f32 v137, -v218, v17, v137
    v_fma_f32 v138, -v218, v18, v138
    v_fma_f32 v139, -v218, v19, v139
    s_waitcnt lgkmcnt(2)
    v_mfma_f32_32x32x16_bf16 v[160:175], v[192:195], v[104:107], v[160:175]
    ds_read_b64_tr_b16 v[204:205], v212 offset:3072
    ds_read_b64_tr_b16 v[206:207], v212 offset:7168
    v_fma_f32 v140, -v218, v20, v140
    v_fma_f32 v141, -v218, v21, v141
    v_mfma_f32_32x32x16_bf16 v[176:191], v[196:199], v[104:107], v[176:191]
    ds_read_b64_tr_b16 v[192:193], v211 offset:8192
    ds_read_b64_tr_b16 v[194:195], v211 offset:12288
    v_fma_f32 v142, -v218, v22, v142
    v_fma_f32 v143, -v218, v23, v143
    v_cvt_pk_bf16_f32 v8, v128, v129
    s_waitcnt lgkmcnt(2)
    v_mfma_f32_32x32x16_bf16 v[160:175], v[200:203], v[108:111], v[160:175]
    ds_read_b64_tr_b16 v[196:197], v212 offset:8192
    ds_read_b64_tr_b16 v[198:199], v212 offset:12288
    v_cvt_pk_bf16_f32 v9, v130, v131
    v_cvt_pk_bf16_f32 v10, v132, v133
    v_mfma_f32_32x32x16_bf16 v[176:191], v[204:207], v[108:111], v[176:191]
    ds_read_b64_tr_b16 v[200:201], v211 offset:9216
    ds_read_b64_tr_b16 v[202:203], v211 offset:13312
    v_cvt_pk_bf16_f32 v11, v134, v135
    v_pk_max_i16 v8, v8, 0
    v_pk_max_i16 v9, v9, 0
    s_waitcnt lgkmcnt(2)
    v_mfma_f32_32x32x16_bf16 v[160:175], v[192:195], v[112:115], v[160:175]
    ds_read_b64_tr_b16 v[204:205], v212 offset:9216
    ds_read_b64_tr_b16 v[206:207], v212 offset:13312
    v_pk_max_i16 v10, v10, 0
    v_pk_max_i16 v11, v11, 0
    v_mfma_f32_32x32x16_bf16 v[176:191], v[196:199], v[112:115], v[176:191]
    ds_read_b64_tr_b16 v[192:193], v211 offset:10240
    ds_read_b64_tr_b16 v[194:195], v211 offset:14336
    v_cvt_pk_bf16_f32 v12, v136, v137
    v_cvt_pk_bf16_f32 v13, v138, v139
    v_cvt_pk_bf16_f32 v14, v140, v141
    s_waitcnt lgkmcnt(2)
    v_mfma_f32_32x32x16_bf16 v[160:175], v[200:203], v[116:119], v[160:175]
    ds_read_b64_tr_b16 v[196:197], v212 offset:10240
    ds_read_b64_tr_b16 v[198:199], v212 offset:14336
    v_cvt_pk_bf16_f32 v15, v142, v143
    v_pk_max_i16 v12, v12, 0
    v_mfma_f32_32x32x16_bf16 v[176:191], v[204:207], v[116:119], v[176:191]
    ds_read_b64_tr_b16 v[200:201], v211 offset:11264
    ds_read_b64_tr_b16 v[202:203], v211 offset:15360
    v_pk_max_i16 v13, v13, 0
    v_pk_max_i16 v14, v14, 0
    v_pk_max_i16 v15, v15, 0
    s_waitcnt lgkmcnt(2)
    v_mfma_f32_32x32x16_bf16 v[160:175], v[192:195], v[120:123], v[160:175]
    ds_read_b64_tr_b16 v[204:205], v212 offset:11264
    ds_read_b64_tr_b16 v[206:207], v212 offset:15360
    s_cmp_eq_u32 s52, 1
    s_cbranch_scc0 L_safe_85
    buffer_store_dwordx4 v[8:11], v223, s[40:43], s84 offen offset:0
    buffer_store_dwordx4 v[12:15], v223, s[40:43], s84 offen offset:1024
L_back_86:
    v_mfma_f32_32x32x16_bf16 v[176:191], v[196:199], v[120:123], v[176:191]
    v_fma_f32 v144, -v218, v24, v144
    v_fma_f32 v145, -v218, v25, v145
    v_fma_f32 v146, -v218, v26, v146
    s_waitcnt lgkmcnt(0)
    v_mfma_f32_32x32x16_bf16 v[160:175], v[200:203], v[124:127], v[160:175]
    v_fma_f32 v147, -v218, v27, v147
    v_fma_f32 v148, -v218, v28, v148
    v_fma_f32 v149, -v218, v29, v149
    v_fma_f32 v150, -v218, v30, v150
    v_mfma_f32_32x32x16_bf16 v[176:191], v[204:207], v[124:127], v[176:191]
    v_fma_f32 v151, -v218, v31, v151
    v_fma_f32 v152, -v218, v32, v152
    v_fma_f32 v153, -v218, v33, v153
    v_fma_f32 v154, -v218, v34, v154
    v_fma_f32 v155, -v218, v35, v155
    v_fma_f32 v156, -v218, v36, v156
    v_fma_f32 v157, -v218, v37, v157
    v_fma_f32 v158, -v218, v38, v158
    v_fma_f32 v159, -v218, v39, v159
    v_cvt_pk_bf16_f32 v24, v144, v145
    v_cvt_pk_bf16_f32 v25, v146, v147
    v_cvt_pk_bf16_f32 v26, v148, v149
    v_cvt_pk_bf16_f32 v27, v150, v151
    v_pk_max_i16 v24, v24, 0
    v_pk_max_i16 v25, v25, 0
    v_pk_max_i16 v26, v26, 0
    v_pk_max_i16 v27, v27, 0
    v_cvt_pk_bf16_f32 v28, v152, v153
    v_cvt_pk_bf16_f32 v29, v154, v155
    v_cvt_pk_bf16_f32 v30, v156, v157
    v_cvt_pk_bf16_f32 v31, v158, v159
    v_pk_max_i16 v28, v28, 0
    v_pk_max_i16 v29, v29, 0
    v_pk_max_i16 v30, v30, 0
    v_pk_max_i16 v31, v31, 0
    s_cmp_eq_u32 s52, 1
    s_cbranch_scc0 L_safe_87
    buffer_store_dwordx4 v[24:27], v223, s[40:43], s84 offen offset:2048
    buffer_store_dwordx4 v[28:31], v223, s[40:43], s84 offen offset:3072
L_back_88:
    ds_read_b128 v[64:67], v217 offset:1664
    ds_read_b128 v[68:71], v217 offset:1696
    ds_read_b128 v[72:75], v217 offset:1728
    ds_read_b128 v[76:79], v217 offset:1760
    ds_read_b128 v[80:83], v217 offset:1792
    ds_read_b128 v[84:87], v217 offset:1824
    ds_read_b128 v[88:91], v217 offset:1856
    ds_read_b128 v[92:95], v217 offset:1888
    s_waitcnt vmcnt(0)
    s_cmp_eq_u32 s52, 1
    s_cbranch_scc0 L_safe_89
    buffer_store_dword v0, v208, s[28:31], 0 offen
L_back_90:
    s_waitcnt lgkmcnt(4)
    v_pk_fma_f32 v[160:161], v[64:65], v[218:219], v[160:161] op_sel_hi:[1,0,1] neg_lo:[0,1,0] neg_hi:[0,1,0]
    v_pk_fma_f32 v[162:163], v[66:67], v[218:219], v[162:163] op_sel_hi:[1,0,1] neg_lo:[0,1,0] neg_hi:[0,1,0]
    v_pk_fma_f32 v[164:165], v[68:69], v[218:219], v[164:165] op_sel_hi:[1,0,1] neg_lo:[0,1,0] neg_hi:[0,1,0]
    v_pk_fma_f32 v[166:167], v[70:71], v[218:219], v[166:167] op_sel_hi:[1,0,1] neg_lo:[0,1,0] neg_hi:[0,1,0]
    v_pk_fma_f32 v[168:169], v[72:73], v[218:219], v[168:169] op_sel_hi:[1,0,1] neg_lo:[0,1,0] neg_hi:[0,1,0]
    v_pk_fma_f32 v[170:171], v[74:75], v[218:219], v[170:171] op_sel_hi:[1,0,1] neg_lo:[0,1,0] neg_hi:[0,1,0]
    v_pk_fma_f32 v[172:173], v[76:77], v[218:219], v[172:173] op_sel_hi:[1,0,1] neg_lo:[0,1,0] neg_hi:[0,1,0]
    v_pk_fma_f32 v[174:175], v[78:79], v[218:219], v[174:175] op_sel_hi:[1,0,1] neg_lo:[0,1,0] neg_hi:[0,1,0]
    v_cvt_pk_bf16_f32 v64, v160, v161
    v_cvt_pk_bf16_f32 v65, v162, v163
    v_cvt_pk_bf16_f32 v66, v164, v165
    v_cvt_pk_bf16_f32 v67, v166, v167
    v_pk_max_i16 v64, v64, 0
    v_pk_max_i16 v65, v65, 0
    v_pk_max_i16 v66, v66, 0
    v_pk_max_i16 v67, v67, 0
    v_cvt_pk_bf16_f32 v68, v168, v169
    v_cvt_pk_bf16_f32 v69, v170, v171
    v_cvt_pk_bf16_f32 v70, v172, v173
    v_cvt_pk_bf16_f32 v71, v174, v175
    v_pk_max_i16 v68, v68, 0
    v_pk_max_i16 v69, v69, 0
    v_pk_max_i16 v70, v70, 0
    v_pk_max_i16 v71, v71, 0
    s_cmp_eq_u32 s52, 1
    s_cbranch_scc0 L_safe_91
    buffer_store_dwordx4 v[64:67], v223, s[40:43], s85 offen offset:0
    buffer_store_dwordx4 v[68:71], v223, s[40:43], s85 offen offset:1024
L_back_92:
    s_waitcnt lgkmcnt(0)
    v_pk_fma_f32 v[176:177], v[80:81], v[218:219], v[176:177] op_sel_hi:[1,0,1] neg_lo:[0,1,0] neg_hi:[0,1,0]
    v_pk_fma_f32 v[178:179], v[82:83], v[218:219], v[178:179] op_sel_hi:[1,0,1] neg_lo:[0,1,0] neg_hi:[0,1,0]
    v_pk_fma_f32 v[180:181], v[84:85], v[218:219], v[180:181] op_sel_hi:[1,0,1] neg_lo:[0,1,0] neg_hi:[0,1,0]
    v_pk_fma_f32 v[182:183], v[86:87], v[218:219], v[182:183] op_sel_hi:[1,0,1] neg_lo:[0,1,0] neg_hi:[0,1,0]
    v_pk_fma_f32 v[184:185], v[88:89], v[218:219], v[184:185] op_sel_hi:[1,0,1] neg_lo:[0,1,0] neg_hi:[0,1,0]
    v_pk_fma_f32 v[186:187], v[90:91], v[218:219], v[186:187] op_sel_hi:[1,0,1] neg_lo:[0,1,0] neg_hi:[0,1,0]
    v_pk_fma_f32 v[188:189], v[92:93], v[218:219], v[188:189] op_sel_hi:[1,0,1] neg_lo:[0,1,0] neg_hi:[0,1,0]
    v_pk_fma_f32 v[190:191], v[94:95], v[218:219], v[190:191] op_sel_hi:[1,0,1] neg_lo:[0,1,0] neg_hi:[0,1,0]
    v_cvt_pk_bf16_f32 v80, v176, v177
    v_cvt_pk_bf16_f32 v81, v178, v179
    v_cvt_pk_bf16_f32 v82, v180, v181
    v_cvt_pk_bf16_f32 v83, v182, v183
    v_pk_max_i16 v80, v80, 0
    v_pk_max_i16 v81, v81, 0
    v_pk_max_i16 v82, v82, 0
    v_pk_max_i16 v83, v83, 0
    v_cvt_pk_bf16_f32 v84, v184, v185
    v_cvt_pk_bf16_f32 v85, v186, v187
    v_cvt_pk_bf16_f32 v86, v188, v189
    v_cvt_pk_bf16_f32 v87, v190, v191
    v_pk_max_i16 v84, v84, 0
    v_pk_max_i16 v85, v85, 0
    v_pk_max_i16 v86, v86, 0
    v_pk_max_i16 v87, v87, 0
    s_cmp_eq_u32 s52, 1
    s_cbranch_scc0 L_safe_93
    buffer_store_dwordx4 v[80:83], v223, s[40:43], s85 offen offset:2048
    buffer_store_dwordx4 v[84:87], v223, s[40:43], s85 offen offset:3072
L_back_94:
    s_lshl_b32 s92, s46, 2
    s_add_u32 s92, s92, s44
    s_lshl_b32 s93, s47, 6
    s_add_u32 s93, s93, s92
    s_lshl_b32 s84, s93, 10
    s_lshl_b32 s93, s92, 10
    s_lshl_b32 s94, s47, 9
    s_add_u32 s85, s93, s94
    s_lshl_b32 s86, s92, 6
    s_mov_b32 s87, s93
    s_add_u32 s92, s84, 0
    s_add_u32 s93, s92, 32768
    buffer_load_dwordx4 v[176:179], v223, s[28:31], s92 offen sc1
    buffer_load_dwordx4 v[180:183], v223, s[28:31], s93 offen sc1
    v_and_b32 v184, 31, v222
    v_lshrrev_b32 v185, 5, v222
    v_lshlrev_b32 v215, 11, v184
    v_lshl_add_u32 v215, v185, 6, v215
    s_lshl_b32 s92, s44, 4
    s_lshl_b32 s93, s46, 7
    s_add_u32 s92, s92, s93
    v_add_u32 v215, s92, v215
    s_lshl_b32 s92, s48, 8
    s_add_u32 s92, s92, s49
    s_lshl_b32 s93, s47, 7
    s_add_u32 s92, s92, s93
    s_lshl_b32 s85, s92, 10
    s_lshl_b32 s92, s47, 8
    s_add_u32 s92, s92, 163200
    v_lshlrev_b32 v188, 2, v184
    v_add_u32 v188, s92, v188
    s_mul_i32 s92, s44, 28
    s_and_b32 s93, s44, 1
    s_lshl_b32 s94, s93, 2
    s_add_u32 s94, s94, s92
    s_xor_b32 s93, s93, 1
    s_mul_i32 s93, s93, 24
    s_add_u32 s93, s93, s92
    s_mul_i32 s92, s47, 224
    s_add_u32 s94, s94, s92
    s_add_u32 s93, s93, s92
    s_lshl_b32 s94, s94, 10
    s_lshl_b32 s93, s93, 10
    s_add_u32 s94, s94, 262144
    s_add_u32 s93, s93, 262144
    v_add_u32 v217, s94, v223
    v_add_u32 v220, 114688, v217
    v_add_u32 v140, s93, v223
    v_add_u32 v141, 114688, v140
    s_waitcnt vmcnt(2)
    s_cmp_eq_u32 s52, 1
    s_cbranch_scc0 L_safe_95
    buffer_store_dword v1, v208, s[28:31], 0 offen
L_back_96:
    s_barrier
    ds_read2_b32 v[218:219], v188 offset0:0 offset1:32
    s_lshl_b32 s92, s44, 8
    s_add_u32 s92, s92, 157696
    v_lshlrev_b32 v156, 2, v222
    v_add_u32 v156, s92, v156
    s_add_u32 s92, s44, 0
    s_and_b32 s92, s92, 3
    s_mul_i32 s93, s92, 6144
    s_add_u32 s93, s93, 131072
    v_add_u32 v214, s93, v223
    s_lshr_b32 s93, s92, 1
    s_mul_i32 s93, s93, 0
    s_add_u32 s93, s93, 4294934528
    v_add_u32 v155, s93, v214
    s_add_u32 s92, s44, 1
    s_and_b32 s92, s92, 3
    s_mul_i32 s93, s92, 6144
    s_add_u32 s93, s93, 131072
    v_add_u32 v211, s93, v223
    s_lshr_b32 s93, s92, 1
    s_mul_i32 s93, s93, 0
    s_add_u32 s93, s93, 4294934528
    v_add_u32 v152, s93, v211
    s_add_u32 s92, s44, 2
    s_and_b32 s92, s92, 3
    s_mul_i32 s93, s92, 6144
    s_add_u32 s93, s93, 133120
    v_add_u32 v212, s93, v223
    s_lshr_b32 s93, s92, 1
    s_mul_i32 s93, s93, 0
    s_add_u32 s93, s93, 4294934528
    v_add_u32 v153, s93, v212
    s_add_u32 s92, s44, 3
    s_and_b32 s92, s92, 3
    s_mul_i32 s93, s92, 6144
    s_add_u32 s93, s93, 135168
    v_add_u32 v213, s93, v223
    s_lshr_b32 s93, s92, 1
    s_mul_i32 s93, s93, 0
    s_add_u32 s93, s93, 4294934528
    v_add_u32 v154, s93, v213
    s_add_u32 s91, s50, 12
L_poll_97:
    buffer_load_dword v184, v209, s[28:31], 0 offen sc1
    s_waitcnt vmcnt(0)
    v_subrev_u32 v184, s91, v184
    v_cmp_gt_u32 vcc, 32, v184
    s_nop 0
    s_andn2_b64 s[96:97], s[58:59], vcc
    s_cbranch_scc1 L_chk_98
L_done_99:
    buffer_load_dwordx4 v[64:67], v217, s[28:31], s66 offen offset:0 sc1
    buffer_load_dwordx4 v[68:71], v217, s[28:31], s66 offen offset:1024 sc1
    buffer_load_dwordx4 v[72:75], v217, s[28:31], s66 offen offset:2048 sc1
    buffer_load_dwordx4 v[76:79], v217, s[28:31], s66 offen offset:3072 sc1
    buffer_load_dwordx4 v[80:83], v217, s[28:31], s68 offen offset:0 sc1
    buffer_load_dwordx4 v[84:87], v217, s[28:31], s68 offen offset:1024 sc1
    buffer_load_dwordx4 v[88:91], v217, s[28:31], s68 offen offset:2048 sc1
    buffer_load_dwordx4 v[92:95], v217, s[28:31], s68 offen offset:3072 sc1
    buffer_load_dwordx4 v[96:99], v217, s[28:31], s70 offen offset:0 sc1
    buffer_load_dwordx4 v[100:103], v217, s[28:31], s70 offen offset:1024 sc1
    buffer_load_dwordx4 v[104:107], v217, s[28:31], s70 offen offset:2048 sc1
    buffer_load_dwordx4 v[108:111], v217, s[28:31], s70 offen offset:3072 sc1
    buffer_load_dword v184, v209, s[28:31], 0 offen sc1
    v_lshlrev_b32 v160, 16, v176
    v_and_b32 v161, 0xffff0000, v176
    v_lshlrev_b32 v162, 16, v177
    v_and_b32 v163, 0xffff0000, v177
    v_lshlrev_b32 v164, 16, v178
    v_and_b32 v165, 0xffff0000, v178
    v_lshlrev_b32 v166, 16, v179
    v_and_b32 v167, 0xffff0000, v179
    v_lshlrev_b32 v168, 16, v180
    v_and_b32 v169, 0xffff0000, v180
    v_lshlrev_b32 v170, 16, v181
    v_and_b32 v171, 0xffff0000, v181
    v_lshlrev_b32 v172, 16, v182
    v_and_b32 v173, 0xffff0000, v182
    v_lshlrev_b32 v174, 16, v183
    v_and_b32 v175, 0xffff0000, v183
    s_waitcnt vmcnt(12) lgkmcnt(0)
    v_mfma_f32_32x32x16_bf16 v[0:15], a[0:3], v[64:67], 0
    v_mfma_f32_32x32x16_bf16 v[16:31], a[4:7], v[64:67], 0
    buffer_load_dwordx4 v[112:115], v220, s[28:31], s66 offen offset:0 sc1
    s_waitcnt vmcnt(12)
    v_mfma_f32_32x32x16_bf16 v[0:15], a[8:11], v[68:71], v[0:15]
    v_mfma_f32_32x32x16_bf16 v[16:31], a[12:15], v[68:71], v[16:31]
    buffer_load_dwordx4 v[116:119], v220, s[28:31], s66 offen offset:1024 sc1
    s_waitcnt vmcnt(12)
    v_mfma_f32_32x32x16_bf16 v[0:15], a[16:19], v[72:75], v[0:15]
    v_mfma_f32_32x32x16_bf16 v[16:31], a[20:23], v[72:75], v[16:31]
    buffer_load_dwordx4 v[120:123], v220, s[28:31], s66 offen offset:2048 sc1
    s_waitcnt vmcnt(12)
    v_mfma_f32_32x32x16_bf16 v[0:15], a[24:27], v[76:79], v[0:15]
    v_mfma_f32_32x32x16_bf16 v[16:31], a[28:31], v[76:79], v[16:31]
    buffer_load_dwordx4 v[124:127], v220, s[28:31], s66 offen offset:3072 sc1
    s_waitcnt vmcnt(12)
    v_mfma_f32_32x32x16_bf16 v[0:15], a[32:35], v[80:83], v[0:15]
    v_mfma_f32_32x32x16_bf16 v[16:31], a[36:39], v[80:83], v[16:31]
    buffer_load_dwordx4 v[64:67], v220, s[28:31], s68 offen offset:0 sc1
    s_waitcnt vmcnt(12)
    v_mfma_f32_32x32x16_bf16 v[0:15], a[40:43], v[84:87], v[0:15]
    v_mfma_f32_32x32x16_bf16 v[16:31], a[44:47], v[84:87], v[16:31]
    buffer_load_dwordx4 v[68:71], v220, s[28:31], s68 offen offset:1024 sc1
    s_waitcnt vmcnt(12)
    v_mfma_f32_32x32x16_bf16 v[0:15], a[48:51], v[88:91], v[0:15]
    v_mfma_f32_32x32x16_bf16 v[16:31], a[52:55], v[88:91], v[16:31]
    buffer_load_dwordx4 v[72:75], v220, s[28:31], s68 offen offset:2048 sc1
    s_waitcnt vmcnt(12)
    v_mfma_f32_32x32x16_bf16 v[0:15], a[56:59], v[92:95], v[0:15]
    v_mfma_f32_32x32x16_bf16 v[16:31], a[60:63], v[92:95], v[16:31]
    buffer_load_dwordx4 v[76:79], v220, s[28:31], s68 offen offset:3072 sc1
    s_waitcnt vmcnt(12)
    v_mfma_f32_32x32x16_bf16 v[0:15], a[64:67], v[96:99], v[0:15]
    v_mfma_f32_32x32x16_bf16 v[16:31], a[68:71], v[96:99], v[16:31]
    buffer_load_dwordx4 v[80:83], v220, s[28:31], s70 offen offset:0 sc1
    s_waitcnt vmcnt(12)
    v_mfma_f32_32x32x16_bf16 v[0:15], a[72:75], v[100:103], v[0:15]
    v_mfma_f32_32x32x16_bf16 v[16:31], a[76:79], v[100:103], v[16:31]
    buffer_load_dwordx4 v[84:87], v220, s[28:31], s70 offen offset:1024 sc1
    s_waitcnt vmcnt(12)
    v_mfma_f32_32x32x16_bf16 v[0:15], a[80:83], v[104:107], v[0:15]
    v_mfma_f32_32x32x16_bf16 v[16:31], a[84:87], v[104:107], v[16:31]
    buffer_load_dwordx4 v[88:91], v220, s[28:31], s70 offen offset:2048 sc1
    s_waitcnt vmcnt(12)
    v_mfma_f32_32x32x16_bf16 v[0:15], a[88:91], v[108:111], v[0:15]
    v_mfma_f32_32x32x16_bf16 v[16:31], a[92:95], v[108:111], v[16:31]
    buffer_load_dwordx4 v[92:95], v220, s[28:31], s70 offen offset:3072 sc1
    s_waitcnt vmcnt(11)
    v_mfma_f32_32x32x16_bf16 v[32:47], a[0:3], v[112:115], 0
    v_mfma_f32_32x32x16_bf16 v[48:63], a[4:7], v[112:115], 0
    s_add_u32 s91, s50, 13
    v_subrev_u32 v184, s91, v184
    v_cmp_gt_u32 vcc, 32, v184
    s_nop 0
    s_andn2_b64 s[96:97], s[58:59], vcc
    s_cbranch_scc1 L_slow_100
L_pback_101:
    buffer_load_dwordx4 v[96:99], v140, s[28:31], s66 offen offset:0 sc1
    s_waitcnt vmcnt(11)
    v_mfma_f32_32x32x16_bf16 v[32:47], a[8:11], v[116:119], v[32:47]
    v_mfma_f32_32x32x16_bf16 v[48:63], a[12:15], v[116:119], v[48:63]
    buffer_load_dwordx4 v[100:103], v140, s[28:31], s66 offen offset:1024 sc1
    s_waitcnt vmcnt(11)
    v_mfma_f32_32x32x16_bf16 v[32:47], a[16:19], v[120:123], v[32:47]
    v_mfma_f32_32x32x16_bf16 v[48:63], a[20:23], v[120:123], v[48:63]
    buffer_load_dwordx4 v[104:107], v140, s[28:31], s66 offen offset:2048 sc1
    s_waitcnt vmcnt(11)
    v_mfma_f32_32x32x16_bf16 v[32:47], a[24:27], v[124:127], v[32:47]
    v_mfma_f32_32x32x16_bf16 v[48:63], a[28:31], v[124:127], v[48:63]
    buffer_load_dwordx4 v[108:111], v140, s[28:31], s66 offen offset:3072 sc1
    s_waitcnt vmcnt(11)
    v_mfma_f32_32x32x16_bf16 v[32:47], a[32:35], v[64:67], v[32:47]
    v_mfma_f32_32x32x16_bf16 v[48:63], a[36:39], v[64:67], v[48:63]
    buffer_load_dwordx4 v[112:115], v217, s[28:31], s67 offen offset:0 sc1
    s_waitcnt vmcnt(11)
    v_mfma_f32_32x32x16_bf16 v[32:47], a[40:43], v[68:71], v[32:47]
    v_mfma_f32_32x32x16_bf16 v[48:63], a[44:47], v[68:71], v[48:63]
    buffer_load_dwordx4 v[116:119], v217, s[28:31], s67 offen offset:1024 sc1
    s_waitcnt vmcnt(11)
    v_mfma_f32_32x32x16_bf16 v[32:47], a[48:51], v[72:75], v[32:47]
    v_mfma_f32_32x32x16_bf16 v[48:63], a[52:55], v[72:75], v[48:63]
    buffer_load_dwordx4 v[120:123], v217, s[28:31], s67 offen offset:2048 sc1
    s_waitcnt vmcnt(11)
    v_mfma_f32_32x32x16_bf16 v[32:47], a[56:59], v[76:79], v[32:47]
    v_mfma_f32_32x32x16_bf16 v[48:63], a[60:63], v[76:79], v[48:63]
    buffer_load_dwordx4 v[124:127], v217, s[28:31], s67 offen offset:3072 sc1
    s_waitcnt vmcnt(11)
    v_mfma_f32_32x32x16_bf16 v[32:47], a[64:67], v[80:83], v[32:47]
    v_mfma_f32_32x32x16_bf16 v[48:63], a[68:71], v[80:83], v[48:63]
    buffer_load_dwordx4 v[64:67], v217, s[28:31], s69 offen offset:0 sc1
    s_waitcnt vmcnt(11)
    v_mfma_f32_32x32x16_bf16 v[32:47], a[72:75], v[84:87], v[32:47]
    v_mfma_f32_32x32x16_bf16 v[48:63], a[76:79], v[84:87], v[48:63]
    buffer_load_dwordx4 v[68:71], v217, s[28:31], s69 offen offset:1024 sc1
    s_waitcnt vmcnt(11)
    v_mfma_f32_32x32x16_bf16 v[32:47], a[80:83], v[88:91], v[32:47]
    v_mfma_f32_32x32x16_bf16 v[48:63], a[84:87], v[88:91], v[48:63]
    buffer_load_dwordx4 v[72:75], v217, s[28:31], s69 offen offset:2048 sc1
    s_waitcnt vmcnt(11)
    v_mfma_f32_32x32x16_bf16 v[32:47], a[88:91], v[92:95], v[32:47]
    v_mfma_f32_32x32x16_bf16 v[48:63], a[92:95], v[92:95], v[48:63]
    buffer_load_dwordx4 v[76:79], v217, s[28:31], s69 offen offset:3072 sc1
    s_waitcnt vmcnt(11)
    v_mfma_f32_32x32x16_bf16 v[0:15], a[96:99], v[96:99], v[0:15]
    v_mfma_f32_32x32x16_bf16 v[16:31], a[100:103], v[96:99], v[16:31]
    buffer_load_dwordx4 v[80:83], v217, s[28:31], s71 offen offset:0 sc1
    s_waitcnt vmcnt(11)
    v_mfma_f32_32x32x16_bf16 v[0:15], a[104:107], v[100:103], v[0:15]
    v_mfma_f32_32x32x16_bf16 v[16:31], a[108:111], v[100:103], v[16:31]
    buffer_load_dwordx4 v[84:87], v217, s[28:31], s71 offen offset:1024 sc1
    s_waitcnt vmcnt(11)
    v_mfma_f32_32x32x16_bf16 v[0:15], a[112:115], v[104:107], v[0:15]
    v_mfma_f32_32x32x16_bf16 v[16:31], a[116:119], v[104:107], v[16:31]
    buffer_load_dwordx4 v[88:91], v217, s[28:31], s71 offen offset:2048 sc1
    s_waitcnt vmcnt(11)
    v_mfma_f32_32x32x16_bf16 v[0:15], a[120:123], v[108:111], v[0:15]
    v_mfma_f32_32x32x16_bf16 v[16:31], a[124:127], v[108:111], v[16:31]
    buffer_load_dwordx4 v[92:95], v217, s[28:31], s71 offen offset:3072 sc1
    s_waitcnt vmcnt(11)
    v_mfma_f32_32x32x16_bf16 v[0:15], a[128:131], v[112:115], v[0:15]
    v_mfma_f32_32x32x16_bf16 v[16:31], a[132:135], v[112:115], v[16:31]
    buffer_load_dwordx4 v[96:99], v141, s[28:31], s66 offen offset:0 sc1
    s_waitcnt vmcnt(11)
    v_mfma_f32_32x32x16_bf16 v[0:15], a[136:139], v[116:119], v[0:15]
    v_mfma_f32_32x32x16_bf16 v[16:31], a[140:143], v[116:119], v[16:31]
    buffer_load_dwordx4 v[100:103], v141, s[28:31], s66 offen offset:1024 sc1
    s_waitcnt vmcnt(11)
    v_mfma_f32_32x32x16_bf16 v[0:15], a[144:147], v[120:123], v[0:15]
    v_mfma_f32_32x32x16_bf16 v[16:31], a[148:151], v[120:123], v[16:31]
    buffer_load_dwordx4 v[104:107], v141, s[28:31], s66 offen offset:2048 sc1
    s_waitcnt vmcnt(11)
    v_mfma_f32_32x32x16_bf16 v[0:15], a[152:155], v[124:127], v[0:15]
    v_mfma_f32_32x32x16_bf16 v[16:31], a[156:159], v[124:127], v[16:31]
    buffer_load_dwordx4 v[108:111], v141, s[28:31], s66 offen offset:3072 sc1
    s_waitcnt vmcnt(11)
    v_mfma_f32_32x32x16_bf16 v[0:15], a[160:163], v[64:67], v[0:15]
    v_mfma_f32_32x32x16_bf16 v[16:31], a[164:167], v[64:67], v[16:31]
    buffer_load_dwordx4 v[112:115], v220, s[28:31], s67 offen offset:0 sc1
    s_waitcnt vmcnt(11)
    v_mfma_f32_32x32x16_bf16 v[0:15], a[168:171], v[68:71], v[0:15]
    v_mfma_f32_32x32x16_bf16 v[16:31], a[172:175], v[68:71], v[16:31]
    buffer_load_dwordx4 v[116:119], v220, s[28:31], s67 offen offset:1024 sc1
    s_waitcnt vmcnt(11)
    v_mfma_f32_32x32x16_bf16 v[0:15], a[176:179], v[72:75], v[0:15]
    v_mfma_f32_32x32x16_bf16 v[16:31], a[180:183], v[72:75], v[16:31]
    buffer_load_dwordx4 v[120:123], v220, s[28:31], s67 offen offset:2048 sc1
    s_waitcnt vmcnt(11)
    v_mfma_f32_32x32x16_bf16 v[0:15], a[184:187], v[76:79], v[0:15]
    v_mfma_f32_32x32x16_bf16 v[16:31], a[188:191], v[76:79], v[16:31]
    buffer_load_dwordx4 v[124:127], v220, s[28:31], s67 offen offset:3072 sc1
    s_waitcnt vmcnt(11)
    v_mfma_f32_32x32x16_bf16 v[0:15], a[192:195], v[80:83], v[0:15]
    v_mfma_f32_32x32x16_bf16 v[16:31], a[196:199], v[80:83], v[16:31]
    buffer_load_dwordx4 v[64:67], v220, s[28:31], s69 offen offset:0 sc1
    s_waitcnt vmcnt(11)
    v_mfma_f32_32x32x16_bf16 v[0:15], a[200:203], v[84:87], v[0:15]
    v_mfma_f32_32x32x16_bf16 v[16:31], a[204:207], v[84:87], v[16:31]
    buffer_load_dwordx4 v[68:71], v220, s[28:31], s69 offen offset:1024 sc1
    s_waitcnt vmcnt(11)
    v_mfma_f32_32x32x16_bf16 v[0:15], a[208:211], v[88:91], v[0:15]
    v_mfma_f32_32x32x16_bf16 v[16:31], a[212:215], v[88:91], v[16:31]
    buffer_load_dwordx4 v[72:75], v220, s[28:31], s69 offen offset:2048 sc1
    s_waitcnt vmcnt(11)
    v_mfma_f32_32x32x16_bf16 v[0:15], a[216:219], v[92:95], v[0:15]
    v_mfma_f32_32x32x16_bf16 v[16:31], a[220:223], v[92:95], v[16:31]
    buffer_load_dwordx4 v[76:79], v220, s[28:31], s69 offen offset:3072 sc1
    s_waitcnt vmcnt(11)
    v_mfma_f32_32x32x16_bf16 v[32:47], a[96:99], v[96:99], v[32:47]
    v_mfma_f32_32x32x16_bf16 v[48:63], a[100:103], v[96:99], v[48:63]
    buffer_load_dwordx4 v[80:83], v220, s[28:31], s71 offen offset:0 sc1
    s_waitcnt vmcnt(11)
    v_mfma_f32_32x32x16_bf16 v[32:47], a[104:107], v[100:103], v[32:47]
    s_nop 3
    ds_write_b128 v211, v[4:7] offset:0
    ds_write_b128 v211, v[20:23] offset:1024
    v_mfma_f32_32x32x16_bf16 v[48:63], a[108:111], v[100:103], v[48:63]
    buffer_load_dwordx4 v[84:87], v220, s[28:31], s71 offen offset:1024 sc1
    ds_write_b128 v212, v[8:11] offset:0
    ds_write_b128 v212, v[24:27] offset:1024
    s_waitcnt vmcnt(11)
    v_mfma_f32_32x32x16_bf16 v[32:47], a[112:115], v[104:107], v[32:47]
    ds_write_b128 v213, v[12:15] offset:0
    ds_write_b128 v213, v[28:31] offset:1024
    v_mfma_f32_32x32x16_bf16 v[48:63], a[116:119], v[104:107], v[48:63]
    buffer_load_dwordx4 v[88:91], v220, s[28:31], s71 offen offset:2048 sc1
    s_waitcnt vmcnt(11)
    v_mfma_f32_32x32x16_bf16 v[32:47], a[120:123], v[108:111], v[32:47]
    v_mfma_f32_32x32x16_bf16 v[48:63], a[124:127], v[108:111], v[48:63]
    buffer_load_dwordx4 v[92:95], v220, s[28:31], s71 offen offset:3072 sc1
    s_waitcnt vmcnt(11)
    v_mfma_f32_32x32x16_bf16 v[32:47], a[128:131], v[112:115], v[32:47]
    v_mfma_f32_32x32x16_bf16 v[48:63], a[132:135], v[112:115], v[48:63]
    s_waitcnt vmcnt(10)
    v_mfma_f32_32x32x16_bf16 v[32:47], a[136:139], v[116:119], v[32:47]
    v_mfma_f32_32x32x16_bf16 v[48:63], a[140:143], v[116:119], v[48:63]
    s_waitcnt lgkmcnt(0)
    s_barrier
    ds_read_b128 v[184:187], v214 offset:0
    ds_read_b128 v[188:191], v214 offset:1024
    s_waitcnt vmcnt(9)
    v_mfma_f32_32x32x16_bf16 v[32:47], a[144:147], v[120:123], v[32:47]
    ds_read_b128 v[192:195], v214 offset:2048
    ds_read_b128 v[196:199], v214 offset:3072
    ds_read_b128 v[200:203], v214 offset:4096
    ds_read_b128 v[204:207], v214 offset:5120
    v_mfma_f32_32x32x16_bf16 v[48:63], a[148:151], v[120:123], v[48:63]
    s_waitcnt vmcnt(8)
    v_mfma_f32_32x32x16_bf16 v[32:47], a[152:155], v[124:127], v[32:47]
    v_mfma_f32_32x32x16_bf16 v[48:63], a[156:159], v[124:127], v[48:63]
    s_waitcnt vmcnt(7)
    v_mfma_f32_32x32x16_bf16 v[32:47], a[160:163], v[64:67], v[32:47]
    v_mfma_f32_32x32x16_bf16 v[48:63], a[164:167], v[64:67], v[48:63]
    s_add_u32 s94, s85, 0
    s_waitcnt lgkmcnt(4)
    v_add_f32 v0, v0, v184
    s_waitcnt vmcnt(6)
    v_mfma_f32_32x32x16_bf16 v[32:47], a[168:171], v[68:71], v[32:47]
    v_add_f32 v1, v1, v185
    v_add_f32 v2, v2, v186
    v_add_f32 v3, v3, v187
    v_mfma_f32_32x32x16_bf16 v[48:63], a[172:175], v[68:71], v[48:63]
    v_add_f32 v16, v16, v188
    v_add_f32 v17, v17, v189
    v_add_f32 v18, v18, v190
    s_waitcnt vmcnt(5)
    v_mfma_f32_32x32x16_bf16 v[32:47], a[176:179], v[72:75], v[32:47]
    v_add_f32 v19, v19, v191
    s_waitcnt lgkmcnt(2)
    v_mfma_f32_32x32x16_bf16 v[48:63], a[180:183], v[72:75], v[48:63]
    v_add_f32 v0, v0, v192
    v_add_f32 v1, v1, v193
    v_add_f32 v2, v2, v194
    v_add_f32 v3, v3, v195
    s_waitcnt vmcnt(4)
    v_mfma_f32_32x32x16_bf16 v[32:47], a[184:187], v[76:79], v[32:47]
    v_add_f32 v16, v16, v196
    v_add_f32 v17, v17, v197
    v_mfma_f32_32x32x16_bf16 v[48:63], a[188:191], v[76:79], v[48:63]
    v_add_f32 v18, v18, v198
    v_add_f32 v19, v19, v199
    s_waitcnt lgkmcnt(0)
    s_waitcnt vmcnt(3)
    v_mfma_f32_32x32x16_bf16 v[32:47], a[192:195], v[80:83], v[32:47]
    v_add_f32 v0, v0, v200
    v_add_f32 v1, v1, v201
    v_add_f32 v2, v2, v202
    v_mfma_f32_32x32x16_bf16 v[48:63], a[196:199], v[80:83], v[48:63]
    v_add_f32 v3, v3, v203
    v_add_f32 v16, v16, v204
    v_add_f32 v17, v17, v205
    s_waitcnt vmcnt(2)
    v_mfma_f32_32x32x16_bf16 v[32:47], a[200:203], v[84:87], v[32:47]
    v_add_f32 v18, v18, v206
    v_add_f32 v19, v19, v207
    v_mfma_f32_32x32x16_bf16 v[48:63], a[204:207], v[84:87], v[48:63]
    v_fma_f32 v160, v0, v218, v160
    v_fma_f32 v161, v1, v218, v161
    v_fma_f32 v162, v2, v218, v162
    v_fma_f32 v163, v3, v218, v163
    s_waitcnt vmcnt(1)
    v_mfma_f32_32x32x16_bf16 v[32:47], a[208:211], v[88:91], v[32:47]
    v_fma_f32 v164, v16, v218, v164
    v_fma_f32 v165, v17, v218, v165
    v_mfma_f32_32x32x16_bf16 v[48:63], a[212:215], v[88:91], v[48:63]
    v_fma_f32 v166, v18, v218, v166
    v_fma_f32 v167, v19, v218, v167
    v_cvt_pk_bf16_f32 v176, v160, v161
    s_waitcnt vmcnt(0)
    v_mfma_f32_32x32x16_bf16 v[32:47], a[216:219], v[92:95], v[32:47]
    v_cvt_pk_bf16_f32 v177, v162, v163
    v_cvt_pk_bf16_f32 v178, v164, v165
    v_cvt_pk_bf16_f32 v179, v166, v167
    v_mfma_f32_32x32x16_bf16 v[48:63], a[220:223], v[92:95], v[48:63]
    v_permlane32_swap_b32 v176, v178
    v_permlane32_swap_b32 v177, v179
    buffer_store_dwordx4 v[176:179], v215, s[24:27], s94 offen
    s_nop 4
    ds_write_b128 v152, v[36:39] offset:0
    s_nop 2
    ds_write_b128 v152, v[52:55] offset:1024
    ds_write_b128 v153, v[40:43] offset:0
    ds_write_b128 v153, v[56:59] offset:1024
    ds_write_b128 v154, v[44:47] offset:0
    ds_write_b128 v154, v[60:63] offset:1024
    s_waitcnt lgkmcnt(0)
    s_barrier
    ds_read_b128 v[128:131], v155 offset:0
    ds_read_b128 v[132:135], v155 offset:1024
    ds_read_b128 v[136:139], v155 offset:2048
    ds_read_b128 v[140:143], v155 offset:3072
    ds_read_b128 v[144:147], v155 offset:4096
    ds_read_b128 v[148:151], v155 offset:5120
    s_add_u32 s92, s85, 65536
    s_waitcnt lgkmcnt(4)
    v_pk_add_f32 v[32:33], v[32:33], v[128:129]
    v_pk_add_f32 v[34:35], v[34:35], v[130:131]
    v_pk_add_f32 v[48:49], v[48:49], v[132:133]
    v_pk_add_f32 v[50:51], v[50:51], v[134:135]
    s_waitcnt lgkmcnt(2)
    v_pk_add_f32 v[32:33], v[32:33], v[136:137]
    v_pk_add_f32 v[34:35], v[34:35], v[138:139]
    v_pk_add_f32 v[48:49], v[48:49], v[140:141]
    v_pk_add_f32 v[50:51], v[50:51], v[142:143]
    s_waitcnt lgkmcnt(0)
    v_pk_add_f32 v[32:33], v[32:33], v[144:145]
    v_pk_add_f32 v[34:35], v[34:35], v[146:147]
    v_pk_add_f32 v[48:49], v[48:49], v[148:149]
    v_pk_add_f32 v[50:51], v[50:51], v[150:151]
    v_pk_fma_f32 v[168:169], v[32:33], v[218:219], v[168:169] op_sel:[0,1,0] op_sel_hi:[1,1,1]
    v_pk_fma_f32 v[170:171], v[34:35], v[218:219], v[170:171] op_sel:[0,1,0] op_sel_hi:[1,1,1]
    v_pk_fma_f32 v[172:173], v[48:49], v[218:219], v[172:173] op_sel:[0,1,0] op_sel_hi:[1,1,1]
    v_pk_fma_f32 v[174:175], v[50:51], v[218:219], v[174:175] op_sel:[0,1,0] op_sel_hi:[1,1,1]
    v_cvt_pk_bf16_f32 v180, v168, v169
    v_cvt_pk_bf16_f32 v181, v170, v171
    v_cvt_pk_bf16_f32 v182, v172, v173
    v_cvt_pk_bf16_f32 v183, v174, v175
    s_nop 0
    v_permlane32_swap_b32 v180, v182
    v_permlane32_swap_b32 v181, v183
    buffer_store_dwordx4 v[180:183], v215, s[24:27], s92 offen
    s_or_b32 s92, s45, s44
    s_cmp_lg_u32 s92, 0
    s_cbranch_scc1 L_noep
    s_add_u32 s92, s50, 64
    v_mov_b32 v10, s92
    v_mov_b32 v11, 2130706432
    s_mov_b32 s92, 1769728
    v_writelane_b32 v11, s92, 0
    s_nop 0
    buffer_store_dword v10, v11, s[28:31], 0 offen sc1
L_noep:
L_end:
    s_endpgm
L_chk_4:
    s_add_u32 s53, s53, 1
    s_cmp_lt_u32 s53, 0x40000
    s_cbranch_scc1 L_poll_3
    s_branch L_done_5
L_slow_1:
    s_add_u32 s91, s50, 40
L_poll_3:
    buffer_load_dword v199, v87, s[28:31], 0 offen sc1
    s_waitcnt vmcnt(0)
    v_subrev_u32 v199, s91, v199
    v_cmp_gt_u32 vcc, 8, v199
    s_nop 0
    s_andn2_b64 s[96:97], s[60:61], vcc
    s_cbranch_scc1 L_chk_4
L_done_5:
    s_nop 1
    s_branch L_pback_2
L_safe_6:
    s_nop 15
    buffer_store_dword v10, v208, s[28:31], 0 offen sc1
    s_nop 1
    s_branch L_back_7
L_chk_9:
    s_add_u32 s53, s53, 1
    s_cmp_lt_u32 s53, 0x40000
    s_cbranch_scc1 L_poll_8
    s_branch L_done_10
L_safe_11:
    s_nop 15
    buffer_store_dword v220, v208, s[28:31], 0 offen sc1
    s_nop 1
    s_branch L_back_12
L_chk_14:
    s_add_u32 s53, s53, 1
    s_cmp_lt_u32 s53, 0x40000
    s_cbranch_scc1 L_poll_13
    s_branch L_done_15
L_safe_16:
    s_nop 15
    buffer_store_dword v160, v164, s[28:31], s94 offen sc1
    s_nop 1
    s_branch L_back_17
L_safe_18:
    s_nop 15
    buffer_store_dword v165, v208, s[28:31], 0 offen sc1
    s_nop 1
    s_branch L_back_19
L_chk_23:
    s_add_u32 s53, s53, 1
    s_cmp_lt_u32 s53, 0x40000
    s_cbranch_scc1 L_poll_22
    s_branch L_done_24
L_slow_20:
    s_add_u32 s91, s50, 4
L_poll_22:
    buffer_load_dword v168, v209, s[28:31], 0 offen sc1
    s_waitcnt vmcnt(0)
    v_subrev_u32 v168, s91, v168
    v_cmp_gt_u32 vcc, 32, v168
    s_nop 0
    s_andn2_b64 s[96:97], s[54:55], vcc
    s_cbranch_scc1 L_chk_23
L_done_24:
    s_nop 1
    s_branch L_pback_21
L_safe_25:
    s_nop 15
    buffer_store_dword v0, v208, s[28:31], 0 offen sc1
    s_nop 1
    s_branch L_back_26
L_safe_27:
    s_nop 15
    buffer_store_dword v1, v208, s[28:31], 0 offen sc1
    s_nop 1
    s_branch L_back_28
L_chk_30:
    s_add_u32 s53, s53, 1
    s_cmp_lt_u32 s53, 0x40000
    s_cbranch_scc1 L_poll_29
    s_branch L_done_31
L_chk_35:
    s_add_u32 s53, s53, 1
    s_cmp_lt_u32 s53, 0x40000
    s_cbranch_scc1 L_poll_34
    s_branch L_done_36
L_slow_32:
    s_add_u32 s91, s50, 6
L_poll_34:
    buffer_load_dword v184, v209, s[28:31], 0 offen sc1
    s_waitcnt vmcnt(0)
    v_subrev_u32 v184, s91, v184
    v_cmp_gt_u32 vcc, 32, v184
    s_nop 0
    s_andn2_b64 s[96:97], s[58:59], vcc
    s_cbranch_scc1 L_chk_35
L_done_36:
    s_nop 1
    s_branch L_pback_33
L_safe_37:
    s_nop 15
    buffer_store_dwordx4 v[180:183], v223, s[28:31], s94 offen sc1
    s_nop 1
    s_branch L_back_38
L_safe_39:
    s_nop 15
    buffer_store_dwordx4 v[176:179], v223, s[28:31], s92 offen sc1
    s_nop 1
    s_branch L_back_40
L_safe_41:
    s_nop 15
    buffer_store_dword v220, v208, s[28:31], 0 offen sc1
    s_nop 1
    s_branch L_back_42
L_chk_44:
    s_add_u32 s53, s53, 1
    s_cmp_lt_u32 s53, 0x40000
    s_cbranch_scc1 L_poll_43
    s_branch L_done_45
L_safe_46:
    s_nop 15
    buffer_store_dword v48, v52, s[28:31], s94 offen sc1
    s_nop 1
    s_branch L_back_47
L_safe_48:
    s_nop 15
    buffer_store_dword v53, v88, s[28:31], 0 offen sc1
    s_nop 1
    s_branch L_back_49
L_chk_53:
    s_add_u32 s53, s53, 1
    s_cmp_lt_u32 s53, 0x40000
    s_cbranch_scc1 L_poll_52
    s_branch L_done_54
L_slow_50:
    s_add_u32 s91, s50, 2
L_poll_52:
    buffer_load_dword v196, v87, s[28:31], 0 offen sc1
    s_waitcnt vmcnt(0)
    v_subrev_u32 v196, s91, v196
    v_cmp_gt_u32 vcc, 32, v196
    s_nop 0
    s_andn2_b64 s[96:97], s[62:63], vcc
    s_cbranch_scc1 L_chk_53
L_done_54:
    s_nop 1
    s_branch L_pback_51
L_chk_58:
    s_add_u32 s53, s53, 1
    s_cmp_lt_u32 s53, 0x40000
    s_cbranch_scc1 L_poll_57
    s_branch L_done_59
L_slow_55:
    s_add_u32 s91, s50, 8
L_poll_57:
    buffer_load_dword v196, v89, s[28:31], 0 offen sc1
    s_waitcnt vmcnt(0)
    v_subrev_u32 v196, s91, v196
    v_cmp_gt_u32 vcc, 32, v196
    s_nop 0
    s_andn2_b64 s[96:97], s[54:55], vcc
    s_cbranch_scc1 L_chk_58
L_done_59:
    s_nop 1
    s_branch L_pback_56
L_safe_60:
    s_nop 15
    buffer_store_dwordx4 v[0:3], v223, s[28:31], s84 offen offset:0 sc1
    buffer_store_dwordx4 v[4:7], v223, s[28:31], s84 offen offset:1024 sc1
    s_nop 1
    s_branch L_back_61
L_safe_62:
    s_nop 15
    buffer_store_dword v10, v208, s[28:31], 0 offen sc1
    s_nop 1
    s_branch L_back_63
L_chk_65:
    s_add_u32 s53, s53, 1
    s_cmp_lt_u32 s53, 0x40000
    s_cbranch_scc1 L_poll_64
    s_branch L_done_66
L_safe_67:
    s_nop 15
    buffer_store_dwordx4 v[176:179], v223, s[28:31], s94 offen sc1
    s_nop 1
    s_branch L_back_68
L_safe_69:
    s_nop 15
    buffer_store_dwordx4 v[180:183], v223, s[28:31], s92 offen sc1
    s_nop 1
    s_branch L_back_70
L_safe_71:
    s_nop 15
    buffer_store_dword v220, v208, s[28:31], 0 offen sc1
    s_nop 1
    s_branch L_back_72
L_chk_74:
    s_add_u32 s53, s53, 1
    s_cmp_lt_u32 s53, 0x40000
    s_cbranch_scc1 L_poll_73
    s_branch L_done_75
L_safe_76:
    s_nop 15
    buffer_store_dword v160, v164, s[28:31], s94 offen sc1
    s_nop 1
    s_branch L_back_77
L_safe_78:
    s_nop 15
    buffer_store_dword v165, v208, s[28:31], 0 offen sc1
    s_nop 1
    s_branch L_back_79
L_chk_83:
    s_add_u32 s53, s53, 1
    s_cmp_lt_u32 s53, 0x40000
    s_cbranch_scc1 L_poll_82
    s_branch L_done_84
L_slow_80:
    s_add_u32 s91, s50, 11
L_poll_82:
    buffer_load_dword v168, v209, s[28:31], 0 offen sc1
    s_waitcnt vmcnt(0)
    v_subrev_u32 v168, s91, v168
    v_cmp_gt_u32 vcc, 32, v168
    s_nop 0
    s_andn2_b64 s[96:97], s[54:55], vcc
    s_cbranch_scc1 L_chk_83
L_done_84:
    s_nop 1
    s_branch L_pback_81
L_safe_85:
    s_nop 15
    buffer_store_dwordx4 v[8:11], v223, s[40:43], s84 offen offset:0 sc1
    buffer_store_dwordx4 v[12:15], v223, s[40:43], s84 offen offset:1024 sc1
    s_nop 1
    s_branch L_back_86
L_safe_87:
    s_nop 15
    buffer_store_dwordx4 v[24:27], v223, s[40:43], s84 offen offset:2048 sc1
    buffer_store_dwordx4 v[28:31], v223, s[40:43], s84 offen offset:3072 sc1
    s_nop 1
    s_branch L_back_88
L_safe_89:
    s_nop 15
    buffer_store_dword v0, v208, s[28:31], 0 offen sc1
    s_nop 1
    s_branch L_back_90
L_safe_91:
    s_nop 15
    buffer_store_dwordx4 v[64:67], v223, s[40:43], s85 offen offset:0 sc1
    buffer_store_dwordx4 v[68:71], v223, s[40:43], s85 offen offset:1024 sc1
    s_nop 1
    s_branch L_back_92
L_safe_93:
    s_nop 15
    buffer_store_dwordx4 v[80:83], v223, s[40:43], s85 offen offset:2048 sc1
    buffer_store_dwordx4 v[84:87], v223, s[40:43], s85 offen offset:3072 sc1
    s_nop 1
    s_branch L_back_94
L_safe_95:
    s_nop 15
    buffer_store_dword v1, v208, s[28:31], 0 offen sc1
    s_nop 1
    s_branch L_back_96
L_chk_98:
    s_add_u32 s53, s53, 1
    s_cmp_lt_u32 s53, 0x40000
    s_cbranch_scc1 L_poll_97
    s_branch L_done_99
L_chk_103:
    s_add_u32 s53, s53, 1
    s_cmp_lt_u32 s53, 0x40000
    s_cbranch_scc1 L_poll_102
    s_branch L_done_104
L_slow_100:
    s_add_u32 s91, s50, 13
L_poll_102:
    buffer_load_dword v184, v209, s[28:31], 0 offen sc1
    s_waitcnt vmcnt(0)
    v_subrev_u32 v184, s91, v184
    v_cmp_gt_u32 vcc, 32, v184
    s_nop 0
    s_andn2_b64 s[96:97], s[58:59], vcc
    s_cbranch_scc1 L_chk_103
L_done_104:
    s_nop 1
    s_branch L_pback_101
    s_endpgm
L_code_end:
    s_endpgm

.section .rodata,"a"
.p2align 6
.amdhsa_kernel interleave_layers__sliding_local_dilated__dense_activation_relu__prompt_kernel
  .amdhsa_next_free_vgpr 512
  .amdhsa_next_free_sgpr 102
  .amdhsa_accum_offset 256
  .amdhsa_group_segment_fixed_size 0
  .amdhsa_kernarg_size 72
  .amdhsa_user_sgpr_count 2
  .amdhsa_user_sgpr_kernarg_segment_ptr 1
  .amdhsa_system_sgpr_workgroup_id_x 1
  .amdhsa_float_denorm_mode_32 3
.end_amdhsa_kernel
```
